```python
import torch

def _softmax(x, axis=-1):
    return torch.softmax(x, dim=axis)
def _gelu(x):
    return torch.nn.functional.gelu(x, approximate="tanh")
def _silu(x):
    return torch.nn.functional.silu(x)
def _sigmoid(x):
    return torch.sigmoid(x)
def _layernorm(x, axis=-1, eps=1e-5):
    m = x.mean(dim=axis, keepdim=True)
    v = x.var(dim=axis, keepdim=True, unbiased=False)
    return (x - m) / torch.sqrt(v + eps)
def _scatter_add(tgt, idx, src, axis=0):
    return tgt.clone().index_add_(axis, idx, src)
def _segment_sum(src, seg, n):
    out = torch.zeros((n,) + src.shape[1:], dtype=src.dtype)
    return out.index_add_(0, seg, src)
def _pad(x, pw):
    flat = tuple(v for pair in reversed(pw) for v in pair)
    return torch.nn.functional.pad(x, flat)

kernel_name = 'interleave_layers__sliding_block__dense_activation_silu__prompt'

def setup_inputs():

    _w = (lambda a: (lambda t: t.to(torch.bfloat16) if t.is_floating_point() else t)(torch.as_tensor(a)))
    def _A_setup():
        B, S, D = 1, 2048, 512
        return {
            "x": _w((lambda *s: torch.randn(*s, dtype=torch.bfloat16) * 0.05)(B, S, D)),
            "wqkv": _w((lambda *s: torch.randn(*s, dtype=torch.bfloat16) * 0.05)(D, 3 * D)),
            "wo": _w((lambda *s: torch.randn(*s, dtype=torch.bfloat16) * 0.05)(D, D)),
        }
    _A_in = _A_setup()

    def _B_setup():
        B, S, D, F = 1, 2048, 512, 1792
        return {
            "x": _w((lambda *s: torch.randn(*s, dtype=torch.bfloat16) * 0.05)(B, S, D)),
            "w1": _w((lambda *s: torch.randn(*s, dtype=torch.bfloat16) * 0.8)(D, F) * (D ** -0.5)),
            "w2": _w((lambda *s: torch.randn(*s, dtype=torch.bfloat16) * 0.8)(F, D) * (F ** -0.5)),
        }
    _B_in = _B_setup()

    return {
        "A_x": _A_in["x"],
        "A_wqkv": _A_in["wqkv"],
        "A_wo": _A_in["wo"],
        "B_x": _B_in["x"],
        "B_w1": _B_in["w1"],
        "B_w2": _B_in["w2"],
    }

def reference(A_x, A_wqkv, A_wo, B_x, B_w1, B_w2):
    def _A_ref(x, wqkv, wo):
        B, S, D = x.shape
        H = 32; Dh = D // H; W = 256
        qkv = (lambda x, *d: x.permute(*d))((x @ wqkv).reshape(B, S, 3, H, Dh), 2, 0, 3, 1, 4)
        q, k, v = qkv[0], qkv[1], qkv[2]
        scores = torch.einsum("bhqd,bhkd->bhqk", q, k) * (Dh ** -0.5)
        idx = torch.arange(S)
        mask = (idx[:, None] - idx[None, :] >= 0) & (idx[:, None] - idx[None, :] < W)
        scores = torch.where(mask[None, None], scores, -1e9)
        p = _softmax(scores, axis=-1)
        o = torch.einsum("bhqk,bhkd->bhqd", p, v)
        return (lambda x, *d: x.permute(*d))(o, 0, 2, 1, 3).reshape(B, S, D) @ wo

    def _B_ref(x, w1, w2):
        h = torch.einsum("bsd,df->bsf", x, w1)
        h = _silu(h)
        out = torch.einsum("bsf,fd->bsd", h, w2)
        return out

    x = A_x
    x = x + _A_ref(_layernorm(x, axis=-1), A_wqkv, A_wo)
    x = x + _B_ref(_layernorm(x, axis=-1), B_w1, B_w2)
    x = x + _A_ref(_layernorm(x, axis=-1), A_wqkv, A_wo)
    x = x + _B_ref(_layernorm(x, axis=-1), B_w1, B_w2)
    return x
```

```asm
; @launch kernel=prep_kernel grid=(608,1,1) block=(256,1,1) lds=16384
; @launch kernel=main_kernel grid=(256,1,1) block=(256,1,1) lds=163840
.amdgcn_target "amdgcn-amd-amdhsa--gfx950"
.text
.globl prep_kernel
.p2align 8
.type prep_kernel,@function
prep_kernel:
    s_load_dwordx2 s[96:97], s[0:1], 64
    s_load_dwordx4 s[64:67], s[0:1], 0
    s_load_dwordx2 s[68:69], s[0:1], 16
    s_load_dwordx4 s[72:75], s[0:1], 32
    s_cmp_ge_u32 s2, 608
    s_cbranch_scc1 P_end
    v_lshrrev_b32 v1, 6, v0
    s_nop 0
    v_readfirstlane_b32 s20, v1
    v_mov_b32 v48, v0
    v_and_b32 v0, 63, v0
    s_cmp_ge_u32 s2, 256
    s_cbranch_scc1 P_w
    s_cmp_lg_u32 s20, 3
    s_cbranch_scc1 P_nopf
    s_getpc_b64 s[40:41]
P_pc:
    s_add_u32 s40, s40, main_kernel-P_pc
    s_addc_u32 s41, s41, 0
    s_lshr_b32 s30, s2, 3
    s_lshl_b32 s30, s30, 11
    s_cmp_ge_u32 s30, M_slow-main_kernel
    s_cbranch_scc1 P_nopf
    v_lshlrev_b32 v80, 4, v0
    v_add_u32 v80, s30, v80
    global_load_dwordx4 v[84:87], v80, s[40:41]
    global_load_dwordx4 v[88:91], v80, s[40:41] offset:1024
P_nopf:
    s_and_b32 s30, s2, 7
    s_lshr_b32 s31, s2, 3
    s_and_b32 s22, s31, 15
    s_lshr_b32 s31, s31, 4
    s_lshl_b32 s21, s30, 1
    s_add_u32 s21, s21, s31
    s_lshr_b32 s23, s22, 3
    s_and_b32 s24, s22, 7
    s_lshl_b32 s28, s21, 2
    s_lshl_b32 s29, s23, 1
    s_add_u32 s29, s29, s28
    s_add_u32 s28, s28, s20
    s_mov_b32 s63, 32768
    v_and_b32 v50, 7, v0
    v_lshrrev_b32 v51, 3, v0
    s_lshl_b32 s30, s20, 3
    v_add_u32 v52, s30, v50
    v_lshlrev_b32 v4, 10, v52
    v_lshl_add_u32 v4, v51, 4, v4
    s_lshl_b32 s30, s29, 15
    s_lshl_b32 s31, s24, 7
    s_add_u32 s30, s30, s31
    v_add_u32 v4, s30, v4
    v_lshrrev_b32 v53, 1, v51
    v_lshlrev_b32 v5, 10, v53
    v_and_b32 v53, 1, v51
    v_lshl_add_u32 v53, v53, 5, v52
    v_lshl_add_u32 v5, v53, 4, v5
    s_lshl_b32 s30, s29, 15
    s_lshl_b32 s31, s24, 12
    s_add_u32 s30, s30, s31
    s_add_u32 s30, s30, 16777216
    v_add_u32 v5, s30, v5
    v_bfe_u32 v53, v0, 4, 1
    v_lshlrev_b32 v53, 2, v53
    v_lshl_add_u32 v7, v52, 3, v53
    s_lshl_b32 s30, s29, 11
    s_lshl_b32 s31, s24, 8
    s_add_u32 s30, s30, s31
    s_add_u32 s30, s30, 18874368
    v_add_u32 v7, s30, v7
    s_waitcnt lgkmcnt(0)
    s_mov_b32 s8, s64
    s_mov_b32 s9, s65
    s_mov_b32 s10, 0x200000
    s_mov_b32 s11, 0x00020000
    s_mov_b32 s4, s96
    s_mov_b32 s5, s97
    s_mov_b32 s6, 0x10000000
    s_mov_b32 s7, 0x00020000
    buffer_load_dwordx4 v[56:59], v4, s[8:11], 0 offen nt
    buffer_load_dwordx4 v[64:67], v4, s[8:11], s63 offen nt
    v_mov_b32 v72, 0
    v_lshlrev_b32 v48, 2, v48
    s_mul_i32 s30, s2, 768
    s_waitcnt vmcnt(0)
    v_lshlrev_b32 v16, 16, v56
    v_and_b32 v17, 0xffff0000, v56
    v_lshlrev_b32 v18, 16, v57
    v_and_b32 v19, 0xffff0000, v57
    v_lshlrev_b32 v20, 16, v58
    v_and_b32 v21, 0xffff0000, v58
    v_lshlrev_b32 v22, 16, v59
    v_and_b32 v23, 0xffff0000, v59
    v_lshlrev_b32 v24, 16, v64
    v_and_b32 v25, 0xffff0000, v64
    v_lshlrev_b32 v26, 16, v65
    v_and_b32 v27, 0xffff0000, v65
    v_lshlrev_b32 v28, 16, v66
    v_and_b32 v29, 0xffff0000, v66
    v_lshlrev_b32 v30, 16, v67
    v_and_b32 v31, 0xffff0000, v67
    buffer_store_dwordx4 v[56:59], v5, s[4:7], 0 offen
    v_pk_add_f32 v[60:61], v[16:17], v[18:19]
    v_pk_mul_f32 v[62:63], v[16:17], v[16:17]
    v_pk_fma_f32 v[62:63], v[18:19], v[18:19], v[62:63]
    v_pk_add_f32 v[60:61], v[60:61], v[20:21]
    v_pk_fma_f32 v[62:63], v[20:21], v[20:21], v[62:63]
    v_pk_add_f32 v[60:61], v[60:61], v[22:23]
    v_pk_fma_f32 v[62:63], v[22:23], v[22:23], v[62:63]
    v_add_f32 v60, v60, v61
    v_add_f32 v62, v62, v63
    s_nop 1
    v_permlane16_swap_b32 v60, v62
    v_add_f32 v60, v60, v62
    s_nop 1
    v_add_f32_dpp v60, v60, v60 row_ror:8 row_mask:0xf bank_mask:0xf
    v_mov_b32 v62, v60
    s_nop 1
    v_permlane32_swap_b32 v60, v62
    v_add_f32 v60, v60, v62
    s_mov_b64 exec, 0xff00ff
    buffer_store_dword v60, v7, s[4:7], 0 offen offset:0
    s_mov_b64 exec, -1
    buffer_store_dwordx4 v[64:67], v5, s[4:7], s63 offen
    v_pk_add_f32 v[68:69], v[24:25], v[26:27]
    v_pk_mul_f32 v[70:71], v[24:25], v[24:25]
    v_pk_fma_f32 v[70:71], v[26:27], v[26:27], v[70:71]
    v_pk_add_f32 v[68:69], v[68:69], v[28:29]
    v_pk_fma_f32 v[70:71], v[28:29], v[28:29], v[70:71]
    v_pk_add_f32 v[68:69], v[68:69], v[30:31]
    v_pk_fma_f32 v[70:71], v[30:31], v[30:31], v[70:71]
    v_add_f32 v68, v68, v69
    v_add_f32 v70, v70, v71
    s_nop 1
    v_permlane16_swap_b32 v68, v70
    v_add_f32 v68, v68, v70
    s_nop 1
    v_add_f32_dpp v68, v68, v68 row_ror:8 row_mask:0xf bank_mask:0xf
    v_mov_b32 v70, v68
    s_nop 1
    v_permlane32_swap_b32 v68, v70
    v_add_f32 v68, v68, v70
    s_mov_b64 exec, 0xff00ff
    buffer_store_dword v68, v7, s[4:7], 0 offen offset:2048
    s_mov_b64 exec, -1
    s_cmp_eq_u32 s20, 3
    s_cbranch_scc1 P_done
    buffer_store_dword v72, v48, s[4:7], s30 offen
    s_branch P_done
P_w:
    s_sub_u32 s33, s2, 256
    s_lshl_b32 s33, s33, 2
    s_add_u32 s33, s33, s20
    v_lshlrev_b32 v1, 4, v0
    v_lshlrev_b32 v10, 2, v0
    v_bfe_u32 v6, v0, 2, 2
    v_and_b32 v7, 3, v0
    s_lshl_b32 s23, s20, 12
    s_waitcnt lgkmcnt(0)
    s_mov_b32 s4, s96
    s_mov_b32 s5, s97
    s_mov_b32 s6, 0x10000000
    s_mov_b32 s7, 0x00020000
    s_cmp_ge_u32 s33, 384
    s_cbranch_scc1 P_n1
    s_mov_b32 s8, s66
    s_mov_b32 s9, s67
    s_mov_b32 s10, 0x180000
    s_mov_b32 s11, 0x00020000
    s_mul_i32 s34, s33, 2731
    s_lshr_b32 s34, s34, 16
    s_mul_i32 s36, s34, 24
    s_sub_u32 s35, s33, s36
    s_mov_b32 s36, 3072
    s_mov_b32 s76, 2
    s_branch P_go
P_n1:
    s_cmp_ge_u32 s33, 832
    s_cbranch_scc1 P_n2
    s_mov_b32 s8, s72
    s_mov_b32 s9, s73
    s_mov_b32 s10, 0x1c0000
    s_mov_b32 s11, 0x00020000
    s_sub_u32 s35, s33, 384
    s_mul_i32 s34, s35, 2341
    s_lshr_b32 s34, s34, 16
    s_mul_i32 s36, s34, 28
    s_sub_u32 s35, s35, s36
    s_mov_b32 s36, 3584
    s_mov_b32 s76, 1
    s_branch P_go
P_n2:
    s_cmp_ge_u32 s33, 960
    s_cbranch_scc1 P_n3
    s_mov_b32 s8, s68
    s_mov_b32 s9, s69
    s_mov_b32 s10, 0x80000
    s_mov_b32 s11, 0x00020000
    s_sub_u32 s34, s33, 832
    s_and_b32 s35, s34, 7
    s_lshr_b32 s34, s34, 3
    s_mul_i32 s77, s35, 65536
    s_add_u32 s77, s77, 1048576
    s_mov_b32 s76, 0
    s_mov_b32 s36, 1024
    s_branch P_go
P_n3:
    s_mov_b32 s8, s74
    s_mov_b32 s9, s75
    s_mov_b32 s10, 0x1c0000
    s_mov_b32 s11, 0x00020000
    s_sub_u32 s34, s33, 960
    s_and_b32 s35, s34, 7
    s_lshr_b32 s34, s34, 3
    s_mul_i32 s77, s35, 229376
    s_add_u32 s77, s77, 1572864
    s_mov_b32 s76, 0
    s_mov_b32 s36, 1024
P_go:
    v_lshrrev_b32 v12, 3, v0
    v_mul_lo_u32 v12, v12, s36
    v_and_b32 v13, 7, v0
    v_lshl_add_u32 v12, v13, 4, v12
    s_mul_i32 s37, s34, s36
    s_lshl_b32 s37, s37, 5
    s_lshl_b32 s30, s35, 7
    s_add_u32 s37, s37, s30
    s_lshl_b32 s36, s36, 3
    s_add_u32 m0, s23, 0
    s_nop 0
    buffer_load_dwordx4 v12, s[8:11], s37 offen nt lds
    s_add_u32 s37, s37, s36
    s_add_u32 m0, s23, 1024
    s_nop 0
    buffer_load_dwordx4 v12, s[8:11], s37 offen nt lds
    s_add_u32 s37, s37, s36
    s_add_u32 m0, s23, 2048
    s_nop 0
    buffer_load_dwordx4 v12, s[8:11], s37 offen nt lds
    s_add_u32 s37, s37, s36
    s_add_u32 m0, s23, 3072
    s_nop 0
    buffer_load_dwordx4 v12, s[8:11], s37 offen nt lds
    v_mov_b32 v32, 0x3f803f80
    v_mov_b32 v33, 0x3f803f80
    v_mov_b32 v34, 0x3f803f80
    v_mov_b32 v35, 0x3f803f80
    s_cmp_eq_u32 s76, 1
    s_cbranch_scc1 P_16
    s_cmp_eq_u32 s76, 2
    s_cselect_b32 s30, 3, 2
    s_lshr_b32 s31, 4096, s30
    v_lshrrev_b32 v14, 5, v0
    v_lshlrev_b32 v14, s30, v14
    v_add_u32 v14, v14, v6
    v_lshlrev_b32 v14, 7, v14
    v_bfe_u32 v15, v0, 4, 1
    v_lshl_add_u32 v14, v15, 5, v14
    v_lshl_add_u32 v14, v7, 3, v14
    v_add_u32 v14, s23, v14
    v_add_u32 v15, s31, v14
    s_waitcnt vmcnt(0)
    ds_read_b64_tr_b16 v[16:17], v14 offset:0
    ds_read_b64_tr_b16 v[18:19], v15 offset:0
    ds_read_b64_tr_b16 v[20:21], v14 offset:64
    ds_read_b64_tr_b16 v[22:23], v15 offset:64
    ds_read_b64_tr_b16 v[24:25], v14 offset:2048
    ds_read_b64_tr_b16 v[26:27], v15 offset:2048
    ds_read_b64_tr_b16 v[28:29], v14 offset:2112
    ds_read_b64_tr_b16 v[30:31], v15 offset:2112
    s_cmp_eq_u32 s76, 2
    s_cbranch_scc1 P_q
    s_lshl_b32 s30, s34, 12
    s_add_u32 s77, s77, s30
    s_waitcnt lgkmcnt(0)
    buffer_store_dwordx4 v[16:19], v1, s[4:7], s77 offen offset:0
    buffer_store_dwordx4 v[20:23], v1, s[4:7], s77 offen offset:1024
    buffer_store_dwordx4 v[24:27], v1, s[4:7], s77 offen offset:2048
    buffer_store_dwordx4 v[28:31], v1, s[4:7], s77 offen offset:3072
    s_branch P_done
P_q:
    s_and_b32 s30, s35, 7
    s_mul_i32 s77, s30, 196608
    s_lshr_b32 s30, s35, 3
    s_lshl_b32 s30, s30, 12
    s_add_u32 s77, s77, s30
    s_lshr_b32 s30, s34, 1
    s_mul_i32 s30, s30, 12288
    s_add_u32 s77, s77, s30
    s_and_b32 s30, s34, 1
    s_lshl_b32 s30, s30, 11
    s_add_u32 s77, s77, s30
    s_add_u32 s77, s77, 6291456
    s_add_u32 s78, s77, 98304
    s_waitcnt lgkmcnt(0)
    v_mfma_f32_32x32x16_bf16 v[64:79], v[32:35], v[16:19], 0
    v_mfma_f32_32x32x16_bf16 v[80:95], v[32:35], v[20:23], 0
    v_mfma_f32_32x32x16_bf16 v[64:79], v[32:35], v[24:27], v[64:79]
    v_mfma_f32_32x32x16_bf16 v[80:95], v[32:35], v[28:31], v[80:95]
    buffer_store_dwordx4 v[16:19], v1, s[4:7], s77 offen offset:0
    buffer_store_dwordx4 v[20:23], v1, s[4:7], s78 offen offset:0
    buffer_store_dwordx4 v[24:27], v1, s[4:7], s77 offen offset:1024
    buffer_store_dwordx4 v[28:31], v1, s[4:7], s78 offen offset:1024
    s_mul_i32 s30, s34, 6144
    s_lshl_b32 s31, s35, 8
    s_add_u32 s30, s30, s31
    s_add_u32 s30, s30, 5373952
    s_mov_b32 exec_lo, 0
    s_nop 2
    v_mov_b32 v64, v80
    s_mov_b64 exec, -1
    buffer_store_dword v64, v10, s[4:7], s30 offen
    s_branch P_done
P_16:
    v_lshrrev_b32 v14, 4, v0
    v_lshl_add_u32 v14, v14, 3, v6
    v_lshlrev_b32 v14, 7, v14
    v_lshl_add_u32 v14, v7, 3, v14
    v_add_u32 v14, s23, v14
    v_lshrrev_b32 v15, 5, v0
    v_mul_u32_u24 v15, 3584, v15
    v_and_b32 v13, 31, v0
    v_lshl_add_u32 v15, v13, 4, v15
    s_mul_i32 s78, s34, 7168
    s_waitcnt vmcnt(0)
    ds_read_b64_tr_b16 v[16:17], v14 offset:0
    ds_read_b64_tr_b16 v[18:19], v14 offset:512
    ds_read_b64_tr_b16 v[20:21], v14 offset:32
    ds_read_b64_tr_b16 v[22:23], v14 offset:544
    ds_read_b64_tr_b16 v[24:25], v14 offset:64
    ds_read_b64_tr_b16 v[26:27], v14 offset:576
    ds_read_b64_tr_b16 v[28:29], v14 offset:96
    ds_read_b64_tr_b16 v[30:31], v14 offset:608
    s_waitcnt lgkmcnt(0)
    v_mfma_f32_16x16x32_bf16 v[40:43], v[32:35], v[16:19], 0
    v_mfma_f32_16x16x32_bf16 v[44:47], v[32:35], v[20:23], 0
    v_mfma_f32_16x16x32_bf16 v[48:51], v[32:35], v[24:27], 0
    v_mfma_f32_16x16x32_bf16 v[52:55], v[32:35], v[28:31], 0
    s_lshl_b32 s30, s35, 2
    s_add_u32 s30, s30, 0
    s_mul_i32 s31, s30, 9363
    s_lshr_b32 s31, s31, 16
    s_mul_i32 s31, s31, 111104
    s_lshl_b32 s30, s30, 9
    s_add_u32 s31, s31, s30
    s_add_u32 s31, s31, s78
    s_add_u32 s31, s31, 3407872
    buffer_store_dwordx4 v[16:19], v15, s[4:7], s31 offen
    s_lshl_b32 s30, s35, 2
    s_add_u32 s30, s30, 1
    s_mul_i32 s31, s30, 9363
    s_lshr_b32 s31, s31, 16
    s_mul_i32 s31, s31, 111104
    s_lshl_b32 s30, s30, 9
    s_add_u32 s31, s31, s30
    s_add_u32 s31, s31, s78
    s_add_u32 s31, s31, 3407872
    buffer_store_dwordx4 v[20:23], v15, s[4:7], s31 offen
    s_lshl_b32 s30, s35, 2
    s_add_u32 s30, s30, 2
    s_mul_i32 s31, s30, 9363
    s_lshr_b32 s31, s31, 16
    s_mul_i32 s31, s31, 111104
    s_lshl_b32 s30, s30, 9
    s_add_u32 s31, s31, s30
    s_add_u32 s31, s31, s78
    s_add_u32 s31, s31, 3407872
    buffer_store_dwordx4 v[24:27], v15, s[4:7], s31 offen
    s_lshl_b32 s30, s35, 2
    s_add_u32 s30, s30, 3
    s_mul_i32 s31, s30, 9363
    s_lshr_b32 s31, s31, 16
    s_mul_i32 s31, s31, 111104
    s_lshl_b32 s30, s30, 9
    s_add_u32 s31, s31, s30
    s_add_u32 s31, s31, s78
    s_add_u32 s31, s31, 3407872
    buffer_store_dwordx4 v[28:31], v15, s[4:7], s31 offen
    s_lshl_b32 s30, s35, 8
    s_add_u32 s31, s30, s78
    s_add_u32 s31, s31, 5242880
    s_mov_b64 exec, 0xffff0000
    v_mov_b32 v40, v44
    s_mov_b32 exec_lo, 0
    s_mov_b32 exec_hi, 0xffff
    v_mov_b32 v40, v48
    s_mov_b32 exec_hi, 0xffff0000
    v_mov_b32 v40, v52
    s_mov_b64 exec, -1
    buffer_store_dword v40, v10, s[4:7], s31 offen
P_done:
P_end:
    s_endpgm
.globl main_kernel
.p2align 8
.type main_kernel,@function
main_kernel:
    s_load_dwordx2 s[96:97], s[0:1], 64
    s_load_dwordx2 s[70:71], s[0:1], 48
    s_cmp_ge_u32 s2, 256
    s_cbranch_scc1 M_end
    v_lshrrev_b32 v1, 6, v0
    s_nop 0
    v_readfirstlane_b32 s20, v1
    v_and_b32 v0, 63, v0
    s_and_b32 s30, s2, 7
    s_lshr_b32 s31, s2, 3
    s_and_b32 s22, s31, 15
    s_lshr_b32 s31, s31, 4
    s_lshl_b32 s21, s30, 1
    s_add_u32 s21, s21, s31
    s_lshr_b32 s23, s22, 3
    s_and_b32 s24, s22, 7
    s_lshl_b32 s28, s21, 2
    s_lshl_b32 s29, s23, 1
    s_add_u32 s29, s29, s28
    s_add_u32 s28, s28, s20
    s_mov_b32 s63, 32768
    s_mov_b32 s25, 0
    s_lshl_b32 s27, s21, 11
    s_mov_b32 s39, 0
    s_mov_b32 s26, 8388608
    v_lshlrev_b32 v1, 4, v0
    v_lshlrev_b32 v10, 2, v0
    v_mov_b32 v9, 0
    v_mov_b32 v11, 1
    s_getreg_b32 s30, hwreg(HW_REG_XCC_ID)
    s_and_b32 s35, s30, 15
    s_add_u32 s35, s35, 1
    v_mov_b32 v54, s35
    s_lshl_b32 s33, s21, 7
    s_add_u32 s33, s33, 163840
    s_lshl_b32 s31, s22, 2
    s_add_u32 s34, s33, s31
    v_and_b32 v50, 7, v0
    v_lshrrev_b32 v51, 3, v0
    s_lshl_b32 s30, s20, 3
    v_add_u32 v52, s30, v50
    v_lshlrev_b32 v4, 10, v52
    v_lshl_add_u32 v4, v51, 4, v4
    s_lshl_b32 s30, s29, 15
    s_lshl_b32 s31, s24, 7
    s_add_u32 s30, s30, s31
    v_add_u32 v4, s30, v4
    v_lshrrev_b32 v53, 1, v51
    v_lshlrev_b32 v5, 10, v53
    v_and_b32 v53, 1, v51
    v_lshl_add_u32 v53, v53, 5, v52
    v_lshl_add_u32 v5, v53, 4, v5
    s_lshl_b32 s30, s29, 15
    s_lshl_b32 s31, s24, 12
    s_add_u32 s30, s30, s31
    s_add_u32 s30, s30, 16777216
    v_add_u32 v5, s30, v5
    v_bfe_u32 v53, v0, 4, 1
    v_lshlrev_b32 v53, 2, v53
    v_lshl_add_u32 v7, v52, 3, v53
    s_lshl_b32 s30, s29, 11
    s_lshl_b32 s31, s24, 8
    s_add_u32 s30, s30, s31
    s_add_u32 s30, s30, 18874368
    v_add_u32 v7, s30, v7
    s_waitcnt lgkmcnt(0)
    s_mov_b32 s4, s96
    s_mov_b32 s5, s97
    s_mov_b32 s6, 0x10000000
    s_mov_b32 s7, 0x00020000
    s_cmp_lg_u32 s20, 3
    s_cbranch_scc1 C_1
    s_mov_b64 exec, 1
    buffer_store_dword v54, v9, s[4:7], s34 offen sc1
    s_mov_b64 exec, -1
C_1:
    v_mul_u32_u24 v13, 272, v52
    v_lshl_add_u32 v13, v51, 5, v13
    v_and_b32 v184, 31, v0
    v_lshrrev_b32 v185, 5, v0
    v_lshlrev_b32 v186, 2, v184
    s_xor_b32 s30, s24, 0
    s_lshl_b32 s40, s30, 12
    s_lshl_b32 s48, s30, 11
    s_xor_b32 s30, s24, 1
    s_lshl_b32 s41, s30, 12
    s_lshl_b32 s49, s30, 11
    s_xor_b32 s30, s24, 2
    s_lshl_b32 s42, s30, 12
    s_lshl_b32 s50, s30, 11
    s_xor_b32 s30, s24, 3
    s_lshl_b32 s43, s30, 12
    s_lshl_b32 s51, s30, 11
    s_xor_b32 s30, s24, 4
    s_lshl_b32 s44, s30, 12
    s_lshl_b32 s52, s30, 11
    s_xor_b32 s30, s24, 5
    s_lshl_b32 s45, s30, 12
    s_lshl_b32 s53, s30, 11
    s_xor_b32 s30, s24, 6
    s_lshl_b32 s46, s30, 12
    s_lshl_b32 s54, s30, 11
    s_xor_b32 s30, s24, 7
    s_lshl_b32 s47, s30, 12
    s_lshl_b32 s55, s30, 11
    s_lshl_b32 s100, s20, 10
    s_mul_i32 s101, s22, 98304
    s_add_u32 s101, s101, 6291456
    s_lshl_b32 s31, s28, 15
    s_add_u32 s30, s31, 16777216
    v_add_u32 v15, s30, v1
    s_mul_i32 s12, s40, 3
    s_add_u32 s12, s12, s100
    s_add_u32 m0, s12, 4096
    s_add_u32 s30, m0, s101
    buffer_load_dwordx4 v1, s[4:7], s30 offen lds
    s_add_u32 m0, s12, 8192
    s_add_u32 s30, m0, s101
    buffer_load_dwordx4 v1, s[4:7], s30 offen lds
    s_mul_i32 s12, s41, 3
    s_add_u32 s12, s12, s100
    s_add_u32 m0, s12, 4096
    s_add_u32 s30, m0, s101
    buffer_load_dwordx4 v1, s[4:7], s30 offen lds
    s_add_u32 m0, s12, 8192
    s_add_u32 s30, m0, s101
    buffer_load_dwordx4 v1, s[4:7], s30 offen lds
    buffer_load_dwordx4 v[48:51], v15, s[4:7], s40 offen offset:0 sc1
    buffer_load_dwordx4 v[52:55], v15, s[4:7], s40 offen offset:1024 sc1
    buffer_load_dwordx4 v[56:59], v15, s[4:7], s40 offen offset:2048 sc1
    buffer_load_dwordx4 v[60:63], v15, s[4:7], s40 offen offset:3072 sc1
    s_mul_i32 s12, s42, 3
    s_add_u32 s12, s12, s100
    s_add_u32 m0, s12, 4096
    s_add_u32 s30, m0, s101
    buffer_load_dwordx4 v1, s[4:7], s30 offen lds
    s_add_u32 m0, s12, 8192
    s_add_u32 s30, m0, s101
    buffer_load_dwordx4 v1, s[4:7], s30 offen lds
    s_mov_b32 s16, s70
    s_mov_b32 s17, s71
    s_mov_b32 s18, 0x200000
    s_mov_b32 s19, 0x00020000
    s_lshl_b32 s30, s23, 8
    s_lshl_b32 s31, s24, 4
    s_add_u32 s30, s30, s31
    s_add_u32 s30, s30, s27
    s_lshl_b32 s31, s20, 2
    s_add_u32 s0, s30, s31
    s_lshl_b32 s30, s20, 6
    s_lshl_b32 s31, s22, 2
    s_add_u32 s30, s30, s31
    s_add_u32 s38, s30, s27
    v_lshlrev_b32 v8, 10, v185
    v_lshl_add_u32 v8, v184, 3, v8
    s_lshl_b32 s30, s28, 11
    s_add_u32 s30, s30, 18874368
    v_add_u32 v8, s30, v8
    s_lshl_b32 s30, s20, 7
    s_add_u32 s30, s30, 159744
    v_lshl_add_u32 v14, v185, 4, s30
    v_mul_u32_u24 v12, 272, v184
    v_lshl_add_u32 v12, v185, 4, v12
    s_mul_i32 s30, s20, 8704
    s_add_u32 s30, s30, 124928
    v_add_u32 v12, s30, v12
    v_add_u32 v13, 124928, v13
    v_lshlrev_b32 v43, 9, v185
    v_bfe_u32 v177, v0, 4, 1
    v_lshlrev_b32 v6, 9, v177
    v_lshl_add_u32 v6, v185, 8, v6
    v_and_b32 v177, 15, v0
    v_lshl_add_u32 v6, v177, 4, v6
    s_mul_i32 s30, s20, 4160
    s_add_u32 s30, s30, 98304
    v_add_u32 v40, s30, v1
    v_add_u32 v41, 2048, v40
    v_add_u32 v42, 2304, v40
    s_add_u32 s31, s30, 3072
    v_mov_b32 v179, s31
    v_and_b32 v177, 16, v0
    v_cmp_eq_u32 vcc, 0, v177
    s_nop 1
    v_cndmask_b32 v41, v179, v41, vcc
    v_cndmask_b32 v42, v179, v42, vcc
    buffer_load_dwordx4 v[64:67], v15, s[4:7], s41 offen offset:0 sc1
    buffer_load_dwordx4 v[68:71], v15, s[4:7], s41 offen offset:1024 sc1
    buffer_load_dwordx4 v[72:75], v15, s[4:7], s41 offen offset:2048 sc1
    buffer_load_dwordx4 v[76:79], v15, s[4:7], s41 offen offset:3072 sc1
    buffer_load_dwordx2 v[240:241], v8, s[4:7], 0 offen offset:0 sc1
    buffer_load_dwordx2 v[242:243], v8, s[4:7], 0 offen offset:256 sc1
    buffer_load_dwordx2 v[244:245], v8, s[4:7], 0 offen offset:512 sc1
    buffer_load_dwordx2 v[246:247], v8, s[4:7], 0 offen offset:768 sc1
    s_add_u32 s30, s24, 0
    s_and_b32 s30, s30, 3
    s_mul_i32 s56, s30, 7168
    s_add_u32 s30, s24, 1
    s_and_b32 s30, s30, 3
    s_mul_i32 s57, s30, 7168
    s_add_u32 s30, s24, 2
    s_and_b32 s30, s30, 3
    s_mul_i32 s58, s30, 7168
    s_add_u32 s30, s24, 3
    s_and_b32 s30, s30, 3
    s_mul_i32 s59, s30, 7168
    s_mul_i32 s13, s24, 229376
    s_mul_i32 s30, s20, 57344
    s_add_u32 s13, s13, s30
    s_add_u32 s13, s13, 1572864
    s_lshl_b32 s8, s56, 1
    s_add_u32 s8, s8, s13
    s_lshl_b32 s9, s57, 1
    s_add_u32 s9, s9, s13
    s_lshl_b32 s10, s58, 1
    s_add_u32 s10, s10, s13
    s_lshl_b32 s11, s59, 1
    s_add_u32 s11, s11, s13
    v_lshlrev_b32 v177, 2, v185
    v_sub_u32 v177, v184, v177
    v_cmp_le_i32 s[64:65], 0, v177
    v_cmp_le_i32 s[66:67], 1, v177
    v_cmp_le_i32 s[68:69], 2, v177
    v_cmp_le_i32 s[70:71], 3, v177
    v_cmp_le_i32 s[72:73], 8, v177
    v_cmp_le_i32 s[74:75], 9, v177
    v_cmp_le_i32 s[76:77], 10, v177
    v_cmp_le_i32 s[78:79], 11, v177
    v_cmp_le_i32 s[80:81], 16, v177
    v_cmp_le_i32 s[82:83], 17, v177
    v_cmp_le_i32 s[84:85], 18, v177
    v_cmp_le_i32 s[86:87], 19, v177
    v_cmp_le_i32 s[88:89], 24, v177
    v_cmp_le_i32 s[90:91], 25, v177
    v_cmp_le_i32 s[92:93], 26, v177
    v_cmp_le_i32 s[94:95], 27, v177
    v_mov_b32 v178, 0xffff
    v_mov_b32 v179, 0xffff0000
    v_cndmask_b32 v176, 0, v178, s[64:65]
    v_cndmask_b32 v32, 0, v179, s[66:67]
    v_or_b32 v32, v176, v32
    v_cndmask_b32 v176, 0, v178, s[68:69]
    v_cndmask_b32 v33, 0, v179, s[70:71]
    v_or_b32 v33, v176, v33
    v_cndmask_b32 v176, 0, v178, s[72:73]
    v_cndmask_b32 v34, 0, v179, s[74:75]
    v_or_b32 v34, v176, v34
    v_cndmask_b32 v176, 0, v178, s[76:77]
    v_cndmask_b32 v35, 0, v179, s[78:79]
    v_or_b32 v35, v176, v35
    v_cndmask_b32 v176, 0, v178, s[80:81]
    v_cndmask_b32 v36, 0, v179, s[82:83]
    v_or_b32 v36, v176, v36
    v_cndmask_b32 v176, 0, v178, s[84:85]
    v_cndmask_b32 v37, 0, v179, s[86:87]
    v_or_b32 v37, v176, v37
    v_cndmask_b32 v176, 0, v178, s[88:89]
    v_cndmask_b32 v38, 0, v179, s[90:91]
    v_or_b32 v38, v176, v38
    v_cndmask_b32 v176, 0, v178, s[92:93]
    v_cndmask_b32 v39, 0, v179, s[94:95]
    v_or_b32 v39, v176, v39
    s_mul_i32 s12, s43, 3
    s_add_u32 s12, s12, s100
    s_add_u32 m0, s12, 4096
    s_add_u32 s30, m0, s101
    buffer_load_dwordx4 v1, s[4:7], s30 offen lds
    s_add_u32 m0, s12, 8192
    s_add_u32 s30, m0, s101
    buffer_load_dwordx4 v1, s[4:7], s30 offen lds
    v_mul_u32_u24 v254, 49152, v185
    v_add_u32 v254, v254, v186
    v_mul_u32_u24 v255, 57344, v185
    v_add_u32 v255, v255, v186
    s_min_u32 s32, s20, 2
    s_lshl_b32 s30, s32, 11
    s_lshl_b32 s31, s22, 7
    s_add_u32 s30, s30, s31
    s_add_u32 s14, s30, 5373952
    s_mul_i32 s31, s22, 448
    s_lshl_b32 s37, s20, 7
    s_add_u32 s31, s31, s37
    s_add_u32 s15, s31, 5242880
    buffer_load_dwordx4 v[80:83], v15, s[4:7], s42 offen offset:0 sc1
    buffer_load_dwordx4 v[84:87], v15, s[4:7], s42 offen offset:1024 sc1
    v_lshlrev_b32 v186, 1, v186
    s_lshl_b32 s30, s32, 8
    s_add_u32 s30, s30, 160256
    v_add_u32 v2, s30, v186
    s_lshl_b32 s30, s20, 8
    s_add_u32 s30, s30, 161024
    v_add_u32 v3, s30, v186
    s_lshl_b32 s30, s20, 2
    s_lshl_b32 s36, 0x000f000f, s30
    s_mov_b32 s37, 0
    s_lshl_b32 s30, s23, 5
    s_lshl_b64 s[36:37], s[36:37], s30
    s_lshl_b32 s30, s23, 5
    s_lshl_b32 s31, s20, 3
    s_add_u32 s30, s30, s31
    s_mov_b32 s60, 0xff
    s_mov_b32 s61, 0
    s_lshl_b64 s[60:61], s[60:61], s30
    s_lshl_b32 s30, s20, 7
    s_add_u32 s34, s27, s30
    s_mov_b32 s1, s33
    s_mov_b32 s3, s35
    v_accvgpr_write_b32 a238, 0
    v_accvgpr_write_b32 a239, 0
    v_lshrrev_b32 v176, 1, v0
    v_mul_u32_u24 v177, 4160, v176
    v_and_b32 v178, 1, v0
    v_mul_u32_u24 v178, 1056, v178
    v_add_u32 v177, v177, v178
    v_add_u32 v177, 101376, v177
    s_lshl_b32 s30, s21, 2
    v_add_u32 v176, s30, v176
    v_mov_b32 v178, 0x3f803f80
    v_cmp_le_u32 vcc, 8, v176
    s_nop 1
    v_cndmask_b32 v180, 0, v178, vcc
    v_mov_b32 v181, v180
    v_mov_b32 v182, v180
    v_mov_b32 v183, v180
    s_lshl_b32 s30, s22, 18
    s_lshl_b32 s31, s28, 12
    s_add_u32 s30, s30, s31
    s_add_u32 s96, s30, s26
    s_lshl_b32 s31, s22, 7
    s_add_u32 s30, s27, s31
    s_add_u32 s35, s30, 98304
    s_mov_b64 exec, 0xffffff
    ds_write_b128 v177, v[180:183]
    s_mov_b64 exec, -1
    v_mad_u32_u24 v46, s40, 3, v1
    s_waitcnt vmcnt(20) lgkmcnt(0)
    s_barrier
    ds_read_b128 v[160:163], v46 offset:4096
    ds_read_b128 v[164:167], v46 offset:8192
    ds_read_b128 v[168:171], v46 offset:5120
    ds_read_b128 v[172:175], v46 offset:9216
    ds_read_b128 v[176:179], v46 offset:6144
    ds_read_b128 v[180:183], v46 offset:10240
    s_waitcnt vmcnt(17) lgkmcnt(4)
    v_mfma_f32_32x32x16_bf16 v[208:223], v[160:163], v[48:51], 0
    ds_read_b128 v[184:187], v46 offset:7168
    buffer_load_dwordx4 v[88:91], v15, s[4:7], s42 offen offset:2048 sc1
    v_mfma_f32_32x32x16_bf16 v[224:239], v[48:51], v[164:167], 0
    ds_read_b128 v[188:191], v46 offset:11264
    buffer_load_dword v192, v254, s[4:7], s14 offen
    buffer_load_dword v200, v255, s[4:7], s15 offen
    s_add_u32 s14, s14, 6144
    s_add_u32 s15, s15, 7168
    s_waitcnt vmcnt(19) lgkmcnt(4)
    v_mfma_f32_32x32x16_bf16 v[208:223], v[168:171], v[52:55], v[208:223]
    v_mad_u32_u24 v47, s41, 3, v1
    s_barrier
    s_mul_i32 s12, s44, 3
    s_add_u32 s12, s12, s100
    s_add_u32 m0, s12, 4096
    s_add_u32 s30, m0, s101
    buffer_load_dwordx4 v1, s[4:7], s30 offen lds
    s_add_u32 m0, s12, 8192
    s_add_u32 s30, m0, s101
    buffer_load_dwordx4 v1, s[4:7], s30 offen lds
    ds_read_b128 v[160:163], v47 offset:4096
    buffer_load_dwordx4 v[92:95], v15, s[4:7], s42 offen offset:3072 sc1
    v_mfma_f32_32x32x16_bf16 v[224:239], v[52:55], v[172:175], v[224:239]
    ds_read_b128 v[164:167], v47 offset:8192
    buffer_load_dword v193, v254, s[4:7], s14 offen
    buffer_load_dword v201, v255, s[4:7], s15 offen
    s_add_u32 s14, s14, 6144
    s_add_u32 s15, s15, 7168
    s_waitcnt vmcnt(23) lgkmcnt(4)
    v_mfma_f32_32x32x16_bf16 v[208:223], v[176:179], v[56:59], v[208:223]
    ds_read_b128 v[168:171], v47 offset:5120
    buffer_load_dwordx4 v[96:99], v15, s[4:7], s43 offen offset:0 sc1
    v_mfma_f32_32x32x16_bf16 v[224:239], v[56:59], v[180:183], v[224:239]
    ds_read_b128 v[172:175], v47 offset:9216
    buffer_load_dword v194, v254, s[4:7], s14 offen
    buffer_load_dword v202, v255, s[4:7], s15 offen
    s_add_u32 s14, s14, 6144
    s_add_u32 s15, s15, 7168
    s_waitcnt vmcnt(25) lgkmcnt(4)
    v_mfma_f32_32x32x16_bf16 v[208:223], v[184:187], v[60:63], v[208:223]
    ds_read_b128 v[176:179], v47 offset:6144
    buffer_load_dwordx4 v[100:103], v15, s[4:7], s43 offen offset:1024 sc1
    v_mfma_f32_32x32x16_bf16 v[224:239], v[60:63], v[188:191], v[224:239]
    ds_read_b128 v[180:183], v47 offset:10240
    buffer_load_dword v195, v254, s[4:7], s14 offen
    buffer_load_dword v203, v255, s[4:7], s15 offen
    s_add_u32 s14, s14, 6144
    s_add_u32 s15, s15, 7168
    s_waitcnt vmcnt(25) lgkmcnt(4)
    v_mfma_f32_32x32x16_bf16 v[208:223], v[160:163], v[64:67], v[208:223]
    ds_read_b128 v[184:187], v47 offset:7168
    buffer_load_dwordx4 v[104:107], v15, s[4:7], s43 offen offset:2048 sc1
    v_mfma_f32_32x32x16_bf16 v[224:239], v[64:67], v[164:167], v[224:239]
    ds_read_b128 v[188:191], v47 offset:11264
    buffer_load_dword v196, v254, s[4:7], s14 offen
    buffer_load_dword v204, v255, s[4:7], s15 offen
    s_add_u32 s14, s14, 6144
    s_add_u32 s15, s15, 7168
    s_waitcnt vmcnt(21)
    v_add_f32 v240, v240, v242
    s_waitcnt lgkmcnt(4)
    v_mfma_f32_32x32x16_bf16 v[208:223], v[168:171], v[68:71], v[208:223]
    v_mad_u32_u24 v46, s42, 3, v1
    s_barrier
    s_mul_i32 s12, s45, 3
    s_add_u32 s12, s12, s100
    s_add_u32 m0, s12, 4096
    s_add_u32 s30, m0, s101
    buffer_load_dwordx4 v1, s[4:7], s30 offen lds
    s_add_u32 m0, s12, 8192
    s_add_u32 s30, m0, s101
    buffer_load_dwordx4 v1, s[4:7], s30 offen lds
    ds_read_b128 v[160:163], v46 offset:4096
    buffer_load_dwordx4 v[108:111], v15, s[4:7], s43 offen offset:3072 sc1
    v_mfma_f32_32x32x16_bf16 v[224:239], v[68:71], v[172:175], v[224:239]
    ds_read_b128 v[164:167], v46 offset:8192
    buffer_load_dword v197, v254, s[4:7], s14 offen
    buffer_load_dword v205, v255, s[4:7], s15 offen
    s_add_u32 s14, s14, 6144
    s_add_u32 s15, s15, 7168
    v_add_f32 v244, v244, v246
    v_add_f32 v241, v241, v243
    s_waitcnt lgkmcnt(4)
    v_mfma_f32_32x32x16_bf16 v[208:223], v[176:179], v[72:75], v[208:223]
    ds_read_b128 v[168:171], v46 offset:5120
    buffer_load_dwordx4 v[112:115], v15, s[4:7], s44 offen offset:0 sc1
    v_mfma_f32_32x32x16_bf16 v[224:239], v[72:75], v[180:183], v[224:239]
    ds_read_b128 v[172:175], v46 offset:9216
    buffer_load_dword v198, v254, s[4:7], s14 offen
    buffer_load_dword v206, v255, s[4:7], s15 offen
    s_add_u32 s14, s14, 6144
    s_add_u32 s15, s15, 7168
    v_add_f32 v245, v245, v247
    v_add_f32 v240, v240, v244
    s_waitcnt lgkmcnt(4)
    v_mfma_f32_32x32x16_bf16 v[208:223], v[184:187], v[76:79], v[208:223]
    ds_read_b128 v[176:179], v46 offset:6144
    buffer_load_dwordx4 v[116:119], v15, s[4:7], s44 offen offset:1024 sc1
    v_mfma_f32_32x32x16_bf16 v[224:239], v[76:79], v[188:191], v[224:239]
    ds_read_b128 v[180:183], v46 offset:10240
    buffer_load_dword v199, v254, s[4:7], s14 offen
    buffer_load_dword v207, v255, s[4:7], s15 offen
    s_add_u32 s14, s14, 6144
    s_add_u32 s15, s15, 7168
    v_add_f32 v241, v241, v245
    v_mov_b32 v242, v240
    s_waitcnt vmcnt(29) lgkmcnt(4)
    v_mfma_f32_32x32x16_bf16 v[208:223], v[160:163], v[80:83], v[208:223]
    ds_read_b128 v[184:187], v46 offset:7168
    buffer_load_dwordx4 v[120:123], v15, s[4:7], s44 offen offset:2048 sc1
    v_mfma_f32_32x32x16_bf16 v[224:239], v[80:83], v[164:167], v[224:239]
    ds_read_b128 v[188:191], v46 offset:11264
    v_mov_b32 v243, v241
    v_mov_b32 v250, 0
    s_waitcnt vmcnt(29) lgkmcnt(4)
    v_mfma_f32_32x32x16_bf16 v[208:223], v[168:171], v[84:87], v[208:223]
    v_mad_u32_u24 v47, s43, 3, v1
    s_barrier
    s_mul_i32 s12, s46, 3
    s_add_u32 s12, s12, s100
    s_add_u32 m0, s12, 4096
    s_add_u32 s30, m0, s101
    buffer_load_dwordx4 v1, s[4:7], s30 offen lds
    s_add_u32 m0, s12, 8192
    s_add_u32 s30, m0, s101
    buffer_load_dwordx4 v1, s[4:7], s30 offen lds
    ds_read_b128 v[160:163], v47 offset:4096
    buffer_load_dwordx4 v[124:127], v15, s[4:7], s44 offen offset:3072 sc1
    v_mfma_f32_32x32x16_bf16 v[224:239], v[84:87], v[172:175], v[224:239]
    ds_read_b128 v[164:167], v47 offset:8192
    v_permlane32_swap_b32 v240, v242
    v_permlane32_swap_b32 v241, v243
    s_waitcnt vmcnt(31) lgkmcnt(4)
    v_mfma_f32_32x32x16_bf16 v[208:223], v[176:179], v[88:91], v[208:223]
    ds_read_b128 v[168:171], v47 offset:5120
    buffer_load_dwordx4 v[128:131], v15, s[4:7], s45 offen offset:0 sc1
    v_mfma_f32_32x32x16_bf16 v[224:239], v[88:91], v[180:183], v[224:239]
    ds_read_b128 v[172:175], v47 offset:9216
    v_add_f32 v240, v240, v242
    v_add_f32 v241, v241, v243
    s_waitcnt vmcnt(27) lgkmcnt(4)
    v_mfma_f32_32x32x16_bf16 v[208:223], v[184:187], v[92:95], v[208:223]
    ds_read_b128 v[176:179], v47 offset:6144
    buffer_load_dwordx4 v[132:135], v15, s[4:7], s45 offen offset:1024 sc1
    v_mfma_f32_32x32x16_bf16 v[224:239], v[92:95], v[188:191], v[224:239]
    ds_read_b128 v[180:183], v47 offset:10240
    v_mul_f32 v240, 0xbb000000, v240
    v_mul_f32 v241, 0x3b000000, v241
    s_waitcnt vmcnt(25) lgkmcnt(4)
    v_mfma_f32_32x32x16_bf16 v[208:223], v[160:163], v[96:99], v[208:223]
    ds_read_b128 v[184:187], v47 offset:7168
    buffer_load_dwordx4 v[136:139], v15, s[4:7], s45 offen offset:2048 sc1
    v_mfma_f32_32x32x16_bf16 v[224:239], v[96:99], v[164:167], v[224:239]
    ds_read_b128 v[188:191], v47 offset:11264
    v_fma_f32 v241, -v240, v240, v241
    v_max_f32 v241, 0, v241
    s_waitcnt vmcnt(23) lgkmcnt(4)
    v_mfma_f32_32x32x16_bf16 v[208:223], v[168:171], v[100:103], v[208:223]
    v_mad_u32_u24 v46, s44, 3, v1
    s_barrier
    s_mul_i32 s12, s47, 3
    s_add_u32 s12, s12, s100
    s_add_u32 m0, s12, 4096
    s_add_u32 s30, m0, s101
    buffer_load_dwordx4 v1, s[4:7], s30 offen lds
    s_add_u32 m0, s12, 8192
    s_add_u32 s30, m0, s101
    buffer_load_dwordx4 v1, s[4:7], s30 offen lds
    ds_read_b128 v[160:163], v46 offset:4096
    buffer_load_dwordx4 v[140:143], v15, s[4:7], s45 offen offset:3072 sc1
    v_mfma_f32_32x32x16_bf16 v[224:239], v[100:103], v[172:175], v[224:239]
    ds_read_b128 v[164:167], v46 offset:8192
    s_waitcnt vmcnt(10)
    v_add_f32 v192, v192, v193
    v_add_f32 v192, v192, v194
    v_add_f32 v192, v192, v195
    v_add_f32 v192, v192, v196
    v_add_f32 v241, 0x3727c5ac, v241
    v_rsq_f32 v252, v241
    s_waitcnt lgkmcnt(4)
    v_mfma_f32_32x32x16_bf16 v[208:223], v[176:179], v[104:107], v[208:223]
    ds_read_b128 v[168:171], v46 offset:5120
    buffer_load_dwordx4 v[144:147], v15, s[4:7], s46 offen offset:0 sc1
    v_mfma_f32_32x32x16_bf16 v[224:239], v[104:107], v[180:183], v[224:239]
    ds_read_b128 v[172:175], v46 offset:9216
    v_add_f32 v192, v192, v197
    v_add_f32 v192, v192, v198
    v_add_f32 v192, v192, v199
    v_mov_b32 v193, v192
    s_nop 0
    v_cvt_pk_bf16_f32 v242, v240, v240
    v_and_b32 v243, 0xffff0000, v242
    s_waitcnt lgkmcnt(4)
    v_mfma_f32_32x32x16_bf16 v[208:223], v[184:187], v[108:111], v[208:223]
    ds_read_b128 v[176:179], v46 offset:6144
    buffer_load_dwordx4 v[148:151], v15, s[4:7], s46 offen offset:1024 sc1
    v_mfma_f32_32x32x16_bf16 v[224:239], v[108:111], v[188:191], v[224:239]
    ds_read_b128 v[180:183], v46 offset:10240
    v_permlane32_swap_b32 v192, v193
    v_add_f32 v193, v192, v193
    v_cvt_pk_bf16_f32 v194, v193, v193
    v_and_b32 v195, 0xffff0000, v194
    v_sub_f32 v195, v193, v195
    v_sub_f32 v243, v240, v243
    v_lshrrev_b32 v249, 5, v0
    s_waitcnt lgkmcnt(4)
    v_mfma_f32_32x32x16_bf16 v[208:223], v[160:163], v[112:115], v[208:223]
    ds_read_b128 v[184:187], v46 offset:7168
    buffer_load_dwordx4 v[152:155], v15, s[4:7], s46 offen offset:2048 sc1
    v_mfma_f32_32x32x16_bf16 v[224:239], v[112:115], v[164:167], v[224:239]
    ds_read_b128 v[188:191], v46 offset:11264
    v_cvt_pk_bf16_f32 v195, v195, v195
    v_add_f32 v200, v200, v201
    v_add_f32 v200, v200, v202
    v_add_f32 v200, v200, v203
    v_add_f32 v200, v200, v204
    v_add_u32 v249, -1, v249
    v_cvt_pk_bf16_f32 v242, v240, v243
    s_waitcnt lgkmcnt(4)
    v_mfma_f32_32x32x16_bf16 v[208:223], v[168:171], v[116:119], v[208:223]
    v_mad_u32_u24 v47, s45, 3, v1
    s_barrier
    s_mul_i32 s12, s40, 3
    s_add_u32 s12, s12, s100
    s_add_u32 m0, s12, 0
    s_add_u32 s30, m0, s101
    buffer_load_dwordx4 v1, s[4:7], s30 offen lds
    s_mul_i32 s12, s41, 3
    s_add_u32 s12, s12, s100
    s_add_u32 m0, s12, 0
    s_add_u32 s30, m0, s101
    buffer_load_dwordx4 v1, s[4:7], s30 offen lds
    ds_read_b128 v[160:163], v47 offset:4096
    buffer_load_dwordx4 v[156:159], v15, s[4:7], s46 offen offset:3072 sc1
    v_mfma_f32_32x32x16_bf16 v[224:239], v[116:119], v[172:175], v[224:239]
    ds_read_b128 v[164:167], v47 offset:8192
    v_add_f32 v200, v200, v205
    v_add_f32 v200, v200, v206
    v_add_f32 v200, v200, v207
    v_mov_b32 v201, v200
    s_nop 0
    v_mov_b32 v251, 0
    v_mov_b32 v253, v252
    s_waitcnt vmcnt(15) lgkmcnt(4)
    v_mfma_f32_32x32x16_bf16 v[208:223], v[176:179], v[120:123], v[208:223]
    ds_read_b128 v[168:171], v47 offset:5120
    buffer_load_dwordx4 a[240:243], v15, s[4:7], s47 offen offset:0 sc1
    v_mfma_f32_32x32x16_bf16 v[224:239], v[120:123], v[180:183], v[224:239]
    ds_read_b128 v[172:175], v47 offset:9216
    v_permlane32_swap_b32 v200, v201
    v_add_f32 v201, v200, v201
    s_cmp_eq_u32 s20, 3
    s_cselect_b32 s30, 16, 0
    v_and_b32 v200, s30, v0
    v_cmp_eq_u32 vcc, 0, v200
    s_nop 1
    v_cndmask_b32 v201, 0, v201, vcc
    v_cvt_pk_bf16_f32 v202, v201, v201
    v_and_b32 v203, 0xffff0000, v202
    v_and_b32 v248, v249, v242
    v_mov_b32 v249, v248
    s_waitcnt vmcnt(13) lgkmcnt(4)
    v_mfma_f32_32x32x16_bf16 v[208:223], v[184:187], v[124:127], v[208:223]
    ds_read_b128 v[176:179], v47 offset:6144
    buffer_load_dwordx4 a[244:247], v15, s[4:7], s47 offen offset:1024 sc1
    v_mfma_f32_32x32x16_bf16 v[224:239], v[124:127], v[188:191], v[224:239]
    ds_read_b128 v[180:183], v47 offset:10240
    v_sub_f32 v203, v201, v203
    v_cvt_pk_bf16_f32 v203, v203, v203
    ds_write_b64 v2, v[194:195]
    ds_write_b64 v3, v[202:203]
    v_mul_f32 v254, 0x3eb8aa3b, v252
    v_mov_b32 v255, v254
    s_waitcnt vmcnt(13) lgkmcnt(6)
    v_mfma_f32_32x32x16_bf16 v[208:223], v[160:163], v[128:131], v[208:223]
    ds_read_b128 v[184:187], v47 offset:7168
    buffer_load_dwordx4 a[248:251], v15, s[4:7], s47 offen offset:2048 sc1
    v_mfma_f32_32x32x16_bf16 v[224:239], v[128:131], v[164:167], v[224:239]
    ds_read_b128 v[188:191], v47 offset:11264
    v_and_b32 v240, 124, v10
    s_lshl_b32 s30, s20, 7
    s_add_u32 s30, s30, 159744
    v_add_u32 v240, s30, v240
    ds_write_b32 v240, v252
    s_waitcnt vmcnt(13) lgkmcnt(7)
    v_mfma_f32_32x32x16_bf16 v[208:223], v[168:171], v[132:135], v[208:223]
    v_mad_u32_u24 v46, s46, 3, v1
    s_waitcnt lgkmcnt(3)
    s_barrier
    s_mul_i32 s12, s42, 3
    s_add_u32 s12, s12, s100
    s_add_u32 m0, s12, 0
    s_add_u32 s30, m0, s101
    buffer_load_dwordx4 v1, s[4:7], s30 offen lds
    s_mul_i32 s12, s43, 3
    s_add_u32 s12, s12, s100
    s_add_u32 m0, s12, 0
    s_add_u32 s30, m0, s101
    buffer_load_dwordx4 v1, s[4:7], s30 offen lds
    ds_read_b128 v[160:163], v46 offset:4096
    buffer_load_dwordx4 a[252:255], v15, s[4:7], s47 offen offset:3072 sc1
    v_mfma_f32_32x32x16_bf16 v[224:239], v[132:135], v[172:175], v[224:239]
    ds_read_b128 v[164:167], v46 offset:8192
    s_waitcnt vmcnt(15)
    v_mfma_f32_32x32x16_bf16 v[208:223], v[176:179], v[136:139], v[208:223]
    ds_read_b128 v[168:171], v46 offset:5120
    v_mfma_f32_32x32x16_bf16 v[224:239], v[136:139], v[180:183], v[224:239]
    ds_read_b128 v[172:175], v46 offset:9216
    ds_read_b128 v[240:243], v14 offset:0
    ds_read_b128 v[244:247], v14 offset:32
    ds_read_b128 v[192:195], v14 offset:64
    ds_read_b128 v[196:199], v14 offset:96
    s_waitcnt vmcnt(12) lgkmcnt(9)
    v_mfma_f32_32x32x16_bf16 v[208:223], v[184:187], v[140:143], v[208:223]
    ds_read_b128 v[176:179], v46 offset:6144
    v_mfma_f32_32x32x16_bf16 v[224:239], v[140:143], v[188:191], v[224:239]
    ds_read_b128 v[180:183], v46 offset:10240
    buffer_load_dwordx4 v[24:27], v5, s[4:7], 0 offen
    buffer_load_dwordx4 v[28:31], v5, s[4:7], s63 offen
    buffer_load_dword v2, v10, s[4:7], s1 offen sc1
    s_waitcnt vmcnt(14) lgkmcnt(8)
    v_mfma_f32_32x32x16_bf16 v[208:223], v[160:163], v[144:147], v[208:223]
    ds_read_b128 v[184:187], v46 offset:7168
    v_mfma_f32_32x32x16_bf16 v[224:239], v[144:147], v[164:167], v[224:239]
    ds_read_b128 v[188:191], v46 offset:11264
    s_waitcnt vmcnt(13) lgkmcnt(8)
    v_mfma_f32_32x32x16_bf16 v[208:223], v[168:171], v[148:151], v[208:223]
    v_mad_u32_u24 v47, s47, 3, v1
    s_barrier
    s_mul_i32 s12, s44, 3
    s_add_u32 s12, s12, s100
    s_add_u32 m0, s12, 0
    s_add_u32 s30, m0, s101
    buffer_load_dwordx4 v1, s[4:7], s30 offen lds
    s_mul_i32 s12, s45, 3
    s_add_u32 s12, s12, s100
    s_add_u32 m0, s12, 0
    s_add_u32 s30, m0, s101
    buffer_load_dwordx4 v1, s[4:7], s30 offen lds
    ds_read_b128 v[160:163], v47 offset:4096
    v_mfma_f32_32x32x16_bf16 v[224:239], v[148:151], v[172:175], v[224:239]
    ds_read_b128 v[164:167], v47 offset:8192
    v_and_b32 v200, 31, v0
    v_lshlrev_b32 v200, 3, v200
    v_add_u32 v200, 160256, v200
    ds_read_b64 a[224:225], v200 offset:0
    ds_read_b64 a[226:227], v200 offset:256
    ds_read_b64 a[228:229], v200 offset:512
    ds_read_b64 a[230:231], v200 offset:768
    ds_read_b64 a[232:233], v200 offset:1024
    ds_read_b64 a[234:235], v200 offset:1280
    ds_read_b64 a[236:237], v200 offset:1536
    s_waitcnt vmcnt(14) lgkmcnt(11)
    v_mfma_f32_32x32x16_bf16 v[208:223], v[176:179], v[152:155], v[208:223]
    ds_read_b128 v[168:171], v47 offset:5120
    v_mfma_f32_32x32x16_bf16 v[224:239], v[152:155], v[180:183], v[224:239]
    ds_read_b128 v[172:175], v47 offset:9216
    s_waitcnt vmcnt(11) lgkmcnt(11)
    v_mfma_f32_32x32x16_bf16 v[208:223], v[184:187], v[156:159], v[208:223]
    ds_read_b128 v[176:179], v47 offset:6144
    v_mfma_f32_32x32x16_bf16 v[224:239], v[156:159], v[188:191], v[224:239]
    ds_read_b128 v[180:183], v47 offset:10240
    s_waitcnt lgkmcnt(4)
    v_mfma_f32_32x32x16_bf16 v[208:223], a[226:229], v[248:251], v[208:223]
    v_mfma_f32_32x32x16_bf16 v[224:239], v[248:251], a[228:231], v[224:239]
    s_waitcnt vmcnt(10)
    v_mfma_f32_32x32x16_bf16 v[208:223], v[160:163], a[240:243], v[208:223]
    ds_read_b128 v[184:187], v47 offset:7168
    v_mfma_f32_32x32x16_bf16 v[224:239], a[240:243], v[164:167], v[224:239]
    ds_read_b128 v[188:191], v47 offset:11264
    s_mul_i32 s12, s46, 3
    s_add_u32 s12, s12, s100
    s_add_u32 m0, s12, 0
    s_add_u32 s30, m0, s101
    buffer_load_dwordx4 v1, s[4:7], s30 offen lds
    s_waitcnt vmcnt(10) lgkmcnt(4)
    v_mfma_f32_32x32x16_bf16 v[208:223], v[168:171], a[244:247], v[208:223]
    v_mfma_f32_32x32x16_bf16 v[224:239], a[244:247], v[172:175], v[224:239]
    v_mad_u32_u24 v46, s40, 3, v1
    s_waitcnt vmcnt(9) lgkmcnt(2)
    v_mfma_f32_32x32x16_bf16 v[208:223], v[176:179], a[248:251], v[208:223]
    v_mfma_f32_32x32x16_bf16 v[224:239], a[248:251], v[180:183], v[224:239]
    s_mul_i32 s12, s47, 3
    s_add_u32 s12, s12, s100
    s_add_u32 m0, s12, 0
    s_add_u32 s30, m0, s101
    buffer_load_dwordx4 v1, s[4:7], s30 offen lds
    s_waitcnt vmcnt(7) lgkmcnt(0)
    v_mfma_f32_32x32x16_bf16 v[208:223], v[184:187], a[252:255], v[208:223]
    v_mfma_f32_32x32x16_bf16 v[224:239], a[252:255], v[188:191], v[224:239]
    s_nop 10
    v_pk_mul_f32 v[208:209], v[252:253], v[208:209]
    v_pk_mul_f32 v[210:211], v[252:253], v[210:211]
    v_pk_mul_f32 v[212:213], v[252:253], v[212:213]
    v_pk_mul_f32 v[214:215], v[252:253], v[214:215]
    v_pk_mul_f32 v[216:217], v[252:253], v[216:217]
    v_pk_mul_f32 v[218:219], v[252:253], v[218:219]
    v_pk_mul_f32 v[220:221], v[252:253], v[220:221]
    v_pk_mul_f32 v[222:223], v[252:253], v[222:223]
    v_cvt_pk_bf16_f32 v208, v208, v209
    v_cvt_pk_bf16_f32 v209, v210, v211
    v_cvt_pk_bf16_f32 v210, v212, v213
    v_cvt_pk_bf16_f32 v211, v214, v215
    v_cvt_pk_bf16_f32 v212, v216, v217
    v_cvt_pk_bf16_f32 v213, v218, v219
    v_cvt_pk_bf16_f32 v214, v220, v221
    v_cvt_pk_bf16_f32 v215, v222, v223
    buffer_store_dwordx4 v[208:211], v1, s[4:7], s96 offen offset:0 sc1
    buffer_store_dwordx4 v[212:215], v1, s[4:7], s96 offen offset:1024 sc1
    v_pk_mul_f32 v[224:225], v[240:241], v[224:225]
    v_pk_mul_f32 v[226:227], v[242:243], v[226:227]
    v_pk_mul_f32 v[228:229], v[244:245], v[228:229]
    v_pk_mul_f32 v[230:231], v[246:247], v[230:231]
    v_pk_mul_f32 v[232:233], v[192:193], v[232:233]
    v_pk_mul_f32 v[234:235], v[194:195], v[234:235]
    v_pk_mul_f32 v[236:237], v[196:197], v[236:237]
    v_pk_mul_f32 v[238:239], v[198:199], v[238:239]
    v_cvt_pk_bf16_f32 v216, v224, v225
    v_cvt_pk_bf16_f32 v217, v226, v227
    v_cvt_pk_bf16_f32 v218, v228, v229
    v_cvt_pk_bf16_f32 v219, v230, v231
    v_cvt_pk_bf16_f32 v220, v232, v233
    v_cvt_pk_bf16_f32 v221, v234, v235
    v_cvt_pk_bf16_f32 v222, v236, v237
    v_cvt_pk_bf16_f32 v223, v238, v239
    buffer_store_dwordx4 v[216:219], v1, s[4:7], s96 offen offset:2048 sc1
    buffer_store_dwordx4 v[220:223], v1, s[4:7], s96 offen offset:3072 sc1
    s_waitcnt vmcnt(4)
    s_barrier
    ds_read_b128 v[160:163], v46 offset:0
    ds_read_b128 v[164:167], v46 offset:1024
    ds_read_b128 v[168:171], v46 offset:2048
    ds_read_b128 v[172:175], v46 offset:3072
    v_mad_u32_u24 v47, s41, 3, v1
    ds_read_b128 v[176:179], v47 offset:0
    ds_read_b128 v[180:183], v47 offset:1024
    v_mfma_f32_32x32x16_bf16 v[192:207], a[224:227], v[248:251], 0
    s_waitcnt lgkmcnt(4)
    v_mfma_f32_32x32x16_bf16 v[192:207], v[160:163], v[48:51], v[192:207]
    ds_read_b128 v[184:187], v47 offset:2048
    ds_write_b128 v40, v[208:211] offset:33280
    buffer_load_dwordx4 a[0:3], v1, s[4:7], s8 offen offset:0
    v_mfma_f32_32x32x16_bf16 v[192:207], v[164:167], v[52:55], v[192:207]
    ds_read_b128 v[188:191], v47 offset:3072
    ds_write_b128 v40, v[212:215] offset:34304
    s_waitcnt lgkmcnt(6)
    v_mfma_f32_32x32x16_bf16 v[192:207], v[168:171], v[56:59], v[192:207]
    v_mad_u32_u24 v46, s42, 3, v1
    ds_read_b128 v[160:163], v46 offset:0
    ds_write_b128 v40, v[216:219] offset:35328
    buffer_load_dwordx4 a[4:7], v1, s[4:7], s8 offen offset:1024
    v_mfma_f32_32x32x16_bf16 v[192:207], v[172:175], v[60:63], v[192:207]
    ds_read_b128 v[164:167], v46 offset:1024
    ds_write_b128 v40, v[220:223] offset:36384
    s_waitcnt lgkmcnt(8)
    v_mfma_f32_32x32x16_bf16 v[192:207], v[176:179], v[64:67], v[192:207]
    ds_read_b128 v[168:171], v46 offset:2048
    s_lshl_b32 s33, s20, 2
    s_add_u32 s33, s33, s35
    buffer_load_dwordx4 a[8:11], v1, s[4:7], s8 offen offset:2048
    v_mfma_f32_32x32x16_bf16 v[192:207], v[180:183], v[68:71], v[192:207]
    ds_read_b128 v[172:175], v46 offset:3072
    v_lshlrev_b32 v16, 16, v24
    v_and_b32 v17, 0xffff0000, v24
    s_waitcnt lgkmcnt(7)
    v_mfma_f32_32x32x16_bf16 v[192:207], v[184:187], v[72:75], v[192:207]
    v_mad_u32_u24 v47, s43, 3, v1
    ds_read_b128 v[176:179], v47 offset:0
    v_lshlrev_b32 v18, 16, v25
    v_and_b32 v19, 0xffff0000, v25
    buffer_load_dwordx4 a[12:15], v1, s[4:7], s8 offen offset:3072
    v_mfma_f32_32x32x16_bf16 v[192:207], v[188:191], v[76:79], v[192:207]
    ds_read_b128 v[180:183], v47 offset:1024
    v_lshlrev_b32 v20, 16, v26
    v_and_b32 v21, 0xffff0000, v26
    s_waitcnt lgkmcnt(5)
    v_mfma_f32_32x32x16_bf16 v[192:207], v[160:163], v[80:83], v[192:207]
    ds_read_b128 v[184:187], v47 offset:2048
    v_lshlrev_b32 v22, 16, v27
    v_and_b32 v23, 0xffff0000, v27
    s_add_u32 s12, s8, 4096
    buffer_load_dwordx4 a[16:19], v1, s[4:7], s12 offen offset:0
    v_mfma_f32_32x32x16_bf16 v[192:207], v[164:167], v[84:87], v[192:207]
    ds_read_b128 v[188:191], v47 offset:3072
    v_lshlrev_b32 v24, 16, v28
    v_and_b32 v25, 0xffff0000, v28
    s_waitcnt lgkmcnt(4)
    v_mfma_f32_32x32x16_bf16 v[192:207], v[168:171], v[88:91], v[192:207]
    v_mad_u32_u24 v46, s44, 3, v1
    ds_read_b128 v[160:163], v46 offset:0
    v_lshlrev_b32 v26, 16, v29
    v_and_b32 v27, 0xffff0000, v29
    buffer_load_dwordx4 a[20:23], v1, s[4:7], s12 offen offset:1024
    v_mfma_f32_32x32x16_bf16 v[192:207], v[172:175], v[92:95], v[192:207]
    ds_read_b128 v[164:167], v46 offset:1024
    v_lshlrev_b32 v28, 16, v30
    v_and_b32 v29, 0xffff0000, v30
    s_waitcnt lgkmcnt(4)
    v_mfma_f32_32x32x16_bf16 v[192:207], v[176:179], v[96:99], v[192:207]
    ds_read_b128 v[168:171], v46 offset:2048
    v_lshlrev_b32 v30, 16, v31
    v_and_b32 v31, 0xffff0000, v31
    buffer_load_dwordx4 a[24:27], v1, s[4:7], s12 offen offset:2048
    v_mfma_f32_32x32x16_bf16 v[192:207], v[180:183], v[100:103], v[192:207]
    ds_read_b128 v[172:175], v46 offset:3072
    s_waitcnt lgkmcnt(4)
    v_mfma_f32_32x32x16_bf16 v[192:207], v[184:187], v[104:107], v[192:207]
    v_mad_u32_u24 v47, s45, 3, v1
    ds_read_b128 v[176:179], v47 offset:0
    buffer_load_dwordx4 a[28:31], v1, s[4:7], s12 offen offset:3072
    v_mfma_f32_32x32x16_bf16 v[192:207], v[188:191], v[108:111], v[192:207]
    ds_read_b128 v[180:183], v47 offset:1024
    s_waitcnt lgkmcnt(4)
    v_mfma_f32_32x32x16_bf16 v[192:207], v[160:163], v[112:115], v[192:207]
    ds_read_b128 v[184:187], v47 offset:2048
    s_add_u32 s12, s8, 8192
    buffer_load_dwordx4 a[32:35], v1, s[4:7], s12 offen offset:0
    v_mfma_f32_32x32x16_bf16 v[192:207], v[164:167], v[116:119], v[192:207]
    ds_read_b128 v[188:191], v47 offset:3072
    s_waitcnt lgkmcnt(4)
    v_mfma_f32_32x32x16_bf16 v[192:207], v[168:171], v[120:123], v[192:207]
    v_mad_u32_u24 v46, s46, 3, v1
    ds_read_b128 v[160:163], v46 offset:0
    buffer_load_dwordx4 a[36:39], v1, s[4:7], s12 offen offset:1024
    s_waitcnt vmcnt(10)
    s_mov_b64 exec, 1
    buffer_store_dword v11, v9, s[4:7], s33 offen offset:0 sc1
    s_mov_b64 exec, -1
    v_mfma_f32_32x32x16_bf16 v[192:207], v[172:175], v[124:127], v[192:207]
    ds_read_b128 v[164:167], v46 offset:1024
    s_waitcnt lgkmcnt(4)
    v_mfma_f32_32x32x16_bf16 v[192:207], v[176:179], v[128:131], v[192:207]
    ds_read_b128 v[168:171], v46 offset:2048
    v_mfma_f32_32x32x16_bf16 v[192:207], v[180:183], v[132:135], v[192:207]
    ds_read_b128 v[172:175], v46 offset:3072
    s_waitcnt lgkmcnt(4)
    v_mfma_f32_32x32x16_bf16 v[192:207], v[184:187], v[136:139], v[192:207]
    v_mad_u32_u24 v47, s47, 3, v1
    ds_read_b128 v[176:179], v47 offset:0
    v_mfma_f32_32x32x16_bf16 v[192:207], v[188:191], v[140:143], v[192:207]
    ds_read_b128 v[180:183], v47 offset:1024
    s_waitcnt lgkmcnt(4)
    v_mfma_f32_32x32x16_bf16 v[192:207], v[160:163], v[144:147], v[192:207]
    ds_read_b128 v[184:187], v47 offset:2048
    s_lshr_b32 s30, s20, 1
    s_sub_u32 s30, 2, s30
    s_min_u32 s31, s30, s21
    s_lshl_b32 s32, s31, 11
    s_sub_u32 s35, s35, s32
    v_mfma_f32_32x32x16_bf16 v[192:207], v[164:167], v[148:151], v[192:207]
    ds_read_b128 v[188:191], v47 offset:3072
    s_waitcnt lgkmcnt(4)
    v_mfma_f32_32x32x16_bf16 v[192:207], v[168:171], v[152:155], v[192:207]
    s_and_b32 s32, s20, 1
    s_lshl_b32 s32, s32, 1
    s_lshl_b32 s32, 3, s32
    s_cmp_eq_u32 s30, s31
    s_cselect_b32 s32, s32, 1
    s_mov_b32 s33, 0
    v_mfma_f32_32x32x16_bf16 v[192:207], v[172:175], v[156:159], v[192:207]
    s_waitcnt lgkmcnt(2)
    v_mfma_f32_32x32x16_bf16 v[192:207], v[176:179], a[240:243], v[192:207]
    s_lshl_b32 s100, s22, 18
    s_add_u32 s100, s100, s26
    s_mul_i32 s101, s20, 8320
    s_add_u32 s101, s101, 98304
    v_mfma_f32_32x32x16_bf16 v[192:207], v[180:183], a[244:247], v[192:207]
    s_waitcnt lgkmcnt(0)
    v_mfma_f32_32x32x16_bf16 v[192:207], v[184:187], a[248:251], v[192:207]
    v_mfma_f32_32x32x16_bf16 v[192:207], v[188:191], a[252:255], v[192:207]
    s_mov_b64 exec, 0xffff
    v_cmp_eq_u32 vcc, 0, v2
    s_nop 0
    s_nop 1
    s_cbranch_vccz S_2
S_3:
    buffer_load_dword v2, v10, s[4:7], s1 offen sc1
    s_waitcnt vmcnt(0)
    v_cmp_eq_u32 vcc, 0, v2
    s_nop 0
    s_cbranch_vccz S_2
    s_add_u32 s39, s39, 1
    s_cmp_lt_u32 s39, 200000
    s_cbranch_scc1 S_3
S_2:
    v_cmp_ne_u32 vcc, s3, v2
    s_mov_b64 exec, -1
    s_cbranch_vccnz M_slow_entry
    s_mov_b64 exec, s[32:33]
    buffer_load_dword v45, v10, s[4:7], s35 offen sc1
    s_mov_b64 exec, -1
    v_pk_mul_f32 v[192:193], v[254:255], v[192:193]
    v_pk_mul_f32 v[194:195], v[254:255], v[194:195]
    v_pk_mul_f32 v[196:197], v[254:255], v[196:197]
    v_pk_mul_f32 v[198:199], v[254:255], v[198:199]
    v_pk_mul_f32 v[200:201], v[254:255], v[200:201]
    v_pk_mul_f32 v[202:203], v[254:255], v[202:203]
    v_pk_mul_f32 v[204:205], v[254:255], v[204:205]
    v_pk_mul_f32 v[206:207], v[254:255], v[206:207]
    v_cvt_pk_bf16_f32 v48, v192, v193
    v_cvt_pk_bf16_f32 v49, v194, v195
    v_cvt_pk_bf16_f32 v50, v196, v197
    v_cvt_pk_bf16_f32 v51, v198, v199
    v_cvt_pk_bf16_f32 v52, v200, v201
    v_cvt_pk_bf16_f32 v53, v202, v203
    v_cvt_pk_bf16_f32 v54, v204, v205
    v_cvt_pk_bf16_f32 v55, v206, v207
    s_mov_b64 exec, s[32:33]
S_5:
    s_waitcnt vmcnt(0)
    v_cmp_ne_u32 vcc, v11, v45
    s_nop 0
    s_cbranch_vccz S_4
    buffer_load_dword v45, v10, s[4:7], s35 offen sc1
    s_add_u32 s39, s39, 1
    s_cmp_lt_u32 s39, 200000
    s_cbranch_scc1 S_5
S_4:
    s_mov_b64 exec, -1
    s_cmp_eq_u32 s30, s31
    s_cbranch_scc1 K_6
    v_mov_b32 v47, 0x7ff00000
    s_add_u32 m0, s101, 0
    s_nop 0
    buffer_load_dwordx4 v43, s[4:7], s100 offen offset:0 sc1 lds
    s_add_u32 m0, s101, 4160
    s_nop 0
    buffer_load_dwordx4 v43, s[4:7], s100 offen offset:0 sc1 lds
    s_add_u32 m0, s101, 0
    s_nop 0
    buffer_load_dwordx4 v43, s[4:7], s100 offen offset:1024 sc1 lds
    s_add_u32 m0, s101, 4160
    s_nop 0
    buffer_load_dwordx4 v43, s[4:7], s100 offen offset:1024 sc1 lds
    s_add_u32 m0, s101, 2048
    s_nop 0
    buffer_load_dwordx4 v47, s[4:7], 0 offen sc1 lds
    s_add_u32 m0, s101, 6208
    s_nop 0
    buffer_load_dwordx4 v47, s[4:7], 0 offen sc1 lds
    s_add_u32 m0, s101, 3104
    s_nop 0
    buffer_load_dwordx4 v47, s[4:7], 0 offen sc1 lds
    s_add_u32 m0, s101, 7264
    s_nop 0
    buffer_load_dwordx4 v47, s[4:7], 0 offen sc1 lds
    s_branch K_7
K_6:
    s_lshl_b32 s31, s21, 2
    s_lshl_b32 s32, s20, 1
    s_add_u32 s31, s31, s32
    s_sub_u32 s31, s31, 8
    s_lshl_b32 s31, s31, 12
    s_add_u32 s100, s100, s31
    s_add_u32 s33, s100, 4096
    s_add_u32 m0, s101, 0
    s_nop 0
    buffer_load_dwordx4 v1, s[4:7], s100 offen offset:0 sc1 lds
    s_add_u32 m0, s101, 4160
    s_nop 0
    buffer_load_dwordx4 v1, s[4:7], s33 offen offset:0 sc1 lds
    s_add_u32 m0, s101, 0
    s_nop 0
    buffer_load_dwordx4 v1, s[4:7], s100 offen offset:1024 sc1 lds
    s_add_u32 m0, s101, 4160
    s_nop 0
    buffer_load_dwordx4 v1, s[4:7], s33 offen offset:1024 sc1 lds
    s_add_u32 m0, s101, 0
    s_nop 0
    buffer_load_dwordx4 v1, s[4:7], s100 offen offset:2048 sc1 lds
    s_add_u32 m0, s101, 4160
    s_nop 0
    buffer_load_dwordx4 v1, s[4:7], s33 offen offset:2048 sc1 lds
    s_add_u32 m0, s101, 32
    s_nop 0
    buffer_load_dwordx4 v1, s[4:7], s100 offen offset:3072 sc1 lds
    s_add_u32 m0, s101, 4192
    s_nop 0
    buffer_load_dwordx4 v1, s[4:7], s33 offen offset:3072 sc1 lds
K_7:
    s_lshl_b32 s30, s28, 15
    s_lshl_b32 s31, s22, 11
    s_add_u32 s30, s30, s31
    s_add_u32 s96, s30, 19922944
    s_lshl_b32 s14, s24, 16
    s_and_b32 s30, s20, 1
    s_lshl_b32 s30, s30, 15
    s_add_u32 s14, s14, s30
    s_add_u32 s14, s14, 1048576
    s_waitcnt lgkmcnt(0)
    s_waitcnt vmcnt(6)
    s_barrier
    ds_read_b128 v[56:59], v40 offset:0
    ds_read_b128 v[60:63], v40 offset:33280
    ds_read_b128 v[64:67], v40 offset:4160
    ds_read_b128 v[68:71], v40 offset:8320
    ds_read_b128 v[72:75], v40 offset:12480
    ds_read_b128 v[76:79], v40 offset:16640
    ds_read_b128 a[240:243], v40 offset:20800
    ds_read_b128 a[244:247], v40 offset:24960
    ds_read_b128 a[248:251], v40 offset:29120
    s_waitcnt lgkmcnt(7)
    v_mfma_f32_32x32x16_bf16 v[80:95], v[56:59], v[48:51], 0
    v_mfma_f32_32x32x16_bf16 v[112:127], v[60:63], v[48:51], 0
    s_waitcnt lgkmcnt(3)
    v_mfma_f32_32x32x16_bf16 v[96:111], v[64:67], v[48:51], 0
    v_mfma_f32_32x32x16_bf16 v[128:143], v[68:71], v[48:51], 0
    s_nop 8
    v_cndmask_b32 v112, v80, v112, s[64:65]
    v_cndmask_b32 v113, v81, v113, s[66:67]
    v_cndmask_b32 v114, v82, v114, s[68:69]
    v_cndmask_b32 v115, v83, v115, s[70:71]
    v_cndmask_b32 v116, v84, v116, s[72:73]
    v_cndmask_b32 v117, v85, v117, s[74:75]
    v_cndmask_b32 v118, v86, v118, s[76:77]
    v_cndmask_b32 v119, v87, v119, s[78:79]
    v_mfma_f32_32x32x16_bf16 v[144:159], v[72:75], v[48:51], 0
    v_cndmask_b32 v120, v88, v120, s[80:81]
    v_cndmask_b32 v121, v89, v121, s[82:83]
    v_cndmask_b32 v122, v90, v122, s[84:85]
    v_cndmask_b32 v123, v91, v123, s[86:87]
    v_cndmask_b32 v124, v92, v124, s[88:89]
    v_cndmask_b32 v125, v93, v125, s[90:91]
    v_cndmask_b32 v126, v94, v126, s[92:93]
    v_cndmask_b32 v127, v95, v127, s[94:95]
    v_max_f32 v45, v112, v113
    v_mfma_f32_32x32x16_bf16 v[80:95], v[76:79], v[48:51], 0
    v_max3_f32 v45, v114, v115, v45
    v_max3_f32 v45, v116, v117, v45
    v_max3_f32 v45, v118, v119, v45
    v_max3_f32 v45, v120, v121, v45
    v_max3_f32 v45, v122, v123, v45
    v_max3_f32 v45, v124, v125, v45
    v_max3_f32 v45, v126, v127, v45
    v_max3_f32 v45, v96, v97, v45
    v_max3_f32 v45, v98, v99, v45
    v_max3_f32 v45, v100, v101, v45
    v_max3_f32 v45, v102, v103, v45
    v_max3_f32 v45, v104, v105, v45
    v_max3_f32 v45, v106, v107, v45
    v_max3_f32 v45, v108, v109, v45
    v_max3_f32 v45, v110, v111, v45
    s_waitcnt lgkmcnt(0)
    v_mfma_f32_32x32x16_bf16 v[96:111], a[240:243], v[48:51], 0
    v_max3_f32 v45, v128, v129, v45
    v_max3_f32 v45, v130, v131, v45
    v_max3_f32 v45, v132, v133, v45
    v_max3_f32 v45, v134, v135, v45
    v_max3_f32 v45, v136, v137, v45
    v_max3_f32 v45, v138, v139, v45
    v_max3_f32 v45, v140, v141, v45
    v_max3_f32 v45, v142, v143, v45
    v_mfma_f32_32x32x16_bf16 v[128:143], a[244:247], v[48:51], 0
    v_max3_f32 v45, v144, v145, v45
    v_max3_f32 v45, v146, v147, v45
    v_max3_f32 v45, v148, v149, v45
    v_max3_f32 v45, v150, v151, v45
    v_max3_f32 v45, v152, v153, v45
    v_max3_f32 v45, v154, v155, v45
    v_max3_f32 v45, v156, v157, v45
    v_max3_f32 v45, v158, v159, v45
    v_mfma_f32_32x32x16_bf16 v[144:159], a[248:251], v[48:51], 0
    v_max3_f32 v45, v80, v81, v45
    v_max3_f32 v45, v82, v83, v45
    v_max3_f32 v45, v84, v85, v45
    v_max3_f32 v45, v86, v87, v45
    v_max3_f32 v45, v88, v89, v45
    v_max3_f32 v45, v90, v91, v45
    v_max3_f32 v45, v92, v93, v45
    v_max3_f32 v45, v94, v95, v45
    v_max3_f32 v45, v96, v97, v45
    v_max3_f32 v45, v98, v99, v45
    v_max3_f32 v45, v100, v101, v45
    v_max3_f32 v45, v102, v103, v45
    v_max3_f32 v45, v104, v105, v45
    v_max3_f32 v45, v106, v107, v45
    v_max3_f32 v45, v108, v109, v45
    v_max3_f32 v45, v110, v111, v45
    v_max3_f32 v45, v128, v129, v45
    v_max3_f32 v45, v130, v131, v45
    v_max3_f32 v45, v132, v133, v45
    v_max3_f32 v45, v134, v135, v45
    v_max3_f32 v45, v136, v137, v45
    v_max3_f32 v45, v138, v139, v45
    v_max3_f32 v45, v140, v141, v45
    v_max3_f32 v45, v142, v143, v45
    s_waitcnt vmcnt(0)
    s_barrier
    v_max3_f32 v45, v144, v145, v45
    v_max3_f32 v45, v146, v147, v45
    v_max3_f32 v45, v148, v149, v45
    v_max3_f32 v45, v150, v151, v45
    v_max3_f32 v45, v152, v153, v45
    v_max3_f32 v45, v154, v155, v45
    v_max3_f32 v45, v156, v157, v45
    v_max3_f32 v45, v158, v159, v45
    v_mov_b32 v128, v45
    ds_read_b128 v[160:163], v41 offset:0
    ds_read_b128 v[164:167], v41 offset:1056
    v_permlane32_swap_b32 v128, v45
    v_max_f32 v45, v128, v45
    v_sub_f32 v128, 0, v45
    v_sub_f32 v129, 0, v45
    v_pk_mov_b32 v[130:131], v[128:129], v[128:129]
    v_pk_mov_b32 v[132:133], v[128:129], v[128:129]
    v_pk_mov_b32 v[134:135], v[128:129], v[128:129]
    v_pk_mov_b32 v[136:137], v[128:129], v[128:129]
    v_pk_mov_b32 v[138:139], v[128:129], v[128:129]
    v_pk_mov_b32 v[140:141], v[128:129], v[128:129]
    v_pk_mov_b32 v[142:143], v[128:129], v[128:129]
    v_pk_add_f32 v[112:113], v[112:113], v[128:129]
    v_pk_add_f32 v[114:115], v[114:115], v[128:129]
    v_pk_add_f32 v[116:117], v[116:117], v[128:129]
    v_pk_add_f32 v[118:119], v[118:119], v[128:129]
    v_pk_add_f32 v[120:121], v[120:121], v[128:129]
    v_pk_add_f32 v[122:123], v[122:123], v[128:129]
    v_pk_add_f32 v[124:125], v[124:125], v[128:129]
    v_pk_add_f32 v[126:127], v[126:127], v[128:129]
    ds_read_b128 v[168:171], v41 offset:33280
    ds_read_b128 v[172:175], v41 offset:34336
    v_mfma_f32_32x32x16_bf16 v[96:111], v[64:67], v[48:51], v[128:143]
    v_exp_f32 v112, v112
    v_exp_f32 v113, v113
    v_exp_f32 v114, v114
    v_cvt_pk_bf16_f32 v112, v112, v113
    s_mul_i32 s100, s20, 24576
    s_add_u32 m0, s100, 0
    s_mul_i32 s101, s22, 114688
    s_add_u32 s101, s101, s100
    s_add_u32 s101, s101, 3407872
    buffer_load_dwordx4 v1, s[4:7], s101 offen offset:0 lds
    v_exp_f32 v115, v115
    v_exp_f32 v116, v116
    v_cvt_pk_bf16_f32 v113, v114, v115
    v_exp_f32 v117, v117
    v_exp_f32 v118, v118
    v_cvt_pk_bf16_f32 v114, v116, v117
    v_exp_f32 v119, v119
    v_exp_f32 v120, v120
    v_cvt_pk_bf16_f32 v115, v118, v119
    buffer_load_dwordx4 v1, s[4:7], s101 offen offset:1024 lds
    v_exp_f32 v121, v121
    v_exp_f32 v122, v122
    v_cvt_pk_bf16_f32 v116, v120, v121
    v_exp_f32 v123, v123
    v_exp_f32 v124, v124
    v_cvt_pk_bf16_f32 v117, v122, v123
    v_exp_f32 v125, v125
    v_exp_f32 v126, v126
    v_cvt_pk_bf16_f32 v118, v124, v125
    buffer_load_dwordx4 v1, s[4:7], s101 offen offset:2048 lds
    v_exp_f32 v127, v127
    v_and_b32 v120, v32, v112
    v_cvt_pk_bf16_f32 v119, v126, v127
    v_xor_b32 v112, v120, v112
    v_and_b32 v121, v33, v113
    v_xor_b32 v113, v121, v113
    v_and_b32 v122, v34, v114
    v_xor_b32 v114, v122, v114
    v_and_b32 v123, v35, v115
    v_xor_b32 v115, v123, v115
    v_and_b32 v124, v36, v116
    v_xor_b32 v116, v124, v116
    v_and_b32 v125, v37, v117
    v_xor_b32 v117, v125, v117
    v_and_b32 v126, v38, v118
    v_xor_b32 v118, v126, v118
    v_and_b32 v127, v39, v119
    v_xor_b32 v119, v127, v119
    v_mfma_f32_32x32x16_bf16 v[80:95], v[68:71], v[48:51], v[128:143]
    v_exp_f32 v96, v96
    v_exp_f32 v97, v97
    buffer_load_dwordx4 v1, s[4:7], s101 offen offset:3072 lds
    v_exp_f32 v98, v98
    v_cvt_pk_bf16_f32 v152, v96, v97
    s_waitcnt lgkmcnt(0)
    v_mfma_f32_32x32x16_bf16 v[176:191], v[160:163], v[112:115], 0
    v_exp_f32 v99, v99
    v_exp_f32 v100, v100
    v_cvt_pk_bf16_f32 v153, v98, v99
    v_exp_f32 v101, v101
    v_mfma_f32_32x32x16_bf16 v[176:191], v[164:167], v[116:119], v[176:191]
    v_exp_f32 v102, v102
    v_cvt_pk_bf16_f32 v154, v100, v101
    ds_read_b128 v[160:163], v41 offset:4160
    v_exp_f32 v103, v103
    v_exp_f32 v104, v104
    v_cvt_pk_bf16_f32 v155, v102, v103
    v_mfma_f32_32x32x16_bf16 v[176:191], v[168:171], v[120:123], v[176:191]
    s_add_u32 m0, m0, 4096
    s_add_u32 s101, s101, 4096
    buffer_load_dwordx4 v1, s[4:7], s101 offen offset:0 lds
    v_exp_f32 v105, v105
    v_exp_f32 v106, v106
    v_cvt_pk_bf16_f32 v156, v104, v105
    v_exp_f32 v107, v107
    v_mfma_f32_32x32x16_bf16 v[176:191], v[172:175], v[124:127], v[176:191]
    v_exp_f32 v108, v108
    v_cvt_pk_bf16_f32 v157, v106, v107
    v_exp_f32 v109, v109
    buffer_load_dwordx4 v1, s[4:7], s101 offen offset:1024 lds
    v_exp_f32 v110, v110
    v_cvt_pk_bf16_f32 v158, v108, v109
    v_exp_f32 v111, v111
    ds_read_b128 v[164:167], v41 offset:5216
    v_cvt_pk_bf16_f32 v159, v110, v111
    v_mfma_f32_32x32x16_bf16 v[96:111], v[72:75], v[48:51], v[128:143]
    v_exp_f32 v80, v80
    v_exp_f32 v81, v81
    buffer_load_dwordx4 v1, s[4:7], s101 offen offset:2048 lds
    v_exp_f32 v82, v82
    v_cvt_pk_bf16_f32 v144, v80, v81
    v_exp_f32 v83, v83
    v_exp_f32 v84, v84
    v_cvt_pk_bf16_f32 v145, v82, v83
    s_waitcnt lgkmcnt(0)
    v_mfma_f32_32x32x16_bf16 v[176:191], v[160:163], v[152:155], v[176:191]
    v_exp_f32 v85, v85
    v_exp_f32 v86, v86
    v_cvt_pk_bf16_f32 v146, v84, v85
    ds_read_b128 v[168:171], v41 offset:8320
    v_exp_f32 v87, v87
    v_exp_f32 v88, v88
    v_cvt_pk_bf16_f32 v147, v86, v87
    buffer_load_dwordx4 v1, s[4:7], s101 offen offset:3072 lds
    v_exp_f32 v89, v89
    v_exp_f32 v90, v90
    v_cvt_pk_bf16_f32 v148, v88, v89
    v_mfma_f32_32x32x16_bf16 v[176:191], v[164:167], v[156:159], v[176:191]
    v_exp_f32 v91, v91
    v_exp_f32 v92, v92
    v_cvt_pk_bf16_f32 v149, v90, v91
    ds_read_b128 v[56:59], v40 offset:1024
    v_exp_f32 v93, v93
    s_add_u32 m0, m0, 4096
    s_add_u32 s101, s101, 4096
    buffer_load_dwordx4 v1, s[4:7], s101 offen offset:0 lds
    v_exp_f32 v94, v94
    v_cvt_pk_bf16_f32 v150, v92, v93
    v_exp_f32 v95, v95
    ds_read_b128 v[172:175], v41 offset:9376
    v_cvt_pk_bf16_f32 v151, v94, v95
    v_mfma_f32_32x32x16_bf16 v[80:95], v[76:79], v[48:51], v[128:143]
    v_exp_f32 v96, v96
    v_exp_f32 v97, v97
    buffer_load_dwordx4 v1, s[4:7], s101 offen offset:1024 lds
    v_exp_f32 v98, v98
    v_cvt_pk_bf16_f32 v152, v96, v97
    v_exp_f32 v99, v99
    v_exp_f32 v100, v100
    v_cvt_pk_bf16_f32 v153, v98, v99
    s_waitcnt lgkmcnt(0)
    v_mfma_f32_32x32x16_bf16 v[176:191], v[168:171], v[144:147], v[176:191]
    v_exp_f32 v101, v101
    v_exp_f32 v102, v102
    v_cvt_pk_bf16_f32 v154, v100, v101
    ds_read_b128 v[160:163], v41 offset:12480
    v_exp_f32 v103, v103
    v_exp_f32 v104, v104
    v_cvt_pk_bf16_f32 v155, v102, v103
    buffer_load_dwordx4 v1, s[4:7], s101 offen offset:2048 lds
    v_exp_f32 v105, v105
    v_exp_f32 v106, v106
    v_cvt_pk_bf16_f32 v156, v104, v105
    v_mfma_f32_32x32x16_bf16 v[176:191], v[172:175], v[148:151], v[176:191]
    v_exp_f32 v107, v107
    v_exp_f32 v108, v108
    v_cvt_pk_bf16_f32 v157, v106, v107
    ds_read_b128 v[60:63], v40 offset:34304
    ds_read_b128 a[252:255], v40 offset:5184
    v_exp_f32 v109, v109
    buffer_load_dwordx4 v1, s[4:7], s101 offen offset:3072 lds
    v_exp_f32 v110, v110
    v_cvt_pk_bf16_f32 v158, v108, v109
    v_exp_f32 v111, v111
    ds_read_b128 v[164:167], v41 offset:13536
    v_cvt_pk_bf16_f32 v159, v110, v111
    v_mfma_f32_32x32x16_bf16 v[96:111], a[240:243], v[48:51], v[128:143]
    v_exp_f32 v80, v80
    v_exp_f32 v81, v81
    s_add_u32 m0, m0, 4096
    s_add_u32 s101, s101, 4096
    buffer_load_dwordx4 v1, s[4:7], s101 offen offset:0 lds
    v_exp_f32 v82, v82
    v_cvt_pk_bf16_f32 v144, v80, v81
    v_exp_f32 v83, v83
    v_exp_f32 v84, v84
    v_cvt_pk_bf16_f32 v145, v82, v83
    s_waitcnt lgkmcnt(0)
    v_mfma_f32_32x32x16_bf16 v[176:191], v[160:163], v[152:155], v[176:191]
    v_exp_f32 v85, v85
    v_exp_f32 v86, v86
    v_cvt_pk_bf16_f32 v146, v84, v85
    ds_read_b128 v[168:171], v41 offset:16640
    v_exp_f32 v87, v87
    v_exp_f32 v88, v88
    v_cvt_pk_bf16_f32 v147, v86, v87
    buffer_load_dwordx4 v1, s[4:7], s101 offen offset:1024 lds
    v_exp_f32 v89, v89
    v_exp_f32 v90, v90
    v_cvt_pk_bf16_f32 v148, v88, v89
    v_mfma_f32_32x32x16_bf16 v[176:191], v[164:167], v[156:159], v[176:191]
    v_exp_f32 v91, v91
    v_exp_f32 v92, v92
    v_cvt_pk_bf16_f32 v149, v90, v91
    ds_read_b128 v[64:67], v40 offset:9344
    ds_read_b128 v[68:71], v40 offset:13504
    v_exp_f32 v93, v93
    buffer_load_dwordx4 v1, s[4:7], s101 offen offset:2048 lds
    v_exp_f32 v94, v94
    v_cvt_pk_bf16_f32 v150, v92, v93
    v_exp_f32 v95, v95
    ds_read_b128 v[172:175], v41 offset:17696
    v_cvt_pk_bf16_f32 v151, v94, v95
    v_mfma_f32_32x32x16_bf16 v[80:95], a[244:247], v[48:51], v[128:143]
    v_exp_f32 v96, v96
    v_exp_f32 v97, v97
    buffer_load_dwordx4 v1, s[4:7], s101 offen offset:3072 lds
    v_exp_f32 v98, v98
    v_cvt_pk_bf16_f32 v152, v96, v97
    v_exp_f32 v99, v99
    v_exp_f32 v100, v100
    v_cvt_pk_bf16_f32 v153, v98, v99
    s_waitcnt lgkmcnt(0)
    v_mfma_f32_32x32x16_bf16 v[176:191], v[168:171], v[144:147], v[176:191]
    v_exp_f32 v101, v101
    v_exp_f32 v102, v102
    v_cvt_pk_bf16_f32 v154, v100, v101
    ds_read_b128 v[160:163], v41 offset:20800
    v_exp_f32 v103, v103
    v_exp_f32 v104, v104
    v_cvt_pk_bf16_f32 v155, v102, v103
    s_add_u32 m0, m0, 4096
    s_add_u32 s101, s101, 4096
    buffer_load_dwordx4 v1, s[4:7], s101 offen offset:0 lds
    v_exp_f32 v105, v105
    v_exp_f32 v106, v106
    v_cvt_pk_bf16_f32 v156, v104, v105
    v_mfma_f32_32x32x16_bf16 v[176:191], v[172:175], v[148:151], v[176:191]
    v_exp_f32 v107, v107
    v_exp_f32 v108, v108
    v_cvt_pk_bf16_f32 v157, v106, v107
    ds_read_b128 v[72:75], v40 offset:17664
    ds_read_b128 v[76:79], v40 offset:21824
    v_exp_f32 v109, v109
    buffer_load_dwordx4 v1, s[4:7], s101 offen offset:1024 lds
    v_exp_f32 v110, v110
    v_cvt_pk_bf16_f32 v158, v108, v109
    v_exp_f32 v111, v111
    ds_read_b128 v[164:167], v41 offset:21856
    v_cvt_pk_bf16_f32 v159, v110, v111
    v_mfma_f32_32x32x16_bf16 v[96:111], a[248:251], v[48:51], v[128:143]
    v_exp_f32 v80, v80
    v_exp_f32 v81, v81
    buffer_load_dwordx4 v1, s[4:7], s101 offen offset:2048 lds
    v_exp_f32 v82, v82
    v_cvt_pk_bf16_f32 v144, v80, v81
    v_exp_f32 v83, v83
    v_exp_f32 v84, v84
    v_cvt_pk_bf16_f32 v145, v82, v83
    s_waitcnt lgkmcnt(0)
    v_mfma_f32_32x32x16_bf16 v[176:191], v[160:163], v[152:155], v[176:191]
    v_exp_f32 v85, v85
    v_exp_f32 v86, v86
    v_cvt_pk_bf16_f32 v146, v84, v85
    ds_read_b128 v[168:171], v41 offset:24960
    v_exp_f32 v87, v87
    v_exp_f32 v88, v88
    v_cvt_pk_bf16_f32 v147, v86, v87
    buffer_load_dwordx4 v1, s[4:7], s101 offen offset:3072 lds
    v_exp_f32 v89, v89
    v_exp_f32 v90, v90
    v_cvt_pk_bf16_f32 v148, v88, v89
    v_mfma_f32_32x32x16_bf16 v[176:191], v[164:167], v[156:159], v[176:191]
    v_exp_f32 v91, v91
    v_exp_f32 v92, v92
    v_cvt_pk_bf16_f32 v149, v90, v91
    ds_read_b128 a[240:243], v40 offset:25984
    ds_read_b128 a[244:247], v40 offset:30144
    v_exp_f32 v93, v93
    s_add_u32 m0, m0, 4096
    s_add_u32 s101, s101, 4096
    buffer_load_dwordx4 v1, s[4:7], s101 offen offset:0 lds
    v_exp_f32 v94, v94
    v_cvt_pk_bf16_f32 v150, v92, v93
    v_exp_f32 v95, v95
    ds_read_b128 v[172:175], v41 offset:26016
    v_cvt_pk_bf16_f32 v151, v94, v95
    v_exp_f32 v96, v96
    v_mfma_f32_32x32x16_bf16 v[80:95], v[56:59], v[52:55], 0
    v_exp_f32 v97, v97
    buffer_load_dwordx4 v1, s[4:7], s101 offen offset:1024 lds
    v_exp_f32 v98, v98
    v_cvt_pk_bf16_f32 v152, v96, v97
    v_exp_f32 v99, v99
    v_exp_f32 v100, v100
    v_cvt_pk_bf16_f32 v153, v98, v99
    s_waitcnt lgkmcnt(0)
    v_mfma_f32_32x32x16_bf16 v[176:191], v[168:171], v[144:147], v[176:191]
    v_exp_f32 v101, v101
    v_exp_f32 v102, v102
    v_cvt_pk_bf16_f32 v154, v100, v101
    ds_read_b128 v[160:163], v41 offset:29120
    ds_read_b128 v[164:167], v41 offset:30176
    v_exp_f32 v103, v103
    v_mfma_f32_32x32x16_bf16 v[112:127], v[60:63], v[52:55], 0
    v_exp_f32 v104, v104
    v_cvt_pk_bf16_f32 v155, v102, v103
    buffer_load_dwordx4 v1, s[4:7], s101 offen offset:2048 lds
    v_exp_f32 v105, v105
    v_exp_f32 v106, v106
    v_cvt_pk_bf16_f32 v156, v104, v105
    v_mfma_f32_32x32x16_bf16 v[176:191], v[172:175], v[148:151], v[176:191]
    v_exp_f32 v107, v107
    v_exp_f32 v108, v108
    v_cvt_pk_bf16_f32 v157, v106, v107
    v_exp_f32 v109, v109
    buffer_load_dwordx4 v1, s[4:7], s101 offen offset:3072 lds
    s_waitcnt lgkmcnt(0)
    v_mfma_f32_32x32x16_bf16 v[176:191], v[160:163], v[152:155], v[176:191]
    v_exp_f32 v110, v110
    v_cvt_pk_bf16_f32 v158, v108, v109
    v_exp_f32 v111, v111
    s_nop 0
    v_cvt_pk_bf16_f32 v159, v110, v111
    s_nop 1
    v_mfma_f32_32x32x16_bf16 v[176:191], v[164:167], v[156:159], v[176:191]
    v_mfma_f32_32x32x16_bf16 v[96:111], a[252:255], v[52:55], 0
    v_mfma_f32_32x32x16_bf16 v[128:143], v[64:67], v[52:55], 0
    v_cndmask_b32 v112, v80, v112, s[64:65]
    v_cndmask_b32 v113, v81, v113, s[66:67]
    v_cndmask_b32 v114, v82, v114, s[68:69]
    v_cndmask_b32 v115, v83, v115, s[70:71]
    v_cndmask_b32 v116, v84, v116, s[72:73]
    v_cndmask_b32 v117, v85, v117, s[74:75]
    v_cndmask_b32 v118, v86, v118, s[76:77]
    v_cndmask_b32 v119, v87, v119, s[78:79]
    v_mfma_f32_32x32x16_bf16 v[144:159], v[68:71], v[52:55], 0
    v_cndmask_b32 v120, v88, v120, s[80:81]
    v_cndmask_b32 v121, v89, v121, s[82:83]
    v_cndmask_b32 v122, v90, v122, s[84:85]
    v_cndmask_b32 v123, v91, v123, s[86:87]
    v_cndmask_b32 v124, v92, v124, s[88:89]
    v_cndmask_b32 v125, v93, v125, s[90:91]
    v_cndmask_b32 v126, v94, v126, s[92:93]
    v_cndmask_b32 v127, v95, v127, s[94:95]
    v_max_f32 v45, v112, v113
    v_mfma_f32_32x32x16_bf16 v[80:95], v[72:75], v[52:55], 0
    v_rcp_f32 v184, v184
    s_nop 0
    v_mul_f32 v176, v176, v184
    v_mul_f32 v177, v177, v184
    v_mul_f32 v178, v178, v184
    v_mul_f32 v179, v179, v184
    v_mul_f32 v180, v180, v184
    v_mul_f32 v181, v181, v184
    v_mul_f32 v182, v182, v184
    v_mul_f32 v183, v183, v184
    v_cvt_pk_bf16_f32 v188, v176, v177
    v_cvt_pk_bf16_f32 v189, v178, v179
    v_cvt_pk_bf16_f32 v190, v180, v181
    v_cvt_pk_bf16_f32 v191, v182, v183
    buffer_store_dwordx4 v[188:191], v1, s[4:7], s96 offen offset:0 sc1
    v_max3_f32 v45, v114, v115, v45
    v_max3_f32 v45, v116, v117, v45
    v_max3_f32 v45, v118, v119, v45
    v_max3_f32 v45, v120, v121, v45
    v_max3_f32 v45, v122, v123, v45
    v_max3_f32 v45, v124, v125, v45
    v_max3_f32 v45, v126, v127, v45
    v_max3_f32 v45, v96, v97, v45
    v_max3_f32 v45, v98, v99, v45
    v_max3_f32 v45, v100, v101, v45
    v_max3_f32 v45, v102, v103, v45
    v_max3_f32 v45, v104, v105, v45
    v_max3_f32 v45, v106, v107, v45
    v_max3_f32 v45, v108, v109, v45
    v_max3_f32 v45, v110, v111, v45
    v_mfma_f32_32x32x16_bf16 v[96:111], v[76:79], v[52:55], 0
    s_add_u32 s15, s14, 0
    buffer_load_dwordx4 v[192:195], v1, s[4:7], s15 offen offset:0
    v_max3_f32 v45, v128, v129, v45
    v_max3_f32 v45, v130, v131, v45
    v_max3_f32 v45, v132, v133, v45
    v_max3_f32 v45, v134, v135, v45
    v_max3_f32 v45, v136, v137, v45
    v_max3_f32 v45, v138, v139, v45
    v_max3_f32 v45, v140, v141, v45
    v_max3_f32 v45, v142, v143, v45
    v_mfma_f32_32x32x16_bf16 v[128:143], a[240:243], v[52:55], 0
    buffer_load_dwordx4 v[196:199], v1, s[4:7], s15 offen offset:1024
    v_max3_f32 v45, v144, v145, v45
    v_max3_f32 v45, v146, v147, v45
    v_max3_f32 v45, v148, v149, v45
    v_max3_f32 v45, v150, v151, v45
    v_max3_f32 v45, v152, v153, v45
    v_max3_f32 v45, v154, v155, v45
    v_max3_f32 v45, v156, v157, v45
    v_max3_f32 v45, v158, v159, v45
    v_mfma_f32_32x32x16_bf16 v[144:159], a[244:247], v[52:55], 0
    s_add_u32 s15, s14, 4096
    buffer_load_dwordx4 v[200:203], v1, s[4:7], s15 offen offset:0
    v_max3_f32 v45, v80, v81, v45
    v_max3_f32 v45, v82, v83, v45
    v_max3_f32 v45, v84, v85, v45
    v_max3_f32 v45, v86, v87, v45
    v_max3_f32 v45, v88, v89, v45
    v_max3_f32 v45, v90, v91, v45
    v_max3_f32 v45, v92, v93, v45
    v_max3_f32 v45, v94, v95, v45
    v_max3_f32 v45, v96, v97, v45
    v_max3_f32 v45, v98, v99, v45
    v_max3_f32 v45, v100, v101, v45
    v_max3_f32 v45, v102, v103, v45
    v_max3_f32 v45, v104, v105, v45
    v_max3_f32 v45, v106, v107, v45
    v_max3_f32 v45, v108, v109, v45
    v_max3_f32 v45, v110, v111, v45
    buffer_load_dwordx4 v[204:207], v1, s[4:7], s15 offen offset:1024
    v_max3_f32 v45, v128, v129, v45
    v_max3_f32 v45, v130, v131, v45
    v_max3_f32 v45, v132, v133, v45
    v_max3_f32 v45, v134, v135, v45
    v_max3_f32 v45, v136, v137, v45
    v_max3_f32 v45, v138, v139, v45
    v_max3_f32 v45, v140, v141, v45
    v_max3_f32 v45, v142, v143, v45
    s_add_u32 s15, s14, 8192
    buffer_load_dwordx4 v[208:211], v1, s[4:7], s15 offen offset:0
    v_max3_f32 v45, v144, v145, v45
    v_max3_f32 v45, v146, v147, v45
    v_max3_f32 v45, v148, v149, v45
    v_max3_f32 v45, v150, v151, v45
    v_max3_f32 v45, v152, v153, v45
    v_max3_f32 v45, v154, v155, v45
    v_max3_f32 v45, v156, v157, v45
    v_max3_f32 v45, v158, v159, v45
    buffer_load_dwordx4 v[212:215], v1, s[4:7], s15 offen offset:1024
    v_mov_b32 v128, v45
    ds_read_b128 v[160:163], v42 offset:0
    ds_read_b128 v[164:167], v42 offset:1056
    v_permlane32_swap_b32 v128, v45
    v_max_f32 v45, v128, v45
    v_sub_f32 v128, 0, v45
    v_sub_f32 v129, 0, v45
    v_pk_mov_b32 v[130:131], v[128:129], v[128:129]
    v_pk_mov_b32 v[132:133], v[128:129], v[128:129]
    v_pk_mov_b32 v[134:135], v[128:129], v[128:129]
    v_pk_mov_b32 v[136:137], v[128:129], v[128:129]
    v_pk_mov_b32 v[138:139], v[128:129], v[128:129]
    v_pk_mov_b32 v[140:141], v[128:129], v[128:129]
    v_pk_mov_b32 v[142:143], v[128:129], v[128:129]
    v_pk_add_f32 v[112:113], v[112:113], v[128:129]
    v_pk_add_f32 v[114:115], v[114:115], v[128:129]
    v_pk_add_f32 v[116:117], v[116:117], v[128:129]
    v_pk_add_f32 v[118:119], v[118:119], v[128:129]
    v_pk_add_f32 v[120:121], v[120:121], v[128:129]
    v_pk_add_f32 v[122:123], v[122:123], v[128:129]
    v_pk_add_f32 v[124:125], v[124:125], v[128:129]
    v_pk_add_f32 v[126:127], v[126:127], v[128:129]
    ds_read_b128 v[168:171], v42 offset:33280
    ds_read_b128 v[172:175], v42 offset:34336
    v_mfma_f32_32x32x16_bf16 v[96:111], a[252:255], v[52:55], v[128:143]
    v_exp_f32 v112, v112
    v_exp_f32 v113, v113
    v_exp_f32 v114, v114
    v_cvt_pk_bf16_f32 v112, v112, v113
    s_add_u32 s15, s14, 12288
    buffer_load_dwordx4 v[216:219], v1, s[4:7], s15 offen offset:0
    v_exp_f32 v115, v115
    v_exp_f32 v116, v116
    v_cvt_pk_bf16_f32 v113, v114, v115
    v_exp_f32 v117, v117
    v_exp_f32 v118, v118
    v_cvt_pk_bf16_f32 v114, v116, v117
    v_exp_f32 v119, v119
    v_exp_f32 v120, v120
    v_cvt_pk_bf16_f32 v115, v118, v119
    buffer_load_dwordx4 v[220:223], v1, s[4:7], s15 offen offset:1024
    v_exp_f32 v121, v121
    v_exp_f32 v122, v122
    v_cvt_pk_bf16_f32 v116, v120, v121
    v_exp_f32 v123, v123
    v_exp_f32 v124, v124
    v_cvt_pk_bf16_f32 v117, v122, v123
    v_exp_f32 v125, v125
    v_exp_f32 v126, v126
    v_cvt_pk_bf16_f32 v118, v124, v125
    s_add_u32 s15, s14, 16384
    buffer_load_dwordx4 v[224:227], v1, s[4:7], s15 offen offset:0
    v_exp_f32 v127, v127
    v_and_b32 v120, v32, v112
    v_cvt_pk_bf16_f32 v119, v126, v127
    v_xor_b32 v112, v120, v112
    v_and_b32 v121, v33, v113
    v_xor_b32 v113, v121, v113
    v_and_b32 v122, v34, v114
    v_xor_b32 v114, v122, v114
    v_and_b32 v123, v35, v115
    v_xor_b32 v115, v123, v115
    v_and_b32 v124, v36, v116
    v_xor_b32 v116, v124, v116
    v_and_b32 v125, v37, v117
    v_xor_b32 v117, v125, v117
    v_and_b32 v126, v38, v118
    v_xor_b32 v118, v126, v118
    v_and_b32 v127, v39, v119
    v_xor_b32 v119, v127, v119
    v_mfma_f32_32x32x16_bf16 v[80:95], v[64:67], v[52:55], v[128:143]
    v_exp_f32 v96, v96
    v_exp_f32 v97, v97
    buffer_load_dwordx4 v[228:231], v1, s[4:7], s15 offen offset:1024
    v_exp_f32 v98, v98
    v_cvt_pk_bf16_f32 v152, v96, v97
    s_waitcnt lgkmcnt(0)
    v_mfma_f32_32x32x16_bf16 v[176:191], v[160:163], v[112:115], 0
    v_exp_f32 v99, v99
    v_exp_f32 v100, v100
    v_cvt_pk_bf16_f32 v153, v98, v99
    v_exp_f32 v101, v101
    v_mfma_f32_32x32x16_bf16 v[176:191], v[164:167], v[116:119], v[176:191]
    v_exp_f32 v102, v102
    v_cvt_pk_bf16_f32 v154, v100, v101
    ds_read_b128 v[160:163], v42 offset:4160
    v_exp_f32 v103, v103
    v_exp_f32 v104, v104
    v_cvt_pk_bf16_f32 v155, v102, v103
    v_mfma_f32_32x32x16_bf16 v[176:191], v[168:171], v[120:123], v[176:191]
    s_add_u32 s15, s14, 20480
    buffer_load_dwordx4 v[232:235], v1, s[4:7], s15 offen offset:0
    v_exp_f32 v105, v105
    v_exp_f32 v106, v106
    v_cvt_pk_bf16_f32 v156, v104, v105
    v_exp_f32 v107, v107
    v_mfma_f32_32x32x16_bf16 v[176:191], v[172:175], v[124:127], v[176:191]
    v_exp_f32 v108, v108
    v_cvt_pk_bf16_f32 v157, v106, v107
    v_exp_f32 v109, v109
    buffer_load_dwordx4 v[236:239], v1, s[4:7], s15 offen offset:1024
    v_exp_f32 v110, v110
    v_cvt_pk_bf16_f32 v158, v108, v109
    v_exp_f32 v111, v111
    ds_read_b128 v[164:167], v42 offset:5216
    v_cvt_pk_bf16_f32 v159, v110, v111
    s_waitcnt vmcnt(12)
    s_mov_b64 exec, 1
    buffer_store_dword v11, v9, s[4:7], s38 offen offset:512
    s_mov_b64 exec, -1
    v_mfma_f32_32x32x16_bf16 v[96:111], v[68:71], v[52:55], v[128:143]
    v_exp_f32 v80, v80
    v_exp_f32 v81, v81
    s_add_u32 s15, s14, 24576
    buffer_load_dwordx4 v[240:243], v1, s[4:7], s15 offen offset:0
    v_exp_f32 v82, v82
    v_cvt_pk_bf16_f32 v144, v80, v81
    v_exp_f32 v83, v83
    v_exp_f32 v84, v84
    v_cvt_pk_bf16_f32 v145, v82, v83
    s_waitcnt lgkmcnt(0)
    v_mfma_f32_32x32x16_bf16 v[176:191], v[160:163], v[152:155], v[176:191]
    v_exp_f32 v85, v85
    v_exp_f32 v86, v86
    v_cvt_pk_bf16_f32 v146, v84, v85
    ds_read_b128 v[168:171], v42 offset:8320
    v_exp_f32 v87, v87
    v_exp_f32 v88, v88
    v_cvt_pk_bf16_f32 v147, v86, v87
    buffer_load_dwordx4 v[244:247], v1, s[4:7], s15 offen offset:1024
    v_exp_f32 v89, v89
    v_exp_f32 v90, v90
    v_cvt_pk_bf16_f32 v148, v88, v89
    v_mfma_f32_32x32x16_bf16 v[176:191], v[164:167], v[156:159], v[176:191]
    v_exp_f32 v91, v91
    v_exp_f32 v92, v92
    v_cvt_pk_bf16_f32 v149, v90, v91
    v_exp_f32 v93, v93
    s_add_u32 s15, s14, 28672
    buffer_load_dwordx4 v[248:251], v1, s[4:7], s15 offen offset:0
    v_exp_f32 v94, v94
    v_cvt_pk_bf16_f32 v150, v92, v93
    v_exp_f32 v95, v95
    ds_read_b128 v[172:175], v42 offset:9376
    v_cvt_pk_bf16_f32 v151, v94, v95
    v_mfma_f32_32x32x16_bf16 v[80:95], v[72:75], v[52:55], v[128:143]
    v_exp_f32 v96, v96
    v_exp_f32 v97, v97
    buffer_load_dwordx4 v[252:255], v1, s[4:7], s15 offen offset:1024
    v_exp_f32 v98, v98
    v_cvt_pk_bf16_f32 v152, v96, v97
    v_exp_f32 v99, v99
    s_add_u32 s62, s14, 0
    buffer_load_dwordx4 v[112:115], v1, s[4:7], s62 offen offset:2048
    v_exp_f32 v100, v100
    v_cvt_pk_bf16_f32 v153, v98, v99
    s_waitcnt lgkmcnt(0)
    v_mfma_f32_32x32x16_bf16 v[176:191], v[168:171], v[144:147], v[176:191]
    v_exp_f32 v101, v101
    v_exp_f32 v102, v102
    v_cvt_pk_bf16_f32 v154, v100, v101
    ds_read_b128 v[160:163], v42 offset:12480
    v_exp_f32 v103, v103
    v_exp_f32 v104, v104
    v_cvt_pk_bf16_f32 v155, v102, v103
    v_exp_f32 v105, v105
    v_exp_f32 v106, v106
    v_cvt_pk_bf16_f32 v156, v104, v105
    v_mfma_f32_32x32x16_bf16 v[176:191], v[172:175], v[148:151], v[176:191]
    v_exp_f32 v107, v107
    buffer_load_dwordx4 v[116:119], v1, s[4:7], s62 offen offset:3072
    v_exp_f32 v108, v108
    v_cvt_pk_bf16_f32 v157, v106, v107
    v_exp_f32 v109, v109
    v_exp_f32 v110, v110
    v_cvt_pk_bf16_f32 v158, v108, v109
    v_exp_f32 v111, v111
    ds_read_b128 v[164:167], v42 offset:13536
    v_cvt_pk_bf16_f32 v159, v110, v111
    v_mfma_f32_32x32x16_bf16 v[96:111], v[76:79], v[52:55], v[128:143]
    v_exp_f32 v80, v80
    v_exp_f32 v81, v81
    v_exp_f32 v82, v82
    v_cvt_pk_bf16_f32 v144, v80, v81
    v_exp_f32 v83, v83
    s_add_u32 s62, s14, 4096
    buffer_load_dwordx4 v[120:123], v1, s[4:7], s62 offen offset:2048
    v_exp_f32 v84, v84
    v_cvt_pk_bf16_f32 v145, v82, v83
    s_waitcnt lgkmcnt(0)
    v_mfma_f32_32x32x16_bf16 v[176:191], v[160:163], v[152:155], v[176:191]
    v_exp_f32 v85, v85
    v_exp_f32 v86, v86
    v_cvt_pk_bf16_f32 v146, v84, v85
    ds_read_b128 v[168:171], v42 offset:16640
    v_exp_f32 v87, v87
    v_exp_f32 v88, v88
    v_cvt_pk_bf16_f32 v147, v86, v87
    v_exp_f32 v89, v89
    v_exp_f32 v90, v90
    v_cvt_pk_bf16_f32 v148, v88, v89
    v_mfma_f32_32x32x16_bf16 v[176:191], v[164:167], v[156:159], v[176:191]
    v_exp_f32 v91, v91
    buffer_load_dwordx4 v[124:127], v1, s[4:7], s62 offen offset:3072
    v_exp_f32 v92, v92
    v_cvt_pk_bf16_f32 v149, v90, v91
    v_exp_f32 v93, v93
    v_exp_f32 v94, v94
    v_cvt_pk_bf16_f32 v150, v92, v93
    v_exp_f32 v95, v95
    ds_read_b128 v[172:175], v42 offset:17696
    v_cvt_pk_bf16_f32 v151, v94, v95
    v_mfma_f32_32x32x16_bf16 v[80:95], a[240:243], v[52:55], v[128:143]
    v_exp_f32 v96, v96
    v_exp_f32 v97, v97
    s_add_u32 s62, s14, 8192
    buffer_load_dwordx4 v[56:59], v1, s[4:7], s62 offen offset:2048
    v_exp_f32 v98, v98
    v_cvt_pk_bf16_f32 v152, v96, v97
    v_exp_f32 v99, v99
    buffer_load_dwordx4 v[60:63], v1, s[4:7], s62 offen offset:3072
    v_exp_f32 v100, v100
    v_cvt_pk_bf16_f32 v153, v98, v99
    s_waitcnt lgkmcnt(0)
    v_mfma_f32_32x32x16_bf16 v[176:191], v[168:171], v[144:147], v[176:191]
    v_exp_f32 v101, v101
    v_exp_f32 v102, v102
    v_cvt_pk_bf16_f32 v154, v100, v101
    ds_read_b128 v[160:163], v42 offset:20800
    v_exp_f32 v103, v103
    s_add_u32 s62, s14, 12288
    buffer_load_dwordx4 v[64:67], v1, s[4:7], s62 offen offset:2048
    v_exp_f32 v104, v104
    v_cvt_pk_bf16_f32 v155, v102, v103
    v_exp_f32 v105, v105
    buffer_load_dwordx4 v[68:71], v1, s[4:7], s62 offen offset:3072
    v_exp_f32 v106, v106
    v_cvt_pk_bf16_f32 v156, v104, v105
    v_mfma_f32_32x32x16_bf16 v[176:191], v[172:175], v[148:151], v[176:191]
    v_exp_f32 v107, v107
    v_exp_f32 v108, v108
    v_cvt_pk_bf16_f32 v157, v106, v107
    v_exp_f32 v109, v109
    v_exp_f32 v110, v110
    v_cvt_pk_bf16_f32 v158, v108, v109
    v_exp_f32 v111, v111
    ds_read_b128 v[164:167], v42 offset:21856
    v_cvt_pk_bf16_f32 v159, v110, v111
    v_mfma_f32_32x32x16_bf16 v[96:111], a[244:247], v[52:55], v[128:143]
    v_exp_f32 v80, v80
    v_exp_f32 v81, v81
    s_add_u32 s62, s14, 16384
    buffer_load_dwordx4 v[72:75], v1, s[4:7], s62 offen offset:2048
    v_exp_f32 v82, v82
    v_cvt_pk_bf16_f32 v144, v80, v81
    v_exp_f32 v83, v83
    buffer_load_dwordx4 v[76:79], v1, s[4:7], s62 offen offset:3072
    v_exp_f32 v84, v84
    v_cvt_pk_bf16_f32 v145, v82, v83
    s_waitcnt lgkmcnt(0)
    v_mfma_f32_32x32x16_bf16 v[176:191], v[160:163], v[152:155], v[176:191]
    v_exp_f32 v85, v85
    v_exp_f32 v86, v86
    v_cvt_pk_bf16_f32 v146, v84, v85
    ds_read_b128 v[168:171], v42 offset:24960
    v_exp_f32 v87, v87
    v_exp_f32 v88, v88
    v_cvt_pk_bf16_f32 v147, v86, v87
    v_exp_f32 v89, v89
    v_exp_f32 v90, v90
    v_cvt_pk_bf16_f32 v148, v88, v89
    v_mfma_f32_32x32x16_bf16 v[176:191], v[164:167], v[156:159], v[176:191]
    v_exp_f32 v91, v91
    v_exp_f32 v92, v92
    v_cvt_pk_bf16_f32 v149, v90, v91
    v_exp_f32 v93, v93
    v_exp_f32 v94, v94
    v_cvt_pk_bf16_f32 v150, v92, v93
    v_exp_f32 v95, v95
    ds_read_b128 v[172:175], v42 offset:26016
    v_cvt_pk_bf16_f32 v151, v94, v95
    v_exp_f32 v96, v96
    v_exp_f32 v97, v97
    s_add_u32 s62, s14, 20480
    buffer_load_dwordx4 v[80:83], v1, s[4:7], s62 offen offset:2048
    v_exp_f32 v98, v98
    v_cvt_pk_bf16_f32 v152, v96, v97
    v_exp_f32 v99, v99
    buffer_load_dwordx4 v[84:87], v1, s[4:7], s62 offen offset:3072
    v_exp_f32 v100, v100
    v_cvt_pk_bf16_f32 v153, v98, v99
    s_waitcnt lgkmcnt(0)
    v_mfma_f32_32x32x16_bf16 v[176:191], v[168:171], v[144:147], v[176:191]
    v_exp_f32 v101, v101
    v_exp_f32 v102, v102
    v_cvt_pk_bf16_f32 v154, v100, v101
    ds_read_b128 v[160:163], v42 offset:29120
    ds_read_b128 v[164:167], v42 offset:30176
    v_exp_f32 v103, v103
    s_add_u32 s62, s14, 24576
    buffer_load_dwordx4 v[88:91], v1, s[4:7], s62 offen offset:2048
    v_exp_f32 v104, v104
    v_cvt_pk_bf16_f32 v155, v102, v103
    v_exp_f32 v105, v105
    buffer_load_dwordx4 v[92:95], v1, s[4:7], s62 offen offset:3072
    v_exp_f32 v106, v106
    v_cvt_pk_bf16_f32 v156, v104, v105
    v_mfma_f32_32x32x16_bf16 v[176:191], v[172:175], v[148:151], v[176:191]
    v_exp_f32 v107, v107
    v_exp_f32 v108, v108
    v_cvt_pk_bf16_f32 v157, v106, v107
    s_add_u32 s62, s14, 28672
    buffer_load_dwordx4 v[128:131], v1, s[4:7], s62 offen offset:2048
    v_exp_f32 v109, v109
    s_waitcnt lgkmcnt(0)
    v_mfma_f32_32x32x16_bf16 v[176:191], v[160:163], v[152:155], v[176:191]
    v_exp_f32 v110, v110
    v_cvt_pk_bf16_f32 v158, v108, v109
    buffer_load_dwordx4 v[132:135], v1, s[4:7], s62 offen offset:3072
    v_exp_f32 v111, v111
    s_nop 0
    v_cvt_pk_bf16_f32 v159, v110, v111
    s_nop 1
    v_mfma_f32_32x32x16_bf16 v[176:191], v[164:167], v[156:159], v[176:191]
    s_lshr_b32 s30, s20, 1
    s_add_u32 s30, s30, s29
    s_lshl_b32 s30, s30, 15
    s_and_b32 s31, s20, 1
    s_lshl_b32 s31, s31, 14
    s_add_u32 s30, s30, s31
    s_add_u32 s30, s30, 19922944
    v_add_u32 v15, s30, v1
    s_mov_b32 s31, 4096
    s_mov_b32 s32, 8192
    s_mov_b32 s33, 12288
    buffer_load_dword v46, v10, s[4:7], s27 offen offset:512 sc1
    v_rcp_f32 v184, v184
    s_nop 0
    v_mul_f32 v176, v176, v184
    v_mul_f32 v177, v177, v184
    v_mul_f32 v178, v178, v184
    v_mul_f32 v179, v179, v184
    v_mul_f32 v180, v180, v184
    v_mul_f32 v181, v181, v184
    v_mul_f32 v182, v182, v184
    v_mul_f32 v183, v183, v184
    v_cvt_pk_bf16_f32 v188, v176, v177
    v_cvt_pk_bf16_f32 v189, v178, v179
    v_cvt_pk_bf16_f32 v190, v180, v181
    v_cvt_pk_bf16_f32 v191, v182, v183
    buffer_store_dwordx4 v[188:191], v1, s[4:7], s96 offen offset:1024 sc1
    s_waitcnt vmcnt(1)
    v_cmp_ne_u32 vcc, v11, v46
    s_nop 0
    s_and_b64 vcc, vcc, s[60:61]
    s_cbranch_scc0 S_8
    s_mov_b64 exec, s[60:61]
    buffer_load_dword v45, v10, s[4:7], s27 offen offset:512 sc1
    s_waitcnt vmcnt(0)
    v_cmp_ne_u32 vcc, v11, v45
    s_mov_b64 exec, 1
    buffer_store_dword v11, v9, s[4:7], s38 offen offset:768
    s_mov_b64 exec, -1
    s_cbranch_vccz S_9
    s_mov_b64 exec, s[60:61]
S_10:
    buffer_load_dword v45, v10, s[4:7], s27 offen offset:512 sc1
    s_waitcnt vmcnt(0)
    v_cmp_ne_u32 vcc, v11, v45
    s_nop 0
    s_cbranch_vccz S_9
    s_add_u32 s39, s39, 1
    s_cmp_lt_u32 s39, 200000
    s_cbranch_scc1 S_10
S_9:
    s_mov_b64 exec, -1
S_8:
    buffer_load_dwordx4 v[96:99], v15, s[4:7], 0 offen offset:0 sc1
    buffer_load_dwordx4 v[100:103], v15, s[4:7], 0 offen offset:2048 sc1
    buffer_load_dwordx4 v[104:107], v15, s[4:7], s31 offen offset:0 sc1
    buffer_load_dwordx4 v[108:111], v15, s[4:7], s31 offen offset:2048 sc1
    buffer_load_dwordx4 v[136:139], v15, s[4:7], s32 offen offset:0 sc1
    buffer_load_dwordx4 v[140:143], v15, s[4:7], s32 offen offset:2048 sc1
    buffer_load_dwordx4 v[144:147], v15, s[4:7], s33 offen offset:0 sc1
    buffer_load_dwordx4 v[148:151], v15, s[4:7], s33 offen offset:2048 sc1
    s_waitcnt vmcnt(8)
    s_mov_b64 exec, 1
    buffer_store_dword v11, v9, s[4:7], s38 offen offset:768
    s_mov_b64 exec, -1
    buffer_load_dwordx4 a[40:43], v1, s[4:7], s12 offen offset:2048
    buffer_load_dwordx4 a[44:47], v1, s[4:7], s12 offen offset:3072
    s_add_u32 s12, s8, 12288
    buffer_load_dwordx4 a[48:51], v1, s[4:7], s12 offen offset:0
    buffer_load_dwordx4 a[52:55], v1, s[4:7], s12 offen offset:1024
    s_mov_b64 exec, s[60:61]
S_12:
    buffer_load_dword v45, v10, s[4:7], s27 offen offset:768 sc1
    s_waitcnt vmcnt(0)
    v_cmp_ne_u32 vcc, v11, v45
    s_nop 0
    s_cbranch_vccz S_11
    s_add_u32 s39, s39, 1
    s_cmp_lt_u32 s39, 200000
    s_cbranch_scc1 S_12
S_11:
    s_mov_b64 exec, -1
    buffer_load_dwordx4 v[152:155], v15, s[4:7], 0 offen offset:1024 sc1
    buffer_load_dwordx4 v[156:159], v15, s[4:7], 0 offen offset:3072 sc1
    buffer_load_dwordx4 v[48:51], v15, s[4:7], s31 offen offset:1024 sc1
    buffer_load_dwordx4 v[52:55], v15, s[4:7], s31 offen offset:3072 sc1
    buffer_load_dwordx4 a[240:243], v15, s[4:7], s32 offen offset:1024 sc1
    buffer_load_dwordx4 a[244:247], v15, s[4:7], s32 offen offset:3072 sc1
    buffer_load_dwordx4 a[248:251], v15, s[4:7], s33 offen offset:1024 sc1
    buffer_load_dwordx4 a[252:255], v15, s[4:7], s33 offen offset:3072 sc1
    s_barrier
    v_mfma_f32_32x32x16_bf16 v[160:175], v[192:195], v[96:99], 0
    v_mfma_f32_32x32x16_bf16 v[176:191], v[196:199], v[96:99], 0
    v_mfma_f32_32x32x16_bf16 v[160:175], v[200:203], v[100:103], v[160:175]
    v_mfma_f32_32x32x16_bf16 v[176:191], v[204:207], v[100:103], v[176:191]
    v_mfma_f32_32x32x16_bf16 v[160:175], v[208:211], v[104:107], v[160:175]
    v_mfma_f32_32x32x16_bf16 v[176:191], v[212:215], v[104:107], v[176:191]
    v_mfma_f32_32x32x16_bf16 v[160:175], v[216:219], v[108:111], v[160:175]
    v_mfma_f32_32x32x16_bf16 v[176:191], v[220:223], v[108:111], v[176:191]
    v_mfma_f32_32x32x16_bf16 v[160:175], v[224:227], v[136:139], v[160:175]
    v_mfma_f32_32x32x16_bf16 v[176:191], v[228:231], v[136:139], v[176:191]
    v_mfma_f32_32x32x16_bf16 v[160:175], v[232:235], v[140:143], v[160:175]
    v_mfma_f32_32x32x16_bf16 v[176:191], v[236:239], v[140:143], v[176:191]
    v_mfma_f32_32x32x16_bf16 v[160:175], v[240:243], v[144:147], v[160:175]
    v_mfma_f32_32x32x16_bf16 v[176:191], v[244:247], v[144:147], v[176:191]
    v_mfma_f32_32x32x16_bf16 v[160:175], v[248:251], v[148:151], v[160:175]
    v_mfma_f32_32x32x16_bf16 v[176:191], v[252:255], v[148:151], v[176:191]
    s_mul_i32 s100, s20, 4096
    s_add_u32 m0, s100, 98304
    s_mul_i32 s101, s22, 114688
    s_add_u32 s101, s101, s100
    s_add_u32 s101, s101, 3506176
    buffer_load_dwordx4 v1, s[4:7], s101 offen offset:0 lds
    buffer_load_dwordx4 v1, s[4:7], s101 offen offset:1024 lds
    buffer_load_dwordx4 v1, s[4:7], s101 offen offset:2048 lds
    buffer_load_dwordx4 v1, s[4:7], s101 offen offset:3072 lds
    s_waitcnt vmcnt(11)
    v_mfma_f32_32x32x16_bf16 v[160:175], v[112:115], v[152:155], v[160:175]
    v_mfma_f32_32x32x16_bf16 v[176:191], v[116:119], v[152:155], v[176:191]
    buffer_load_dwordx4 a[56:59], v1, s[4:7], s9 offen offset:0
    s_waitcnt vmcnt(11)
    v_mfma_f32_32x32x16_bf16 v[160:175], v[120:123], v[156:159], v[160:175]
    v_mfma_f32_32x32x16_bf16 v[176:191], v[124:127], v[156:159], v[176:191]
    buffer_load_dwordx4 a[60:63], v1, s[4:7], s9 offen offset:1024
    s_waitcnt vmcnt(11)
    v_mfma_f32_32x32x16_bf16 v[160:175], v[56:59], v[48:51], v[160:175]
    v_mfma_f32_32x32x16_bf16 v[176:191], v[60:63], v[48:51], v[176:191]
    buffer_load_dwordx4 a[64:67], v1, s[4:7], s9 offen offset:2048
    s_waitcnt vmcnt(11)
    v_mfma_f32_32x32x16_bf16 v[160:175], v[64:67], v[52:55], v[160:175]
    v_mfma_f32_32x32x16_bf16 v[176:191], v[68:71], v[52:55], v[176:191]
    buffer_load_dwordx4 a[68:71], v1, s[4:7], s9 offen offset:3072
    s_waitcnt vmcnt(11)
    v_mfma_f32_32x32x16_bf16 v[160:175], v[72:75], a[240:243], v[160:175]
    v_mfma_f32_32x32x16_bf16 v[176:191], v[76:79], a[240:243], v[176:191]
    s_add_u32 s12, s9, 4096
    buffer_load_dwordx4 a[72:75], v1, s[4:7], s12 offen offset:0
    s_waitcnt vmcnt(11)
    v_mfma_f32_32x32x16_bf16 v[160:175], v[80:83], a[244:247], v[160:175]
    v_mfma_f32_32x32x16_bf16 v[176:191], v[84:87], a[244:247], v[176:191]
    buffer_load_dwordx4 a[76:79], v1, s[4:7], s12 offen offset:1024
    s_waitcnt vmcnt(11)
    v_mfma_f32_32x32x16_bf16 v[160:175], v[88:91], a[248:251], v[160:175]
    v_mfma_f32_32x32x16_bf16 v[176:191], v[92:95], a[248:251], v[176:191]
    s_waitcnt vmcnt(10)
    v_mfma_f32_32x32x16_bf16 v[160:175], v[128:131], a[252:255], v[160:175]
    v_mfma_f32_32x32x16_bf16 v[176:191], v[132:135], a[252:255], v[176:191]
    s_lshl_b32 s31, s28, 15
    s_add_u32 s30, s31, 16777216
    v_add_u32 v15, s30, v1
    s_nop 7
    ds_write_b128 v12, v[160:163] offset:0
    ds_write_b128 v12, v[164:167] offset:32
    ds_write_b128 v12, v[168:171] offset:64
    ds_write_b128 v12, v[172:175] offset:96
    ds_write_b128 v12, v[176:179] offset:128
    ds_write_b128 v12, v[180:183] offset:160
    ds_write_b128 v12, v[184:187] offset:192
    ds_write_b128 v12, v[188:191] offset:224
    s_waitcnt lgkmcnt(0)
    s_barrier
    ds_read_b128 v[48:51], v13 offset:0
    ds_read_b128 v[52:55], v13 offset:16
    ds_read_b128 v[56:59], v13 offset:8704
    ds_read_b128 v[60:63], v13 offset:8720
    ds_read_b128 v[64:67], v13 offset:17408
    ds_read_b128 v[68:71], v13 offset:17424
    ds_read_b128 v[72:75], v13 offset:26112
    ds_read_b128 v[76:79], v13 offset:26128
    s_waitcnt lgkmcnt(4)
    v_pk_add_f32 v[16:17], v[16:17], v[48:49]
    v_pk_add_f32 v[18:19], v[18:19], v[50:51]
    v_pk_add_f32 v[20:21], v[20:21], v[52:53]
    v_pk_add_f32 v[22:23], v[22:23], v[54:55]
    v_pk_add_f32 v[16:17], v[16:17], v[56:57]
    v_pk_add_f32 v[18:19], v[18:19], v[58:59]
    v_pk_add_f32 v[20:21], v[20:21], v[60:61]
    v_pk_add_f32 v[22:23], v[22:23], v[62:63]
    v_cvt_pk_bf16_f32 v112, v16, v17
    v_cvt_pk_bf16_f32 v113, v18, v19
    v_cvt_pk_bf16_f32 v114, v20, v21
    v_cvt_pk_bf16_f32 v115, v22, v23
    buffer_store_dwordx4 v[112:115], v5, s[4:7], 0 offen
    s_waitcnt lgkmcnt(0)
    v_pk_add_f32 v[24:25], v[24:25], v[64:65]
    v_pk_add_f32 v[26:27], v[26:27], v[66:67]
    v_pk_add_f32 v[28:29], v[28:29], v[68:69]
    v_pk_add_f32 v[30:31], v[30:31], v[70:71]
    v_pk_add_f32 v[24:25], v[24:25], v[72:73]
    v_pk_add_f32 v[26:27], v[26:27], v[74:75]
    v_pk_add_f32 v[28:29], v[28:29], v[76:77]
    v_pk_add_f32 v[30:31], v[30:31], v[78:79]
    v_cvt_pk_bf16_f32 v120, v24, v25
    v_cvt_pk_bf16_f32 v121, v26, v27
    v_cvt_pk_bf16_f32 v122, v28, v29
    v_cvt_pk_bf16_f32 v123, v30, v31
    buffer_store_dwordx4 v[120:123], v5, s[4:7], s63 offen
    v_pk_add_f32 v[116:117], v[16:17], v[18:19]
    v_pk_add_f32 v[124:125], v[24:25], v[26:27]
    v_pk_mul_f32 v[118:119], v[16:17], v[16:17]
    v_pk_mul_f32 v[126:127], v[24:25], v[24:25]
    v_pk_fma_f32 v[118:119], v[18:19], v[18:19], v[118:119]
    v_pk_fma_f32 v[126:127], v[26:27], v[26:27], v[126:127]
    v_pk_add_f32 v[116:117], v[116:117], v[20:21]
    v_pk_add_f32 v[124:125], v[124:125], v[28:29]
    v_pk_fma_f32 v[118:119], v[20:21], v[20:21], v[118:119]
    v_pk_fma_f32 v[126:127], v[28:29], v[28:29], v[126:127]
    v_pk_add_f32 v[116:117], v[116:117], v[22:23]
    v_pk_add_f32 v[124:125], v[124:125], v[30:31]
    v_pk_fma_f32 v[118:119], v[22:23], v[22:23], v[118:119]
    v_pk_fma_f32 v[126:127], v[30:31], v[30:31], v[126:127]
    v_add_f32 v116, v116, v117
    v_add_f32 v124, v124, v125
    v_add_f32 v118, v118, v119
    v_add_f32 v126, v126, v127
    s_nop 0
    v_permlane16_swap_b32 v116, v118
    v_permlane16_swap_b32 v124, v126
    v_add_f32 v116, v116, v118
    v_add_f32 v124, v124, v126
    s_nop 0
    v_add_f32_dpp v116, v116, v116 row_ror:8 row_mask:0xf bank_mask:0xf
    v_add_f32_dpp v124, v124, v124 row_ror:8 row_mask:0xf bank_mask:0xf
    v_mov_b32 v118, v116
    v_mov_b32 v126, v124
    s_nop 0
    v_permlane32_swap_b32 v116, v118
    v_permlane32_swap_b32 v124, v126
    v_add_f32 v116, v116, v118
    v_add_f32 v124, v124, v126
    s_mov_b64 exec, 0xff00ff
    buffer_store_dword v116, v7, s[4:7], 0 offen offset:0
    s_mov_b64 exec, -1
    s_mov_b64 exec, 0xff00ff
    buffer_store_dword v124, v7, s[4:7], 0 offen offset:2048
    s_mov_b64 exec, -1
    s_waitcnt vmcnt(0)
    s_mov_b32 exec_lo, 1
    s_mov_b32 exec_hi, 1
    buffer_store_dword v11, v10, s[4:7], s0 offen offset:1024
    s_mov_b64 exec, -1
    s_barrier
    s_mov_b64 exec, 0xffffffff
S_14:
    buffer_load_dword v45, v10, s[4:7], s34 offen offset:1024 sc1
    s_waitcnt vmcnt(0)
    v_cmp_ne_u32 vcc, v11, v45
    s_nop 0
    s_cbranch_vccz S_13
    s_add_u32 s39, s39, 1
    s_cmp_lt_u32 s39, 200000
    s_cbranch_scc1 S_14
S_13:
    s_mov_b64 exec, -1
    buffer_load_dwordx4 v[48:51], v15, s[4:7], s40 offen offset:0 sc1
    buffer_load_dwordx4 v[52:55], v15, s[4:7], s40 offen offset:1024 sc1
    buffer_load_dwordx4 v[56:59], v15, s[4:7], s40 offen offset:2048 sc1
    buffer_load_dwordx4 v[60:63], v15, s[4:7], s40 offen offset:3072 sc1
    buffer_load_dwordx2 v[240:241], v8, s[4:7], 0 offen offset:0 sc1
    buffer_load_dwordx2 v[242:243], v8, s[4:7], 0 offen offset:256 sc1
    buffer_load_dwordx2 v[244:245], v8, s[4:7], 0 offen offset:512 sc1
    buffer_load_dwordx2 v[246:247], v8, s[4:7], 0 offen offset:768 sc1
    buffer_load_dwordx4 v[64:67], v15, s[4:7], s41 offen offset:0 sc1
    buffer_load_dwordx4 v[68:71], v15, s[4:7], s41 offen offset:1024 sc1
    buffer_load_dwordx4 v[72:75], v15, s[4:7], s41 offen offset:2048 sc1
    buffer_load_dwordx4 v[76:79], v15, s[4:7], s41 offen offset:3072 sc1
    buffer_load_dwordx4 v[80:83], v15, s[4:7], s42 offen offset:0 sc1
    buffer_load_dwordx4 v[84:87], v15, s[4:7], s42 offen offset:1024 sc1
    v_mad_u32_u24 v46, s48, 7, v6
    ds_read_b128 v[160:163], v46 offset:0
    ds_read_b128 v[164:167], v46 offset:1024
    ds_read_b128 v[168:171], v46 offset:2048
    ds_read_b128 v[172:175], v46 offset:3584
    ds_read_b128 v[176:179], v46 offset:4608
    ds_read_b128 v[180:183], v46 offset:5632
    s_waitcnt vmcnt(13) lgkmcnt(3)
    v_mfma_f32_32x32x16_bf16 v[192:207], v[160:163], v[48:51], 0
    ds_read_b128 v[184:187], v46 offset:7168
    v_mfma_f32_32x32x16_bf16 v[208:223], v[164:167], v[48:51], 0
    ds_read_b128 v[188:191], v46 offset:8192
    buffer_load_dwordx4 v[88:91], v15, s[4:7], s42 offen offset:2048 sc1
    v_mfma_f32_32x32x16_bf16 v[224:239], v[168:171], v[48:51], 0
    ds_read_b128 v[160:163], v46 offset:9216
    s_waitcnt vmcnt(13) lgkmcnt(3)
    v_mfma_f32_32x32x16_bf16 v[192:207], v[172:175], v[52:55], v[192:207]
    ds_read_b128 v[164:167], v46 offset:10752
    v_mfma_f32_32x32x16_bf16 v[208:223], v[176:179], v[52:55], v[208:223]
    ds_read_b128 v[168:171], v46 offset:11776
    buffer_load_dwordx4 v[92:95], v15, s[4:7], s42 offen offset:3072 sc1
    v_mfma_f32_32x32x16_bf16 v[224:239], v[180:183], v[52:55], v[224:239]
    ds_read_b128 v[172:175], v46 offset:12800
    s_waitcnt vmcnt(13) lgkmcnt(3)
    v_mfma_f32_32x32x16_bf16 v[192:207], v[184:187], v[56:59], v[192:207]
    v_mad_u32_u24 v47, s49, 7, v6
    ds_read_b128 v[176:179], v47 offset:0
    v_mfma_f32_32x32x16_bf16 v[208:223], v[188:191], v[56:59], v[208:223]
    ds_read_b128 v[180:183], v47 offset:1024
    buffer_load_dwordx4 v[96:99], v15, s[4:7], s43 offen offset:0 sc1
    v_mfma_f32_32x32x16_bf16 v[224:239], v[160:163], v[56:59], v[224:239]
    ds_read_b128 v[184:187], v47 offset:2048
    s_waitcnt vmcnt(13) lgkmcnt(3)
    v_mfma_f32_32x32x16_bf16 v[192:207], v[164:167], v[60:63], v[192:207]
    ds_read_b128 v[188:191], v47 offset:3584
    v_mfma_f32_32x32x16_bf16 v[208:223], v[168:171], v[60:63], v[208:223]
    ds_read_b128 v[160:163], v47 offset:4608
    buffer_load_dwordx4 v[100:103], v15, s[4:7], s43 offen offset:1024 sc1
    v_mfma_f32_32x32x16_bf16 v[224:239], v[172:175], v[60:63], v[224:239]
    ds_read_b128 v[164:167], v47 offset:5632
    s_waitcnt vmcnt(9) lgkmcnt(3)
    v_mfma_f32_32x32x16_bf16 v[192:207], v[176:179], v[64:67], v[192:207]
    ds_read_b128 v[168:171], v47 offset:7168
    v_mfma_f32_32x32x16_bf16 v[208:223], v[180:183], v[64:67], v[208:223]
    ds_read_b128 v[172:175], v47 offset:8192
    buffer_load_dwordx4 v[104:107], v15, s[4:7], s43 offen offset:2048 sc1
    v_add_f32 v240, v240, v242
    v_mfma_f32_32x32x16_bf16 v[224:239], v[184:187], v[64:67], v[224:239]
    ds_read_b128 v[176:179], v47 offset:9216
    v_add_f32 v244, v244, v246
    s_waitcnt vmcnt(9) lgkmcnt(3)
    v_mfma_f32_32x32x16_bf16 v[192:207], v[188:191], v[68:71], v[192:207]
    ds_read_b128 v[180:183], v47 offset:10752
    v_add_f32 v241, v241, v243
    v_mfma_f32_32x32x16_bf16 v[208:223], v[160:163], v[68:71], v[208:223]
    ds_read_b128 v[184:187], v47 offset:11776
    buffer_load_dwordx4 v[108:111], v15, s[4:7], s43 offen offset:3072 sc1
    v_add_f32 v245, v245, v247
    v_mfma_f32_32x32x16_bf16 v[224:239], v[164:167], v[68:71], v[224:239]
    ds_read_b128 v[188:191], v47 offset:12800
    v_add_f32 v240, v240, v244
    s_waitcnt vmcnt(9) lgkmcnt(3)
    v_mfma_f32_32x32x16_bf16 v[192:207], v[168:171], v[72:75], v[192:207]
    v_mad_u32_u24 v46, s50, 7, v6
    ds_read_b128 v[160:163], v46 offset:0
    v_add_f32 v241, v241, v245
    v_mfma_f32_32x32x16_bf16 v[208:223], v[172:175], v[72:75], v[208:223]
    ds_read_b128 v[164:167], v46 offset:1024
    buffer_load_dwordx4 v[112:115], v15, s[4:7], s44 offen offset:0 sc1
    v_mov_b32 v242, v240
    v_mfma_f32_32x32x16_bf16 v[224:239], v[176:179], v[72:75], v[224:239]
    ds_read_b128 v[168:171], v46 offset:2048
    v_mov_b32 v243, v241
    s_waitcnt vmcnt(9) lgkmcnt(3)
    v_mfma_f32_32x32x16_bf16 v[192:207], v[180:183], v[76:79], v[192:207]
    ds_read_b128 v[172:175], v46 offset:3584
    v_mov_b32 v250, 0
    v_mfma_f32_32x32x16_bf16 v[208:223], v[184:187], v[76:79], v[208:223]
    ds_read_b128 v[176:179], v46 offset:4608
    buffer_load_dwordx4 v[116:119], v15, s[4:7], s44 offen offset:1024 sc1
    v_permlane32_swap_b32 v240, v242
    v_mfma_f32_32x32x16_bf16 v[224:239], v[188:191], v[76:79], v[224:239]
    ds_read_b128 v[180:183], v46 offset:5632
    v_permlane32_swap_b32 v241, v243
    s_waitcnt vmcnt(9) lgkmcnt(3)
    v_mfma_f32_32x32x16_bf16 v[192:207], v[160:163], v[80:83], v[192:207]
    ds_read_b128 v[184:187], v46 offset:7168
    v_add_f32 v240, v240, v242
    v_mfma_f32_32x32x16_bf16 v[208:223], v[164:167], v[80:83], v[208:223]
    ds_read_b128 v[188:191], v46 offset:8192
    buffer_load_dwordx4 v[120:123], v15, s[4:7], s44 offen offset:2048 sc1
    v_add_f32 v241, v241, v243
    v_mfma_f32_32x32x16_bf16 v[224:239], v[168:171], v[80:83], v[224:239]
    ds_read_b128 v[160:163], v46 offset:9216
    v_mul_f32 v240, 0xbb000000, v240
    s_waitcnt vmcnt(9) lgkmcnt(3)
    v_mfma_f32_32x32x16_bf16 v[192:207], v[172:175], v[84:87], v[192:207]
    ds_read_b128 v[164:167], v46 offset:10752
    v_mul_f32 v241, 0x3b000000, v241
    v_mfma_f32_32x32x16_bf16 v[208:223], v[176:179], v[84:87], v[208:223]
    ds_read_b128 v[168:171], v46 offset:11776
    buffer_load_dwordx4 v[124:127], v15, s[4:7], s44 offen offset:3072 sc1
    v_fma_f32 v241, -v240, v240, v241
    v_mfma_f32_32x32x16_bf16 v[224:239], v[180:183], v[84:87], v[224:239]
    ds_read_b128 v[172:175], v46 offset:12800
    v_max_f32 v241, 0, v241
    s_waitcnt vmcnt(9) lgkmcnt(3)
    v_mfma_f32_32x32x16_bf16 v[192:207], v[184:187], v[88:91], v[192:207]
    v_mad_u32_u24 v47, s51, 7, v6
    ds_read_b128 v[176:179], v47 offset:0
    v_add_f32 v241, 0x3727c5ac, v241
    v_mfma_f32_32x32x16_bf16 v[208:223], v[188:191], v[88:91], v[208:223]
    ds_read_b128 v[180:183], v47 offset:1024
    buffer_load_dwordx4 v[128:131], v15, s[4:7], s45 offen offset:0 sc1
    v_rsq_f32 v252, v241
    v_mfma_f32_32x32x16_bf16 v[224:239], v[160:163], v[88:91], v[224:239]
    ds_read_b128 v[184:187], v47 offset:2048
    v_cvt_pk_bf16_f32 v242, v240, v240
    s_waitcnt vmcnt(9) lgkmcnt(3)
    v_mfma_f32_32x32x16_bf16 v[192:207], v[164:167], v[92:95], v[192:207]
    ds_read_b128 v[188:191], v47 offset:3584
    v_and_b32 v243, 0xffff0000, v242
    v_mfma_f32_32x32x16_bf16 v[208:223], v[168:171], v[92:95], v[208:223]
    ds_read_b128 v[160:163], v47 offset:4608
    buffer_load_dwordx4 v[132:135], v15, s[4:7], s45 offen offset:1024 sc1
    v_sub_f32 v243, v240, v243
    v_mfma_f32_32x32x16_bf16 v[224:239], v[172:175], v[92:95], v[224:239]
    ds_read_b128 v[164:167], v47 offset:5632
    v_lshrrev_b32 v249, 5, v0
    s_waitcnt vmcnt(9) lgkmcnt(3)
    v_mfma_f32_32x32x16_bf16 v[192:207], v[176:179], v[96:99], v[192:207]
    ds_read_b128 v[168:171], v47 offset:7168
    v_add_u32 v249, -1, v249
    v_mfma_f32_32x32x16_bf16 v[208:223], v[180:183], v[96:99], v[208:223]
    ds_read_b128 v[172:175], v47 offset:8192
    buffer_load_dwordx4 v[136:139], v15, s[4:7], s45 offen offset:2048 sc1
    v_cvt_pk_bf16_f32 v242, v240, v243
    v_mfma_f32_32x32x16_bf16 v[224:239], v[184:187], v[96:99], v[224:239]
    ds_read_b128 v[176:179], v47 offset:9216
    v_mov_b32 v251, 0
    s_waitcnt vmcnt(9) lgkmcnt(3)
    v_mfma_f32_32x32x16_bf16 v[192:207], v[188:191], v[100:103], v[192:207]
    ds_read_b128 v[180:183], v47 offset:10752
    v_mov_b32 v253, v252
    v_mfma_f32_32x32x16_bf16 v[208:223], v[160:163], v[100:103], v[208:223]
    ds_read_b128 v[184:187], v47 offset:11776
    buffer_load_dwordx4 v[140:143], v15, s[4:7], s45 offen offset:3072 sc1
    v_and_b32 v248, v249, v242
    v_mfma_f32_32x32x16_bf16 v[224:239], v[164:167], v[100:103], v[224:239]
    ds_read_b128 v[188:191], v47 offset:12800
    v_mov_b32 v249, v248
    s_waitcnt vmcnt(9) lgkmcnt(3)
    v_mfma_f32_32x32x16_bf16 v[192:207], v[168:171], v[104:107], v[192:207]
    v_mad_u32_u24 v46, s52, 7, v6
    ds_read_b128 v[160:163], v46 offset:0
    v_mul_f32 v254, 0xbfb8aa3b, v252
    v_mfma_f32_32x32x16_bf16 v[208:223], v[172:175], v[104:107], v[208:223]
    ds_read_b128 v[164:167], v46 offset:1024
    buffer_load_dwordx4 v[144:147], v15, s[4:7], s46 offen offset:0 sc1
    v_mov_b32 v255, v254
    v_mfma_f32_32x32x16_bf16 v[224:239], v[176:179], v[104:107], v[224:239]
    ds_read_b128 v[168:171], v46 offset:2048
    s_waitcnt vmcnt(9) lgkmcnt(3)
    v_mfma_f32_32x32x16_bf16 v[192:207], v[180:183], v[108:111], v[192:207]
    ds_read_b128 v[172:175], v46 offset:3584
    v_mfma_f32_32x32x16_bf16 v[208:223], v[184:187], v[108:111], v[208:223]
    ds_read_b128 v[176:179], v46 offset:4608
    buffer_load_dwordx4 v[148:151], v15, s[4:7], s46 offen offset:1024 sc1
    v_mfma_f32_32x32x16_bf16 v[224:239], v[188:191], v[108:111], v[224:239]
    ds_read_b128 v[180:183], v46 offset:5632
    s_waitcnt vmcnt(9) lgkmcnt(3)
    v_mfma_f32_32x32x16_bf16 v[192:207], v[160:163], v[112:115], v[192:207]
    ds_read_b128 v[184:187], v46 offset:7168
    v_mfma_f32_32x32x16_bf16 v[208:223], v[164:167], v[112:115], v[208:223]
    ds_read_b128 v[188:191], v46 offset:8192
    buffer_load_dwordx4 v[152:155], v15, s[4:7], s46 offen offset:2048 sc1
    v_mfma_f32_32x32x16_bf16 v[224:239], v[168:171], v[112:115], v[224:239]
    ds_read_b128 v[160:163], v46 offset:9216
    v_mfma_f32_32x32x16_bf16 v[192:207], a[230:233], v[248:251], v[192:207]
    v_mfma_f32_32x32x16_bf16 v[208:223], a[232:235], v[248:251], v[208:223]
    v_mfma_f32_32x32x16_bf16 v[224:239], a[234:237], v[248:251], v[224:239]
    s_waitcnt vmcnt(9) lgkmcnt(3)
    v_mfma_f32_32x32x16_bf16 v[192:207], v[172:175], v[116:119], v[192:207]
    ds_read_b128 v[164:167], v46 offset:10752
    v_mfma_f32_32x32x16_bf16 v[208:223], v[176:179], v[116:119], v[208:223]
    ds_read_b128 v[168:171], v46 offset:11776
    buffer_load_dwordx4 v[156:159], v15, s[4:7], s46 offen offset:3072 sc1
    v_mfma_f32_32x32x16_bf16 v[224:239], v[180:183], v[116:119], v[224:239]
    ds_read_b128 v[172:175], v46 offset:12800
    s_waitcnt vmcnt(9) lgkmcnt(3)
    v_mfma_f32_32x32x16_bf16 v[192:207], v[184:187], v[120:123], v[192:207]
    v_mad_u32_u24 v47, s53, 7, v6
    ds_read_b128 v[176:179], v47 offset:0
    v_mfma_f32_32x32x16_bf16 v[208:223], v[188:191], v[120:123], v[208:223]
    ds_read_b128 v[180:183], v47 offset:1024
    buffer_load_dwordx4 a[240:243], v15, s[4:7], s47 offen offset:0 sc1
    v_mfma_f32_32x32x16_bf16 v[224:239], v[160:163], v[120:123], v[224:239]
    ds_read_b128 v[184:187], v47 offset:2048
    s_waitcnt vmcnt(9) lgkmcnt(3)
    v_mfma_f32_32x32x16_bf16 v[192:207], v[164:167], v[124:127], v[192:207]
    ds_read_b128 v[188:191], v47 offset:3584
    v_mfma_f32_32x32x16_bf16 v[208:223], v[168:171], v[124:127], v[208:223]
    ds_read_b128 v[160:163], v47 offset:4608
    buffer_load_dwordx4 a[244:247], v15, s[4:7], s47 offen offset:1024 sc1
    v_mfma_f32_32x32x16_bf16 v[224:239], v[172:175], v[124:127], v[224:239]
    ds_read_b128 v[164:167], v47 offset:5632
    s_waitcnt vmcnt(9) lgkmcnt(3)
    v_mfma_f32_32x32x16_bf16 v[192:207], v[176:179], v[128:131], v[192:207]
    ds_read_b128 v[168:171], v47 offset:7168
    v_mfma_f32_32x32x16_bf16 v[208:223], v[180:183], v[128:131], v[208:223]
    ds_read_b128 v[172:175], v47 offset:8192
    buffer_load_dwordx4 a[248:251], v15, s[4:7], s47 offen offset:2048 sc1
    v_mfma_f32_32x32x16_bf16 v[224:239], v[184:187], v[128:131], v[224:239]
    ds_read_b128 v[176:179], v47 offset:9216
    s_waitcnt vmcnt(9) lgkmcnt(3)
    v_mfma_f32_32x32x16_bf16 v[192:207], v[188:191], v[132:135], v[192:207]
    ds_read_b128 v[180:183], v47 offset:10752
    v_mfma_f32_32x32x16_bf16 v[208:223], v[160:163], v[132:135], v[208:223]
    ds_read_b128 v[184:187], v47 offset:11776
    buffer_load_dwordx4 a[252:255], v15, s[4:7], s47 offen offset:3072 sc1
    v_mfma_f32_32x32x16_bf16 v[224:239], v[164:167], v[132:135], v[224:239]
    ds_read_b128 v[188:191], v47 offset:12800
    s_waitcnt vmcnt(9) lgkmcnt(3)
    v_mfma_f32_32x32x16_bf16 v[192:207], v[168:171], v[136:139], v[192:207]
    v_mad_u32_u24 v46, s54, 7, v6
    ds_read_b128 v[160:163], v46 offset:0
    buffer_load_dwordx4 a[80:83], v1, s[4:7], s12 offen offset:2048
    v_mfma_f32_32x32x16_bf16 v[208:223], v[172:175], v[136:139], v[208:223]
    ds_read_b128 v[164:167], v46 offset:1024
    buffer_load_dwordx4 a[84:87], v1, s[4:7], s12 offen offset:3072
    v_mfma_f32_32x32x16_bf16 v[224:239], v[176:179], v[136:139], v[224:239]
    ds_read_b128 v[168:171], v46 offset:2048
    s_waitcnt vmcnt(10) lgkmcnt(3)
    v_mfma_f32_32x32x16_bf16 v[192:207], v[180:183], v[140:143], v[192:207]
    ds_read_b128 v[172:175], v46 offset:3584
    s_add_u32 s12, s9, 8192
    buffer_load_dwordx4 a[88:91], v1, s[4:7], s12 offen offset:0
    v_mfma_f32_32x32x16_bf16 v[208:223], v[184:187], v[140:143], v[208:223]
    ds_read_b128 v[176:179], v46 offset:4608
    buffer_load_dwordx4 a[92:95], v1, s[4:7], s12 offen offset:1024
    v_mfma_f32_32x32x16_bf16 v[224:239], v[188:191], v[140:143], v[224:239]
    ds_read_b128 v[180:183], v46 offset:5632
    s_waitcnt vmcnt(11) lgkmcnt(3)
    v_mfma_f32_32x32x16_bf16 v[192:207], v[160:163], v[144:147], v[192:207]
    ds_read_b128 v[184:187], v46 offset:7168
    buffer_load_dwordx4 a[96:99], v1, s[4:7], s12 offen offset:2048
    v_mfma_f32_32x32x16_bf16 v[208:223], v[164:167], v[144:147], v[208:223]
    ds_read_b128 v[188:191], v46 offset:8192
    buffer_load_dwordx4 a[100:103], v1, s[4:7], s12 offen offset:3072
    v_mfma_f32_32x32x16_bf16 v[224:239], v[168:171], v[144:147], v[224:239]
    ds_read_b128 v[160:163], v46 offset:9216
    s_mul_i32 s30, s28, 114688
    s_mul_i32 s31, s22, 7168
    s_add_u32 s30, s30, s31
    s_add_u32 s96, s30, 22020096
    s_add_u32 s97, s96, 4096
    s_waitcnt vmcnt(12) lgkmcnt(3)
    v_mfma_f32_32x32x16_bf16 v[192:207], v[172:175], v[148:151], v[192:207]
    ds_read_b128 v[164:167], v46 offset:10752
    s_add_u32 s12, s9, 12288
    buffer_load_dwordx4 a[104:107], v1, s[4:7], s12 offen offset:0
    v_mfma_f32_32x32x16_bf16 v[208:223], v[176:179], v[148:151], v[208:223]
    ds_read_b128 v[168:171], v46 offset:11776
    buffer_load_dwordx4 a[108:111], v1, s[4:7], s12 offen offset:1024
    v_mfma_f32_32x32x16_bf16 v[224:239], v[180:183], v[148:151], v[224:239]
    ds_read_b128 v[172:175], v46 offset:12800
    s_waitcnt vmcnt(13) lgkmcnt(3)
    v_mfma_f32_32x32x16_bf16 v[192:207], v[184:187], v[152:155], v[192:207]
    v_mad_u32_u24 v47, s55, 7, v6
    ds_read_b128 v[176:179], v47 offset:0
    buffer_load_dwordx4 a[112:115], v1, s[4:7], s10 offen offset:0
    v_mfma_f32_32x32x16_bf16 v[208:223], v[188:191], v[152:155], v[208:223]
    ds_read_b128 v[180:183], v47 offset:1024
    buffer_load_dwordx4 a[116:119], v1, s[4:7], s10 offen offset:1024
    v_mfma_f32_32x32x16_bf16 v[224:239], v[160:163], v[152:155], v[224:239]
    ds_read_b128 v[184:187], v47 offset:2048
    s_getpc_b64 s[30:31]
PC_15:
    s_add_u32 s30, s30, M_l1-PC_15
    s_addc_u32 s31, s31, 0
    s_lshr_b32 s32, s2, 3
    s_lshl_b32 s32, s32, 2
    s_add_u32 s32, s32, s20
    s_lshl_b32 s32, s32, 8
    v_add_u32 v2, s32, v10
    global_load_dword v2, v2, s[30:31]
    s_waitcnt vmcnt(15) lgkmcnt(3)
    v_mfma_f32_32x32x16_bf16 v[192:207], v[164:167], v[156:159], v[192:207]
    ds_read_b128 v[188:191], v47 offset:3584
    buffer_load_dwordx4 a[120:123], v1, s[4:7], s10 offen offset:2048
    v_mfma_f32_32x32x16_bf16 v[208:223], v[168:171], v[156:159], v[208:223]
    ds_read_b128 v[160:163], v47 offset:4608
    buffer_load_dwordx4 a[124:127], v1, s[4:7], s10 offen offset:3072
    v_mfma_f32_32x32x16_bf16 v[224:239], v[172:175], v[156:159], v[224:239]
    ds_read_b128 v[164:167], v47 offset:5632
    s_waitcnt vmcnt(16) lgkmcnt(3)
    v_mfma_f32_32x32x16_bf16 v[192:207], v[176:179], a[240:243], v[192:207]
    ds_read_b128 v[168:171], v47 offset:7168
    s_add_u32 s12, s10, 4096
    buffer_load_dwordx4 a[128:131], v1, s[4:7], s12 offen offset:0
    v_mfma_f32_32x32x16_bf16 v[208:223], v[180:183], a[240:243], v[208:223]
    ds_read_b128 v[172:175], v47 offset:8192
    buffer_load_dwordx4 a[132:135], v1, s[4:7], s12 offen offset:1024
    v_mfma_f32_32x32x16_bf16 v[224:239], v[184:187], a[240:243], v[224:239]
    ds_read_b128 v[176:179], v47 offset:9216
    s_waitcnt vmcnt(17) lgkmcnt(3)
    v_mfma_f32_32x32x16_bf16 v[192:207], v[188:191], a[244:247], v[192:207]
    ds_read_b128 v[180:183], v47 offset:10752
    buffer_load_dwordx4 a[136:139], v1, s[4:7], s12 offen offset:2048
    v_mfma_f32_32x32x16_bf16 v[208:223], v[160:163], a[244:247], v[208:223]
    ds_read_b128 v[184:187], v47 offset:11776
    buffer_load_dwordx4 a[140:143], v1, s[4:7], s12 offen offset:3072
    v_mfma_f32_32x32x16_bf16 v[224:239], v[164:167], a[244:247], v[224:239]
    ds_read_b128 v[188:191], v47 offset:12800
    s_waitcnt vmcnt(18) lgkmcnt(3)
    v_mfma_f32_32x32x16_bf16 v[192:207], v[168:171], a[248:251], v[192:207]
    s_add_u32 s12, s10, 8192
    buffer_load_dwordx4 a[144:147], v1, s[4:7], s12 offen offset:0
    v_mfma_f32_32x32x16_bf16 v[208:223], v[172:175], a[248:251], v[208:223]
    buffer_load_dwordx4 a[148:151], v1, s[4:7], s12 offen offset:1024
    v_mfma_f32_32x32x16_bf16 v[224:239], v[176:179], a[248:251], v[224:239]
    v_mad_u32_u24 v46, s48, 7, v6
    s_waitcnt vmcnt(19) lgkmcnt(0)
    v_mfma_f32_32x32x16_bf16 v[192:207], v[180:183], a[252:255], v[192:207]
    buffer_load_dwordx4 a[152:155], v1, s[4:7], s12 offen offset:2048
    v_mfma_f32_32x32x16_bf16 v[208:223], v[184:187], a[252:255], v[208:223]
    buffer_load_dwordx4 a[156:159], v1, s[4:7], s12 offen offset:3072
    v_mfma_f32_32x32x16_bf16 v[224:239], v[188:191], a[252:255], v[224:239]
    ds_read_b128 v[160:163], v46 offset:3072
    ds_read_b128 v[164:167], v46 offset:6656
    ds_read_b128 v[168:171], v46 offset:10240
    v_mfma_f32_32x32x16_bf16 v[176:191], a[236:239], v[248:251], 0
    s_waitcnt lgkmcnt(1)
    v_mfma_f32_32x32x16_bf16 v[176:191], v[160:163], v[48:51], v[176:191]
    ds_read_b128 v[172:175], v46 offset:13824
    s_add_u32 s12, s10, 12288
    buffer_load_dwordx4 a[160:163], v1, s[4:7], s12 offen offset:0
    v_mfma_f32_32x32x16_bf16 v[176:191], v[164:167], v[52:55], v[176:191]
    v_mad_u32_u24 v47, s49, 7, v6
    ds_read_b128 v[160:163], v47 offset:3072
    v_mul_f32 v240, v254, v192
    v_mul_f32 v241, v254, v193
    v_mul_f32 v242, v254, v194
    v_mul_f32 v243, v254, v195
    v_mul_f32 v244, v254, v196
    v_mul_f32 v245, v254, v197
    s_waitcnt lgkmcnt(1)
    v_mfma_f32_32x32x16_bf16 v[176:191], v[168:171], v[56:59], v[176:191]
    ds_read_b128 v[164:167], v47 offset:6656
    v_mul_f32 v246, v254, v198
    v_mul_f32 v247, v254, v199
    v_exp_f32 v240, v240
    v_mul_f32 v192, v252, v192
    v_exp_f32 v241, v241
    v_mul_f32 v193, v252, v193
    buffer_load_dwordx4 a[164:167], v1, s[4:7], s12 offen offset:1024
    v_mfma_f32_32x32x16_bf16 v[176:191], v[172:175], v[60:63], v[176:191]
    ds_read_b128 v[168:171], v47 offset:10240
    v_exp_f32 v242, v242
    v_mul_f32 v194, v252, v194
    v_exp_f32 v243, v243
    v_mul_f32 v195, v252, v195
    v_exp_f32 v244, v244
    v_mul_f32 v196, v252, v196
    s_waitcnt lgkmcnt(1)
    v_mfma_f32_32x32x16_bf16 v[176:191], v[160:163], v[64:67], v[176:191]
    ds_read_b128 v[172:175], v47 offset:13824
    v_exp_f32 v245, v245
    v_mul_f32 v197, v252, v197
    v_exp_f32 v246, v246
    v_mul_f32 v198, v252, v198
    v_exp_f32 v247, v247
    v_mul_f32 v199, v252, v199
    buffer_load_dwordx4 a[168:171], v1, s[4:7], s11 offen offset:0
    v_mfma_f32_32x32x16_bf16 v[176:191], v[164:167], v[68:71], v[176:191]
    v_mad_u32_u24 v46, s50, 7, v6
    ds_read_b128 v[160:163], v46 offset:3072
    v_add_f32 v240, 1.0, v240
    v_add_f32 v241, 1.0, v241
    v_add_f32 v242, 1.0, v242
    v_add_f32 v243, 1.0, v243
    v_add_f32 v244, 1.0, v244
    v_add_f32 v245, 1.0, v245
    s_waitcnt lgkmcnt(1)
    v_mfma_f32_32x32x16_bf16 v[176:191], v[168:171], v[72:75], v[176:191]
    ds_read_b128 v[164:167], v46 offset:6656
    v_add_f32 v246, 1.0, v246
    v_add_f32 v247, 1.0, v247
    v_rcp_f32 v240, v240
    v_rcp_f32 v241, v241
    v_rcp_f32 v242, v242
    v_rcp_f32 v243, v243
    buffer_load_dwordx4 a[172:175], v1, s[4:7], s11 offen offset:1024
    v_mfma_f32_32x32x16_bf16 v[176:191], v[172:175], v[76:79], v[176:191]
    ds_read_b128 v[168:171], v46 offset:10240
    v_rcp_f32 v244, v244
    v_rcp_f32 v245, v245
    v_rcp_f32 v246, v246
    v_rcp_f32 v247, v247
    v_mul_f32 v192, v192, v240
    v_mul_f32 v193, v193, v241
    s_waitcnt lgkmcnt(1)
    v_mfma_f32_32x32x16_bf16 v[176:191], v[160:163], v[80:83], v[176:191]
    ds_read_b128 v[172:175], v46 offset:13824
    v_mul_f32 v194, v194, v242
    v_mul_f32 v195, v195, v243
    v_mul_f32 v196, v196, v244
    v_mul_f32 v197, v197, v245
    v_mul_f32 v198, v198, v246
    v_mul_f32 v199, v199, v247
    buffer_load_dwordx4 a[176:179], v1, s[4:7], s11 offen offset:2048
    v_mfma_f32_32x32x16_bf16 v[176:191], v[164:167], v[84:87], v[176:191]
    v_mad_u32_u24 v47, s51, 7, v6
    ds_read_b128 v[160:163], v47 offset:3072
    v_cvt_pk_bf16_f32 v192, v192, v193
    v_cvt_pk_bf16_f32 v193, v194, v195
    v_cvt_pk_bf16_f32 v194, v196, v197
    v_cvt_pk_bf16_f32 v195, v198, v199
    buffer_store_dwordx4 v[192:195], v1, s[4:7], s96 offen offset:0 sc1
    v_mul_f32 v240, v254, v200
    s_waitcnt lgkmcnt(1)
    v_mfma_f32_32x32x16_bf16 v[176:191], v[168:171], v[88:91], v[176:191]
    ds_read_b128 v[164:167], v47 offset:6656
    v_mul_f32 v241, v254, v201
    v_mul_f32 v242, v254, v202
    v_mul_f32 v243, v254, v203
    v_mul_f32 v244, v254, v204
    v_mul_f32 v245, v254, v205
    v_mul_f32 v246, v254, v206
    buffer_load_dwordx4 a[180:183], v1, s[4:7], s11 offen offset:3072
    v_mfma_f32_32x32x16_bf16 v[176:191], v[172:175], v[92:95], v[176:191]
    ds_read_b128 v[168:171], v47 offset:10240
    v_mul_f32 v247, v254, v207
    v_exp_f32 v240, v240
    v_mul_f32 v200, v252, v200
    v_exp_f32 v241, v241
    v_mul_f32 v201, v252, v201
    v_exp_f32 v242, v242
    s_waitcnt lgkmcnt(1)
    v_mfma_f32_32x32x16_bf16 v[176:191], v[160:163], v[96:99], v[176:191]
    ds_read_b128 v[172:175], v47 offset:13824
    v_mul_f32 v202, v252, v202
    v_exp_f32 v243, v243
    v_mul_f32 v203, v252, v203
    v_exp_f32 v244, v244
    v_mul_f32 v204, v252, v204
    v_exp_f32 v245, v245
    s_add_u32 s12, s11, 4096
    buffer_load_dwordx4 a[184:187], v1, s[4:7], s12 offen offset:0
    v_mfma_f32_32x32x16_bf16 v[176:191], v[164:167], v[100:103], v[176:191]
    v_mad_u32_u24 v46, s52, 7, v6
    ds_read_b128 v[160:163], v46 offset:3072
    v_mul_f32 v205, v252, v205
    v_exp_f32 v246, v246
    v_mul_f32 v206, v252, v206
    v_exp_f32 v247, v247
    v_mul_f32 v207, v252, v207
    v_add_f32 v240, 1.0, v240
    s_waitcnt lgkmcnt(1)
    v_mfma_f32_32x32x16_bf16 v[176:191], v[168:171], v[104:107], v[176:191]
    ds_read_b128 v[164:167], v46 offset:6656
    v_add_f32 v241, 1.0, v241
    v_add_f32 v242, 1.0, v242
    v_add_f32 v243, 1.0, v243
    v_add_f32 v244, 1.0, v244
    v_add_f32 v245, 1.0, v245
    v_add_f32 v246, 1.0, v246
    buffer_load_dwordx4 a[188:191], v1, s[4:7], s12 offen offset:1024
    v_mfma_f32_32x32x16_bf16 v[176:191], v[172:175], v[108:111], v[176:191]
    ds_read_b128 v[168:171], v46 offset:10240
    v_add_f32 v247, 1.0, v247
    v_rcp_f32 v240, v240
    v_rcp_f32 v241, v241
    v_rcp_f32 v242, v242
    v_rcp_f32 v243, v243
    v_rcp_f32 v244, v244
    s_waitcnt lgkmcnt(1)
    v_mfma_f32_32x32x16_bf16 v[176:191], v[160:163], v[112:115], v[176:191]
    ds_read_b128 v[172:175], v46 offset:13824
    v_rcp_f32 v245, v245
    v_rcp_f32 v246, v246
    v_rcp_f32 v247, v247
    v_mul_f32 v200, v200, v240
    v_mul_f32 v201, v201, v241
    v_mul_f32 v202, v202, v242
    buffer_load_dwordx4 a[192:195], v1, s[4:7], s12 offen offset:2048
    v_mfma_f32_32x32x16_bf16 v[176:191], v[164:167], v[116:119], v[176:191]
    v_mad_u32_u24 v47, s53, 7, v6
    ds_read_b128 v[160:163], v47 offset:3072
    v_mul_f32 v203, v203, v243
    v_mul_f32 v204, v204, v244
    v_mul_f32 v205, v205, v245
    v_mul_f32 v206, v206, v246
    v_mul_f32 v207, v207, v247
    v_cvt_pk_bf16_f32 v200, v200, v201
    s_waitcnt lgkmcnt(1)
    v_mfma_f32_32x32x16_bf16 v[176:191], v[168:171], v[120:123], v[176:191]
    ds_read_b128 v[164:167], v47 offset:6656
    v_cvt_pk_bf16_f32 v201, v202, v203
    v_cvt_pk_bf16_f32 v202, v204, v205
    v_cvt_pk_bf16_f32 v203, v206, v207
    buffer_store_dwordx4 v[200:203], v1, s[4:7], s96 offen offset:1024 sc1
    v_mul_f32 v240, v254, v208
    v_mul_f32 v241, v254, v209
    buffer_load_dwordx4 a[196:199], v1, s[4:7], s12 offen offset:3072
    v_mfma_f32_32x32x16_bf16 v[176:191], v[172:175], v[124:127], v[176:191]
    ds_read_b128 v[168:171], v47 offset:10240
    v_mul_f32 v242, v254, v210
    v_mul_f32 v243, v254, v211
    v_mul_f32 v244, v254, v212
    v_mul_f32 v245, v254, v213
    v_mul_f32 v246, v254, v214
    v_mul_f32 v247, v254, v215
    s_waitcnt lgkmcnt(1)
    v_mfma_f32_32x32x16_bf16 v[176:191], v[160:163], v[128:131], v[176:191]
    ds_read_b128 v[172:175], v47 offset:13824
    v_exp_f32 v240, v240
    v_mul_f32 v208, v252, v208
    v_exp_f32 v241, v241
    v_mul_f32 v209, v252, v209
    v_exp_f32 v242, v242
    v_mul_f32 v210, v252, v210
    s_add_u32 s12, s11, 8192
    buffer_load_dwordx4 a[200:203], v1, s[4:7], s12 offen offset:0
    v_mfma_f32_32x32x16_bf16 v[176:191], v[164:167], v[132:135], v[176:191]
    v_mad_u32_u24 v46, s54, 7, v6
    ds_read_b128 v[160:163], v46 offset:3072
    v_exp_f32 v243, v243
    v_mul_f32 v211, v252, v211
    v_exp_f32 v244, v244
    v_mul_f32 v212, v252, v212
    v_exp_f32 v245, v245
    v_mul_f32 v213, v252, v213
    s_waitcnt lgkmcnt(1)
    v_mfma_f32_32x32x16_bf16 v[176:191], v[168:171], v[136:139], v[176:191]
    ds_read_b128 v[164:167], v46 offset:6656
    v_exp_f32 v246, v246
    v_mul_f32 v214, v252, v214
    v_exp_f32 v247, v247
    v_mul_f32 v215, v252, v215
    v_add_f32 v240, 1.0, v240
    v_add_f32 v241, 1.0, v241
    buffer_load_dwordx4 a[204:207], v1, s[4:7], s12 offen offset:1024
    v_mfma_f32_32x32x16_bf16 v[176:191], v[172:175], v[140:143], v[176:191]
    ds_read_b128 v[168:171], v46 offset:10240
    v_add_f32 v242, 1.0, v242
    v_add_f32 v243, 1.0, v243
    v_add_f32 v244, 1.0, v244
    v_add_f32 v245, 1.0, v245
    v_add_f32 v246, 1.0, v246
    v_add_f32 v247, 1.0, v247
    s_waitcnt lgkmcnt(1)
    v_mfma_f32_32x32x16_bf16 v[176:191], v[160:163], v[144:147], v[176:191]
    ds_read_b128 v[172:175], v46 offset:13824
    v_rcp_f32 v240, v240
    v_rcp_f32 v241, v241
    v_rcp_f32 v242, v242
    v_rcp_f32 v243, v243
    v_rcp_f32 v244, v244
    v_rcp_f32 v245, v245
    buffer_load_dwordx4 a[208:211], v1, s[4:7], s12 offen offset:2048
    v_mfma_f32_32x32x16_bf16 v[176:191], v[164:167], v[148:151], v[176:191]
    v_mad_u32_u24 v47, s55, 7, v6
    ds_read_b128 v[160:163], v47 offset:3072
    v_rcp_f32 v246, v246
    v_rcp_f32 v247, v247
    v_mul_f32 v208, v208, v240
    v_mul_f32 v209, v209, v241
    v_mul_f32 v210, v210, v242
    v_mul_f32 v211, v211, v243
    s_waitcnt lgkmcnt(1)
    v_mfma_f32_32x32x16_bf16 v[176:191], v[168:171], v[152:155], v[176:191]
    ds_read_b128 v[164:167], v47 offset:6656
    v_mul_f32 v212, v212, v244
    v_mul_f32 v213, v213, v245
    v_mul_f32 v214, v214, v246
    v_mul_f32 v215, v215, v247
    v_cvt_pk_bf16_f32 v208, v208, v209
    v_cvt_pk_bf16_f32 v209, v210, v211
    buffer_load_dwordx4 a[212:215], v1, s[4:7], s12 offen offset:3072
    v_mfma_f32_32x32x16_bf16 v[176:191], v[172:175], v[156:159], v[176:191]
    ds_read_b128 v[168:171], v47 offset:10240
    v_cvt_pk_bf16_f32 v210, v212, v213
    v_cvt_pk_bf16_f32 v211, v214, v215
    buffer_store_dwordx4 v[208:211], v1, s[4:7], s96 offen offset:2048 sc1
    s_waitcnt lgkmcnt(1)
    v_mfma_f32_32x32x16_bf16 v[176:191], v[160:163], a[240:243], v[176:191]
    ds_read_b128 v[172:175], v47 offset:13824
    s_add_u32 s12, s11, 12288
    buffer_load_dwordx4 a[216:219], v1, s[4:7], s12 offen offset:0
    v_mfma_f32_32x32x16_bf16 v[176:191], v[164:167], a[244:247], v[176:191]
    s_waitcnt lgkmcnt(0)
    v_mfma_f32_32x32x16_bf16 v[176:191], v[168:171], a[248:251], v[176:191]
    buffer_load_dwordx4 a[220:223], v1, s[4:7], s12 offen offset:1024
    v_mfma_f32_32x32x16_bf16 v[176:191], v[172:175], a[252:255], v[176:191]
    s_mul_i32 s30, s29, 114688
    s_mul_i32 s31, s20, 28672
    s_add_u32 s30, s30, s31
    s_add_u32 s30, s30, 22020096
    v_add_u32 v15, s30, v1
    v_add_u32 v47, 4096, v15
    v_add_u32 v2, 114688, v15
    v_add_u32 v3, 118784, v15
    v_pk_mul_f32 v[240:241], v[254:255], v[216:217]
    v_pk_mul_f32 v[242:243], v[254:255], v[218:219]
    v_pk_mul_f32 v[244:245], v[254:255], v[220:221]
    v_pk_mul_f32 v[246:247], v[254:255], v[222:223]
    v_exp_f32 v240, v240
    v_exp_f32 v241, v241
    v_pk_mul_f32 v[216:217], v[252:253], v[216:217]
    v_exp_f32 v242, v242
    v_exp_f32 v243, v243
    v_pk_mul_f32 v[218:219], v[252:253], v[218:219]
    v_exp_f32 v244, v244
    v_exp_f32 v245, v245
    v_pk_mul_f32 v[220:221], v[252:253], v[220:221]
    v_exp_f32 v246, v246
    v_exp_f32 v247, v247
    v_pk_mul_f32 v[222:223], v[252:253], v[222:223]
    v_pk_add_f32 v[240:241], v[240:241], 1.0 op_sel_hi:[1,0]
    v_pk_add_f32 v[242:243], v[242:243], 1.0 op_sel_hi:[1,0]
    v_pk_add_f32 v[244:245], v[244:245], 1.0 op_sel_hi:[1,0]
    v_pk_add_f32 v[246:247], v[246:247], 1.0 op_sel_hi:[1,0]
    v_rcp_f32 v240, v240
    v_rcp_f32 v241, v241
    v_rcp_f32 v242, v242
    v_rcp_f32 v243, v243
    v_rcp_f32 v244, v244
    v_rcp_f32 v245, v245
    v_rcp_f32 v246, v246
    v_rcp_f32 v247, v247
    v_pk_mul_f32 v[216:217], v[216:217], v[240:241]
    v_pk_mul_f32 v[218:219], v[218:219], v[242:243]
    v_pk_mul_f32 v[220:221], v[220:221], v[244:245]
    v_pk_mul_f32 v[222:223], v[222:223], v[246:247]
    v_cvt_pk_bf16_f32 v216, v216, v217
    v_cvt_pk_bf16_f32 v217, v218, v219
    v_cvt_pk_bf16_f32 v218, v220, v221
    v_cvt_pk_bf16_f32 v219, v222, v223
    buffer_store_dwordx4 v[216:219], v1, s[4:7], s96 offen offset:3072 sc1
    s_waitcnt vmcnt(3)
    s_mov_b64 exec, 1
    buffer_store_dword v11, v9, s[4:7], s38 offen offset:1536
    s_mov_b64 exec, -1
    v_pk_mul_f32 v[240:241], v[254:255], v[224:225]
    v_pk_mul_f32 v[242:243], v[254:255], v[226:227]
    v_pk_mul_f32 v[244:245], v[254:255], v[228:229]
    v_pk_mul_f32 v[246:247], v[254:255], v[230:231]
    v_exp_f32 v240, v240
    v_exp_f32 v241, v241
    v_pk_mul_f32 v[224:225], v[252:253], v[224:225]
    v_exp_f32 v242, v242
    v_exp_f32 v243, v243
    v_pk_mul_f32 v[226:227], v[252:253], v[226:227]
    v_exp_f32 v244, v244
    v_exp_f32 v245, v245
    v_pk_mul_f32 v[228:229], v[252:253], v[228:229]
    v_exp_f32 v246, v246
    v_exp_f32 v247, v247
    v_pk_mul_f32 v[230:231], v[252:253], v[230:231]
    v_pk_add_f32 v[240:241], v[240:241], 1.0 op_sel_hi:[1,0]
    v_pk_add_f32 v[242:243], v[242:243], 1.0 op_sel_hi:[1,0]
    v_pk_add_f32 v[244:245], v[244:245], 1.0 op_sel_hi:[1,0]
    v_pk_add_f32 v[246:247], v[246:247], 1.0 op_sel_hi:[1,0]
    v_rcp_f32 v240, v240
    v_rcp_f32 v241, v241
    v_rcp_f32 v242, v242
    v_rcp_f32 v243, v243
    v_rcp_f32 v244, v244
    v_rcp_f32 v245, v245
    v_rcp_f32 v246, v246
    v_rcp_f32 v247, v247
    v_pk_mul_f32 v[224:225], v[224:225], v[240:241]
    v_pk_mul_f32 v[226:227], v[226:227], v[242:243]
    v_pk_mul_f32 v[228:229], v[228:229], v[244:245]
    v_pk_mul_f32 v[230:231], v[230:231], v[246:247]
    v_cvt_pk_bf16_f32 v224, v224, v225
    v_cvt_pk_bf16_f32 v225, v226, v227
    v_cvt_pk_bf16_f32 v226, v228, v229
    v_cvt_pk_bf16_f32 v227, v230, v231
    buffer_store_dwordx4 v[224:227], v1, s[4:7], s97 offen offset:0 sc1
    v_pk_mul_f32 v[240:241], v[254:255], v[232:233]
    v_pk_mul_f32 v[242:243], v[254:255], v[234:235]
    v_pk_mul_f32 v[244:245], v[254:255], v[236:237]
    v_pk_mul_f32 v[246:247], v[254:255], v[238:239]
    v_exp_f32 v240, v240
    v_exp_f32 v241, v241
    v_pk_mul_f32 v[232:233], v[252:253], v[232:233]
    v_exp_f32 v242, v242
    v_exp_f32 v243, v243
    v_pk_mul_f32 v[234:235], v[252:253], v[234:235]
    v_exp_f32 v244, v244
    v_exp_f32 v245, v245
    v_pk_mul_f32 v[236:237], v[252:253], v[236:237]
    v_exp_f32 v246, v246
    v_exp_f32 v247, v247
    v_pk_mul_f32 v[238:239], v[252:253], v[238:239]
    v_pk_add_f32 v[240:241], v[240:241], 1.0 op_sel_hi:[1,0]
    v_pk_add_f32 v[242:243], v[242:243], 1.0 op_sel_hi:[1,0]
    v_pk_add_f32 v[244:245], v[244:245], 1.0 op_sel_hi:[1,0]
    v_pk_add_f32 v[246:247], v[246:247], 1.0 op_sel_hi:[1,0]
    v_rcp_f32 v240, v240
    v_rcp_f32 v241, v241
    v_rcp_f32 v242, v242
    v_rcp_f32 v243, v243
    v_rcp_f32 v244, v244
    v_rcp_f32 v245, v245
    v_rcp_f32 v246, v246
    v_rcp_f32 v247, v247
    v_pk_mul_f32 v[232:233], v[232:233], v[240:241]
    v_pk_mul_f32 v[234:235], v[234:235], v[242:243]
    v_pk_mul_f32 v[236:237], v[236:237], v[244:245]
    v_pk_mul_f32 v[238:239], v[238:239], v[246:247]
    v_cvt_pk_bf16_f32 v232, v232, v233
    v_cvt_pk_bf16_f32 v233, v234, v235
    v_cvt_pk_bf16_f32 v234, v236, v237
    v_cvt_pk_bf16_f32 v235, v238, v239
    buffer_store_dwordx4 v[232:235], v1, s[4:7], s97 offen offset:1024 sc1
    buffer_load_dword v45, v10, s[4:7], s27 offen offset:1536 sc1
    v_pk_mul_f32 v[240:241], v[254:255], v[176:177]
    v_pk_mul_f32 v[242:243], v[254:255], v[178:179]
    v_pk_mul_f32 v[244:245], v[254:255], v[180:181]
    v_pk_mul_f32 v[246:247], v[254:255], v[182:183]
    v_exp_f32 v240, v240
    v_exp_f32 v241, v241
    v_pk_mul_f32 v[176:177], v[252:253], v[176:177]
    v_exp_f32 v242, v242
    v_exp_f32 v243, v243
    v_pk_mul_f32 v[178:179], v[252:253], v[178:179]
    v_exp_f32 v244, v244
    v_exp_f32 v245, v245
    v_pk_mul_f32 v[180:181], v[252:253], v[180:181]
    v_exp_f32 v246, v246
    v_exp_f32 v247, v247
    v_pk_mul_f32 v[182:183], v[252:253], v[182:183]
    v_pk_add_f32 v[240:241], v[240:241], 1.0 op_sel_hi:[1,0]
    v_pk_add_f32 v[242:243], v[242:243], 1.0 op_sel_hi:[1,0]
    v_pk_add_f32 v[244:245], v[244:245], 1.0 op_sel_hi:[1,0]
    v_pk_add_f32 v[246:247], v[246:247], 1.0 op_sel_hi:[1,0]
    v_rcp_f32 v240, v240
    v_rcp_f32 v241, v241
    v_rcp_f32 v242, v242
    v_rcp_f32 v243, v243
    v_rcp_f32 v244, v244
    v_rcp_f32 v245, v245
    v_rcp_f32 v246, v246
    v_rcp_f32 v247, v247
    v_pk_mul_f32 v[176:177], v[176:177], v[240:241]
    v_pk_mul_f32 v[178:179], v[178:179], v[242:243]
    v_pk_mul_f32 v[180:181], v[180:181], v[244:245]
    v_pk_mul_f32 v[182:183], v[182:183], v[246:247]
    v_cvt_pk_bf16_f32 v176, v176, v177
    v_cvt_pk_bf16_f32 v177, v178, v179
    v_cvt_pk_bf16_f32 v178, v180, v181
    v_cvt_pk_bf16_f32 v179, v182, v183
    buffer_store_dwordx4 v[176:179], v1, s[4:7], s97 offen offset:2048 sc1
    s_waitcnt vmcnt(1)
    v_cmp_ne_u32 vcc, v11, v45
    s_nop 0
    s_and_b64 vcc, vcc, s[36:37]
    s_cbranch_scc0 S_16
    s_mov_b64 exec, s[36:37]
    buffer_load_dword v45, v10, s[4:7], s27 offen offset:1536 sc1
    s_waitcnt vmcnt(0)
    v_cmp_ne_u32 vcc, v11, v45
    s_mov_b64 exec, 1
    buffer_store_dword v11, v9, s[4:7], s38 offen offset:1792
    s_mov_b64 exec, -1
    s_cbranch_vccz S_17
    s_mov_b64 exec, s[36:37]
S_18:
    buffer_load_dword v45, v10, s[4:7], s27 offen offset:1536 sc1
    s_waitcnt vmcnt(0)
    v_cmp_ne_u32 vcc, v11, v45
    s_nop 0
    s_cbranch_vccz S_17
    s_add_u32 s39, s39, 1
    s_cmp_lt_u32 s39, 200000
    s_cbranch_scc1 S_18
S_17:
    s_mov_b64 exec, -1
S_16:
    buffer_load_dwordx4 v[48:51], v15, s[4:7], s56 offen offset:0 sc1
    buffer_load_dwordx4 v[52:55], v15, s[4:7], s56 offen offset:1024 sc1
    buffer_load_dwordx4 v[56:59], v15, s[4:7], s56 offen offset:2048 sc1
    buffer_load_dwordx4 v[60:63], v15, s[4:7], s57 offen offset:0 sc1
    buffer_load_dwordx4 v[64:67], v15, s[4:7], s57 offen offset:1024 sc1
    buffer_load_dwordx4 v[68:71], v15, s[4:7], s57 offen offset:2048 sc1
    buffer_load_dwordx4 v[72:75], v15, s[4:7], s58 offen offset:0 sc1
    buffer_load_dwordx4 v[76:79], v15, s[4:7], s58 offen offset:1024 sc1
    s_waitcnt vmcnt(8)
    s_mov_b64 exec, 1
    buffer_store_dword v11, v9, s[4:7], s38 offen offset:1792
    s_mov_b64 exec, -1
    buffer_load_dwordx4 v[80:83], v15, s[4:7], s58 offen offset:2048 sc1
    buffer_load_dwordx4 v[84:87], v15, s[4:7], s59 offen offset:0 sc1
    buffer_load_dwordx4 v[88:91], v15, s[4:7], s59 offen offset:1024 sc1
    buffer_load_dwordx4 v[92:95], v15, s[4:7], s59 offen offset:2048 sc1
    buffer_load_dwordx4 v[96:99], v2, s[4:7], s56 offen offset:0 sc1
    buffer_load_dwordx4 v[100:103], v2, s[4:7], s56 offen offset:1024 sc1
    buffer_load_dwordx4 v[104:107], v2, s[4:7], s56 offen offset:2048 sc1
    buffer_load_dwordx4 v[108:111], v2, s[4:7], s57 offen offset:0 sc1
    s_barrier
    s_add_u32 s0, s0, 32768
    s_add_u32 s34, s34, 32768
    s_waitcnt vmcnt(16)
    v_mfma_f32_32x32x16_bf16 v[112:127], a[0:3], v[48:51], 0
    v_mfma_f32_32x32x16_bf16 v[128:143], a[4:7], v[48:51], 0
    buffer_load_dwordx4 v[48:51], v2, s[4:7], s57 offen offset:1024 sc1
    s_waitcnt vmcnt(16)
    v_mfma_f32_32x32x16_bf16 v[112:127], a[8:11], v[52:55], v[112:127]
    v_mfma_f32_32x32x16_bf16 v[128:143], a[12:15], v[52:55], v[128:143]
    buffer_load_dwordx4 v[52:55], v2, s[4:7], s57 offen offset:2048 sc1
    s_waitcnt vmcnt(16)
    v_mfma_f32_32x32x16_bf16 v[112:127], a[16:19], v[56:59], v[112:127]
    v_mfma_f32_32x32x16_bf16 v[128:143], a[20:23], v[56:59], v[128:143]
    buffer_load_dwordx4 v[56:59], v2, s[4:7], s58 offen offset:0 sc1
    buffer_load_dword v45, v10, s[4:7], s27 offen offset:1792 sc1
    s_waitcnt vmcnt(17)
    v_mfma_f32_32x32x16_bf16 v[112:127], a[56:59], v[60:63], v[112:127]
    v_mfma_f32_32x32x16_bf16 v[128:143], a[60:63], v[60:63], v[128:143]
    buffer_load_dwordx4 v[60:63], v2, s[4:7], s58 offen offset:1024 sc1
    s_waitcnt vmcnt(17)
    v_mfma_f32_32x32x16_bf16 v[112:127], a[64:67], v[64:67], v[112:127]
    v_mfma_f32_32x32x16_bf16 v[128:143], a[68:71], v[64:67], v[128:143]
    buffer_load_dwordx4 v[64:67], v2, s[4:7], s58 offen offset:2048 sc1
    s_mul_i32 s100, s20, 24576
    s_add_u32 m0, s100, 0
    s_mul_i32 s101, s22, 98304
    s_add_u32 s101, s101, s100
    s_add_u32 s101, s101, 6291456
    buffer_load_dwordx4 v1, s[4:7], s101 offen offset:0 lds
    s_waitcnt vmcnt(18)
    v_mfma_f32_32x32x16_bf16 v[112:127], a[72:75], v[68:71], v[112:127]
    v_mfma_f32_32x32x16_bf16 v[128:143], a[76:79], v[68:71], v[128:143]
    buffer_load_dwordx4 v[68:71], v2, s[4:7], s59 offen offset:0 sc1
    s_waitcnt vmcnt(18)
    v_mfma_f32_32x32x16_bf16 v[112:127], a[112:115], v[72:75], v[112:127]
    v_mfma_f32_32x32x16_bf16 v[128:143], a[116:119], v[72:75], v[128:143]
    buffer_load_dwordx4 v[72:75], v2, s[4:7], s59 offen offset:1024 sc1
    s_waitcnt vmcnt(18)
    v_mfma_f32_32x32x16_bf16 v[112:127], a[120:123], v[76:79], v[112:127]
    v_mfma_f32_32x32x16_bf16 v[128:143], a[124:127], v[76:79], v[128:143]
    buffer_load_dwordx4 v[76:79], v2, s[4:7], s59 offen offset:2048 sc1
    s_waitcnt vmcnt(6)
    v_cmp_ne_u32 vcc, v11, v45
    s_nop 0
    s_and_b64 vcc, vcc, s[36:37]
    s_cbranch_scc0 S_19
    s_mov_b64 exec, s[36:37]
S_21:
    buffer_load_dword v45, v10, s[4:7], s27 offen offset:1792 sc1
    s_waitcnt vmcnt(0)
    v_cmp_ne_u32 vcc, v11, v45
    s_nop 0
    s_cbranch_vccz S_20
    s_add_u32 s39, s39, 1
    s_cmp_lt_u32 s39, 200000
    s_cbranch_scc1 S_21
S_20:
    s_mov_b64 exec, -1
S_19:
    v_mfma_f32_32x32x16_bf16 v[112:127], a[128:131], v[80:83], v[112:127]
    v_mfma_f32_32x32x16_bf16 v[128:143], a[132:135], v[80:83], v[128:143]
    buffer_load_dwordx4 v[80:83], v15, s[4:7], s56 offen offset:3072 sc1
    v_mfma_f32_32x32x16_bf16 v[112:127], a[168:171], v[84:87], v[112:127]
    v_mfma_f32_32x32x16_bf16 v[128:143], a[172:175], v[84:87], v[128:143]
    buffer_load_dwordx4 v[84:87], v47, s[4:7], s56 offen offset:0 sc1
    buffer_load_dwordx4 v1, s[4:7], s101 offen offset:1024 lds
    v_mfma_f32_32x32x16_bf16 v[112:127], a[176:179], v[88:91], v[112:127]
    v_mfma_f32_32x32x16_bf16 v[128:143], a[180:183], v[88:91], v[128:143]
    buffer_load_dwordx4 v[88:91], v47, s[4:7], s56 offen offset:1024 sc1
    v_mfma_f32_32x32x16_bf16 v[112:127], a[184:187], v[92:95], v[112:127]
    v_mfma_f32_32x32x16_bf16 v[128:143], a[188:191], v[92:95], v[128:143]
    buffer_load_dwordx4 v[92:95], v47, s[4:7], s56 offen offset:2048 sc1
    v_mfma_f32_32x32x16_bf16 v[144:159], a[0:3], v[96:99], 0
    v_mfma_f32_32x32x16_bf16 v[160:175], a[4:7], v[96:99], 0
    buffer_load_dwordx4 v[96:99], v15, s[4:7], s57 offen offset:3072 sc1
    v_mfma_f32_32x32x16_bf16 v[144:159], a[8:11], v[100:103], v[144:159]
    v_mfma_f32_32x32x16_bf16 v[160:175], a[12:15], v[100:103], v[160:175]
    buffer_load_dwordx4 v[100:103], v47, s[4:7], s57 offen offset:0 sc1
    v_mfma_f32_32x32x16_bf16 v[144:159], a[16:19], v[104:107], v[144:159]
    v_mfma_f32_32x32x16_bf16 v[160:175], a[20:23], v[104:107], v[160:175]
    buffer_load_dwordx4 v[104:107], v47, s[4:7], s57 offen offset:1024 sc1
    buffer_load_dwordx4 v1, s[4:7], s101 offen offset:2048 lds
    v_mfma_f32_32x32x16_bf16 v[144:159], a[56:59], v[108:111], v[144:159]
    v_mfma_f32_32x32x16_bf16 v[160:175], a[60:63], v[108:111], v[160:175]
    buffer_load_dwordx4 v[108:111], v47, s[4:7], s57 offen offset:2048 sc1
    v_mfma_f32_32x32x16_bf16 v[144:159], a[64:67], v[48:51], v[144:159]
    v_mfma_f32_32x32x16_bf16 v[160:175], a[68:71], v[48:51], v[160:175]
    buffer_load_dwordx4 v[48:51], v15, s[4:7], s58 offen offset:3072 sc1
    v_mfma_f32_32x32x16_bf16 v[144:159], a[72:75], v[52:55], v[144:159]
    v_mfma_f32_32x32x16_bf16 v[160:175], a[76:79], v[52:55], v[160:175]
    buffer_load_dwordx4 v[52:55], v47, s[4:7], s58 offen offset:0 sc1
    v_mfma_f32_32x32x16_bf16 v[144:159], a[112:115], v[56:59], v[144:159]
    v_mfma_f32_32x32x16_bf16 v[160:175], a[116:119], v[56:59], v[160:175]
    buffer_load_dwordx4 v[56:59], v47, s[4:7], s58 offen offset:1024 sc1
    s_waitcnt vmcnt(18)
    v_mfma_f32_32x32x16_bf16 v[144:159], a[120:123], v[60:63], v[144:159]
    v_mfma_f32_32x32x16_bf16 v[160:175], a[124:127], v[60:63], v[160:175]
    buffer_load_dwordx4 v[60:63], v47, s[4:7], s58 offen offset:2048 sc1
    buffer_load_dwordx4 v1, s[4:7], s101 offen offset:3072 lds
    s_waitcnt vmcnt(19)
    v_mfma_f32_32x32x16_bf16 v[144:159], a[128:131], v[64:67], v[144:159]
    v_mfma_f32_32x32x16_bf16 v[160:175], a[132:135], v[64:67], v[160:175]
    buffer_load_dwordx4 v[64:67], v15, s[4:7], s59 offen offset:3072 sc1
    s_waitcnt vmcnt(18)
    v_mfma_f32_32x32x16_bf16 v[144:159], a[168:171], v[68:71], v[144:159]
    v_mfma_f32_32x32x16_bf16 v[160:175], a[172:175], v[68:71], v[160:175]
    buffer_load_dwordx4 v[68:71], v47, s[4:7], s59 offen offset:0 sc1
    s_waitcnt vmcnt(18)
    v_mfma_f32_32x32x16_bf16 v[144:159], a[176:179], v[72:75], v[144:159]
    v_mfma_f32_32x32x16_bf16 v[160:175], a[180:183], v[72:75], v[160:175]
    buffer_load_dwordx4 v[72:75], v47, s[4:7], s59 offen offset:1024 sc1
    s_waitcnt vmcnt(18)
    v_mfma_f32_32x32x16_bf16 v[144:159], a[184:187], v[76:79], v[144:159]
    v_mfma_f32_32x32x16_bf16 v[160:175], a[188:191], v[76:79], v[160:175]
    buffer_load_dwordx4 v[76:79], v47, s[4:7], s59 offen offset:2048 sc1
    s_waitcnt vmcnt(18)
    v_mfma_f32_32x32x16_bf16 v[112:127], a[24:27], v[80:83], v[112:127]
    v_mfma_f32_32x32x16_bf16 v[128:143], a[28:31], v[80:83], v[128:143]
    buffer_load_dwordx4 v[80:83], v2, s[4:7], s56 offen offset:3072 sc1
    s_add_u32 m0, m0, 4096
    s_add_u32 s101, s101, 4096
    buffer_load_dwordx4 v1, s[4:7], s101 offen offset:0 lds
    s_waitcnt vmcnt(19)
    v_mfma_f32_32x32x16_bf16 v[112:127], a[32:35], v[84:87], v[112:127]
    v_mfma_f32_32x32x16_bf16 v[128:143], a[36:39], v[84:87], v[128:143]
    buffer_load_dwordx4 v[84:87], v3, s[4:7], s56 offen offset:0 sc1
    s_waitcnt vmcnt(18)
    v_mfma_f32_32x32x16_bf16 v[112:127], a[40:43], v[88:91], v[112:127]
    v_mfma_f32_32x32x16_bf16 v[128:143], a[44:47], v[88:91], v[128:143]
    buffer_load_dwordx4 v[88:91], v3, s[4:7], s56 offen offset:1024 sc1
    s_waitcnt vmcnt(18)
    v_mfma_f32_32x32x16_bf16 v[112:127], a[48:51], v[92:95], v[112:127]
    v_mfma_f32_32x32x16_bf16 v[128:143], a[52:55], v[92:95], v[128:143]
    buffer_load_dwordx4 v[92:95], v3, s[4:7], s56 offen offset:2048 sc1
    s_waitcnt vmcnt(18)
    v_mfma_f32_32x32x16_bf16 v[112:127], a[80:83], v[96:99], v[112:127]
    v_mfma_f32_32x32x16_bf16 v[128:143], a[84:87], v[96:99], v[128:143]
    buffer_load_dwordx4 v[96:99], v2, s[4:7], s57 offen offset:3072 sc1
    s_waitcnt vmcnt(18)
    v_mfma_f32_32x32x16_bf16 v[112:127], a[88:91], v[100:103], v[112:127]
    v_mfma_f32_32x32x16_bf16 v[128:143], a[92:95], v[100:103], v[128:143]
    buffer_load_dwordx4 v[100:103], v3, s[4:7], s57 offen offset:0 sc1
    buffer_load_dwordx4 v1, s[4:7], s101 offen offset:1024 lds
    s_waitcnt vmcnt(19)
    v_mfma_f32_32x32x16_bf16 v[112:127], a[96:99], v[104:107], v[112:127]
    v_mfma_f32_32x32x16_bf16 v[128:143], a[100:103], v[104:107], v[128:143]
    buffer_load_dwordx4 v[104:107], v3, s[4:7], s57 offen offset:1024 sc1
    s_waitcnt vmcnt(18)
    v_mfma_f32_32x32x16_bf16 v[112:127], a[104:107], v[108:111], v[112:127]
    v_mfma_f32_32x32x16_bf16 v[128:143], a[108:111], v[108:111], v[128:143]
    buffer_load_dwordx4 v[108:111], v3, s[4:7], s57 offen offset:2048 sc1
    s_waitcnt vmcnt(18)
    v_mfma_f32_32x32x16_bf16 v[112:127], a[136:139], v[48:51], v[112:127]
    v_mfma_f32_32x32x16_bf16 v[128:143], a[140:143], v[48:51], v[128:143]
    buffer_load_dwordx4 v[48:51], v2, s[4:7], s58 offen offset:3072 sc1
    s_waitcnt vmcnt(18)
    v_mfma_f32_32x32x16_bf16 v[112:127], a[144:147], v[52:55], v[112:127]
    v_mfma_f32_32x32x16_bf16 v[128:143], a[148:151], v[52:55], v[128:143]
    buffer_load_dwordx4 v[52:55], v3, s[4:7], s58 offen offset:0 sc1
    s_waitcnt vmcnt(18)
    v_mfma_f32_32x32x16_bf16 v[112:127], a[152:155], v[56:59], v[112:127]
    v_mfma_f32_32x32x16_bf16 v[128:143], a[156:159], v[56:59], v[128:143]
    buffer_load_dwordx4 v[56:59], v3, s[4:7], s58 offen offset:1024 sc1
    buffer_load_dwordx4 v1, s[4:7], s101 offen offset:2048 lds
    s_waitcnt vmcnt(19)
    v_mfma_f32_32x32x16_bf16 v[112:127], a[160:163], v[60:63], v[112:127]
    v_mfma_f32_32x32x16_bf16 v[128:143], a[164:167], v[60:63], v[128:143]
    buffer_load_dwordx4 v[60:63], v3, s[4:7], s58 offen offset:2048 sc1
    s_waitcnt vmcnt(18)
    v_mfma_f32_32x32x16_bf16 v[112:127], a[192:195], v[64:67], v[112:127]
    v_mfma_f32_32x32x16_bf16 v[128:143], a[196:199], v[64:67], v[128:143]
    buffer_load_dwordx4 v[64:67], v2, s[4:7], s59 offen offset:3072 sc1
    s_waitcnt vmcnt(18)
    v_mfma_f32_32x32x16_bf16 v[112:127], a[200:203], v[68:71], v[112:127]
    v_mfma_f32_32x32x16_bf16 v[128:143], a[204:207], v[68:71], v[128:143]
    buffer_load_dwordx4 v[68:71], v3, s[4:7], s59 offen offset:0 sc1
    s_waitcnt vmcnt(18)
    v_mfma_f32_32x32x16_bf16 v[112:127], a[208:211], v[72:75], v[112:127]
    v_mfma_f32_32x32x16_bf16 v[128:143], a[212:215], v[72:75], v[128:143]
    buffer_load_dwordx4 v[72:75], v3, s[4:7], s59 offen offset:1024 sc1
    s_waitcnt vmcnt(18)
    v_mfma_f32_32x32x16_bf16 v[112:127], a[216:219], v[76:79], v[112:127]
    v_mfma_f32_32x32x16_bf16 v[128:143], a[220:223], v[76:79], v[128:143]
    buffer_load_dwordx4 v[76:79], v3, s[4:7], s59 offen offset:2048 sc1
    buffer_load_dwordx4 v1, s[4:7], s101 offen offset:3072 lds
    s_waitcnt vmcnt(19)
    v_mfma_f32_32x32x16_bf16 v[144:159], a[24:27], v[80:83], v[144:159]
    v_mfma_f32_32x32x16_bf16 v[160:175], a[28:31], v[80:83], v[160:175]
    s_add_u32 m0, m0, 4096
    s_add_u32 s101, s101, 4096
    buffer_load_dwordx4 v1, s[4:7], s101 offen offset:0 lds
    s_waitcnt vmcnt(18)
    v_mfma_f32_32x32x16_bf16 v[144:159], a[32:35], v[84:87], v[144:159]
    s_nop 0
    ds_write_b128 v12, v[112:115] offset:0
    v_mfma_f32_32x32x16_bf16 v[160:175], a[36:39], v[84:87], v[160:175]
    ds_write_b128 v12, v[116:119] offset:32
    buffer_load_dwordx4 v1, s[4:7], s101 offen offset:1024 lds
    s_waitcnt vmcnt(18)
    v_mfma_f32_32x32x16_bf16 v[144:159], a[40:43], v[88:91], v[144:159]
    ds_write_b128 v12, v[120:123] offset:64
    v_mfma_f32_32x32x16_bf16 v[160:175], a[44:47], v[88:91], v[160:175]
    ds_write_b128 v12, v[124:127] offset:96
    buffer_load_dwordx4 v1, s[4:7], s101 offen offset:2048 lds
    s_waitcnt vmcnt(18)
    v_mfma_f32_32x32x16_bf16 v[144:159], a[48:51], v[92:95], v[144:159]
    ds_write_b128 v12, v[128:131] offset:128
    v_mfma_f32_32x32x16_bf16 v[160:175], a[52:55], v[92:95], v[160:175]
    ds_write_b128 v12, v[132:135] offset:160
    buffer_load_dwordx4 v1, s[4:7], s101 offen offset:3072 lds
    s_waitcnt vmcnt(18)
    v_mfma_f32_32x32x16_bf16 v[144:159], a[80:83], v[96:99], v[144:159]
    ds_write_b128 v12, v[136:139] offset:192
    v_mfma_f32_32x32x16_bf16 v[160:175], a[84:87], v[96:99], v[160:175]
    ds_write_b128 v12, v[140:143] offset:224
    s_add_u32 m0, m0, 4096
    s_add_u32 s101, s101, 4096
    buffer_load_dwordx4 v1, s[4:7], s101 offen offset:0 lds
    s_waitcnt vmcnt(18)
    v_mfma_f32_32x32x16_bf16 v[144:159], a[88:91], v[100:103], v[144:159]
    v_mfma_f32_32x32x16_bf16 v[160:175], a[92:95], v[100:103], v[160:175]
    buffer_load_dwordx4 v1, s[4:7], s101 offen offset:1024 lds
    s_waitcnt lgkmcnt(0)
    s_barrier
    s_waitcnt vmcnt(17)
    v_mfma_f32_32x32x16_bf16 v[144:159], a[96:99], v[104:107], v[144:159]
    ds_read_b128 v[176:179], v13 offset:0
    ds_read_b128 v[180:183], v13 offset:16
    ds_read_b128 v[184:187], v13 offset:8704
    ds_read_b128 v[188:191], v13 offset:8720
    ds_read_b128 v[192:195], v13 offset:17408
    v_mfma_f32_32x32x16_bf16 v[160:175], a[100:103], v[104:107], v[160:175]
    ds_read_b128 v[196:199], v13 offset:17424
    ds_read_b128 v[200:203], v13 offset:26112
    ds_read_b128 v[204:207], v13 offset:26128
    s_nop 0
    s_nop 0
    buffer_load_dwordx4 v1, s[4:7], s101 offen offset:2048 lds
    s_waitcnt vmcnt(17)
    v_mfma_f32_32x32x16_bf16 v[144:159], a[104:107], v[108:111], v[144:159]
    s_waitcnt lgkmcnt(4)
    v_add_f32 v16, v16, v176
    v_add_f32 v17, v17, v177
    v_add_f32 v18, v18, v178
    v_add_f32 v19, v19, v179
    v_mfma_f32_32x32x16_bf16 v[160:175], a[108:111], v[108:111], v[160:175]
    v_add_f32 v20, v20, v180
    v_add_f32 v21, v21, v181
    v_add_f32 v22, v22, v182
    v_add_f32 v23, v23, v183
    v_add_f32 v16, v16, v184
    buffer_load_dwordx4 v1, s[4:7], s101 offen offset:3072 lds
    s_waitcnt vmcnt(17)
    v_mfma_f32_32x32x16_bf16 v[144:159], a[136:139], v[48:51], v[144:159]
    v_add_f32 v17, v17, v185
    v_add_f32 v18, v18, v186
    v_add_f32 v19, v19, v187
    v_add_f32 v20, v20, v188
    v_add_f32 v21, v21, v189
    v_mfma_f32_32x32x16_bf16 v[160:175], a[140:143], v[48:51], v[160:175]
    v_add_f32 v22, v22, v190
    v_add_f32 v23, v23, v191
    s_waitcnt lgkmcnt(0)
    v_add_f32 v16, v16, v192
    v_add_f32 v17, v17, v193
    s_add_u32 m0, m0, 4096
    s_add_u32 s101, s101, 4096
    buffer_load_dwordx4 v1, s[4:7], s101 offen offset:0 lds
    s_waitcnt vmcnt(17)
    v_mfma_f32_32x32x16_bf16 v[144:159], a[144:147], v[52:55], v[144:159]
    v_add_f32 v18, v18, v194
    v_add_f32 v19, v19, v195
    v_add_f32 v20, v20, v196
    v_add_f32 v21, v21, v197
    v_add_f32 v22, v22, v198
    v_mfma_f32_32x32x16_bf16 v[160:175], a[148:151], v[52:55], v[160:175]
    v_add_f32 v23, v23, v199
    v_add_f32 v16, v16, v200
    v_add_f32 v17, v17, v201
    v_add_f32 v18, v18, v202
    v_add_f32 v19, v19, v203
    buffer_load_dwordx4 v1, s[4:7], s101 offen offset:1024 lds
    s_waitcnt vmcnt(17)
    v_mfma_f32_32x32x16_bf16 v[144:159], a[152:155], v[56:59], v[144:159]
    v_add_f32 v20, v20, v204
    v_add_f32 v21, v21, v205
    v_add_f32 v22, v22, v206
    v_add_f32 v23, v23, v207
    v_cvt_pk_bf16_f32 v212, v16, v17
    v_mfma_f32_32x32x16_bf16 v[160:175], a[156:159], v[56:59], v[160:175]
    v_cvt_pk_bf16_f32 v213, v18, v19
    v_cvt_pk_bf16_f32 v214, v20, v21
    v_cvt_pk_bf16_f32 v215, v22, v23
    buffer_store_dwordx4 v[212:215], v5, s[4:7], 0 offen
    v_add_f32 v216, v16, v17
    buffer_load_dwordx4 v1, s[4:7], s101 offen offset:2048 lds
    s_waitcnt vmcnt(17)
    v_mfma_f32_32x32x16_bf16 v[144:159], a[160:163], v[60:63], v[144:159]
    v_mul_f32 v218, v16, v16
    v_fmac_f32 v218, v17, v17
    v_add_f32 v216, v216, v18
    v_fmac_f32 v218, v18, v18
    v_add_f32 v216, v216, v19
    v_mfma_f32_32x32x16_bf16 v[160:175], a[164:167], v[60:63], v[160:175]
    v_fmac_f32 v218, v19, v19
    v_add_f32 v216, v216, v20
    v_fmac_f32 v218, v20, v20
    v_add_f32 v216, v216, v21
    v_fmac_f32 v218, v21, v21
    buffer_load_dwordx4 v1, s[4:7], s101 offen offset:3072 lds
    s_waitcnt vmcnt(17)
    v_mfma_f32_32x32x16_bf16 v[144:159], a[192:195], v[64:67], v[144:159]
    v_add_f32 v216, v216, v22
    v_fmac_f32 v218, v22, v22
    v_add_f32 v216, v216, v23
    v_fmac_f32 v218, v23, v23
    s_nop 1
    v_permlane16_swap_b32 v216, v218
    v_mfma_f32_32x32x16_bf16 v[160:175], a[196:199], v[64:67], v[160:175]
    v_add_f32 v216, v216, v218
    s_nop 1
    v_add_f32_dpp v216, v216, v216 row_ror:8 row_mask:0xf bank_mask:0xf
    v_mov_b32 v218, v216
    s_nop 1
    v_permlane32_swap_b32 v216, v218
    v_add_f32 v216, v216, v218
    s_add_u32 m0, m0, 4096
    s_add_u32 s101, s101, 4096
    buffer_load_dwordx4 v1, s[4:7], s101 offen offset:0 lds
    s_waitcnt vmcnt(17)
    v_mfma_f32_32x32x16_bf16 v[144:159], a[200:203], v[68:71], v[144:159]
    s_mov_b64 exec, 0xff00ff
    buffer_store_dword v216, v7, s[4:7], 0 offen offset:0
    s_mov_b64 exec, -1
    v_mfma_f32_32x32x16_bf16 v[160:175], a[204:207], v[68:71], v[160:175]
    buffer_load_dwordx4 v1, s[4:7], s101 offen offset:1024 lds
    s_waitcnt vmcnt(18)
    v_mfma_f32_32x32x16_bf16 v[144:159], a[208:211], v[72:75], v[144:159]
    v_mfma_f32_32x32x16_bf16 v[160:175], a[212:215], v[72:75], v[160:175]
    buffer_load_dwordx4 v1, s[4:7], s101 offen offset:2048 lds
    s_waitcnt vmcnt(18)
    v_mfma_f32_32x32x16_bf16 v[144:159], a[216:219], v[76:79], v[144:159]
    v_mfma_f32_32x32x16_bf16 v[160:175], a[220:223], v[76:79], v[160:175]
    buffer_load_dwordx4 v1, s[4:7], s101 offen offset:3072 lds
    s_barrier
    s_nop 8
    ds_write_b128 v12, v[144:147] offset:0
    ds_write_b128 v12, v[148:151] offset:32
    ds_write_b128 v12, v[152:155] offset:64
    ds_write_b128 v12, v[156:159] offset:96
    ds_write_b128 v12, v[160:163] offset:128
    ds_write_b128 v12, v[164:167] offset:160
    ds_write_b128 v12, v[168:171] offset:192
    ds_write_b128 v12, v[172:175] offset:224
    s_waitcnt vmcnt(3)
    s_mov_b64 exec, 1
    buffer_store_dword v11, v9, s[4:7], s0 offen offset:0
    s_mov_b64 exec, -1
    s_waitcnt vmcnt(1)
    s_waitcnt lgkmcnt(0)
    s_barrier
    ds_read_b128 v[176:179], v13 offset:0
    ds_read_b128 v[180:183], v13 offset:16
    ds_read_b128 v[184:187], v13 offset:8704
    ds_read_b128 v[188:191], v13 offset:8720
    ds_read_b128 v[192:195], v13 offset:17408
    ds_read_b128 v[196:199], v13 offset:17424
    ds_read_b128 v[200:203], v13 offset:26112
    ds_read_b128 v[204:207], v13 offset:26128
    s_waitcnt lgkmcnt(4)
    v_pk_add_f32 v[24:25], v[24:25], v[176:177]
    v_pk_add_f32 v[26:27], v[26:27], v[178:179]
    v_pk_add_f32 v[28:29], v[28:29], v[180:181]
    v_pk_add_f32 v[30:31], v[30:31], v[182:183]
    v_pk_add_f32 v[24:25], v[24:25], v[184:185]
    v_pk_add_f32 v[26:27], v[26:27], v[186:187]
    v_pk_add_f32 v[28:29], v[28:29], v[188:189]
    v_pk_add_f32 v[30:31], v[30:31], v[190:191]
    s_waitcnt lgkmcnt(0)
    v_pk_add_f32 v[24:25], v[24:25], v[192:193]
    v_pk_add_f32 v[26:27], v[26:27], v[194:195]
    v_pk_add_f32 v[28:29], v[28:29], v[196:197]
    v_pk_add_f32 v[30:31], v[30:31], v[198:199]
    v_pk_add_f32 v[24:25], v[24:25], v[200:201]
    v_pk_add_f32 v[26:27], v[26:27], v[202:203]
    v_pk_add_f32 v[28:29], v[28:29], v[204:205]
    v_pk_add_f32 v[30:31], v[30:31], v[206:207]
    v_cvt_pk_bf16_f32 v212, v24, v25
    v_cvt_pk_bf16_f32 v213, v26, v27
    v_cvt_pk_bf16_f32 v214, v28, v29
    v_cvt_pk_bf16_f32 v215, v30, v31
    buffer_store_dwordx4 v[212:215], v5, s[4:7], s63 offen
    v_pk_add_f32 v[216:217], v[24:25], v[26:27]
    v_pk_mul_f32 v[218:219], v[24:25], v[24:25]
    v_pk_fma_f32 v[218:219], v[26:27], v[26:27], v[218:219]
    v_pk_add_f32 v[216:217], v[216:217], v[28:29]
    v_pk_fma_f32 v[218:219], v[28:29], v[28:29], v[218:219]
    v_pk_add_f32 v[216:217], v[216:217], v[30:31]
    v_pk_fma_f32 v[218:219], v[30:31], v[30:31], v[218:219]
    v_add_f32 v216, v216, v217
    v_add_f32 v218, v218, v219
    s_nop 1
    v_permlane16_swap_b32 v216, v218
    v_add_f32 v216, v216, v218
    s_nop 1
    v_add_f32_dpp v216, v216, v216 row_ror:8 row_mask:0xf bank_mask:0xf
    v_mov_b32 v218, v216
    s_nop 1
    v_permlane32_swap_b32 v216, v218
    v_add_f32 v216, v216, v218
    s_mov_b64 exec, 0xff00ff
    buffer_store_dword v216, v7, s[4:7], 0 offen offset:2048
    s_mov_b64 exec, -1
    s_barrier
    s_lshl_b32 s31, s28, 15
    s_add_u32 s30, s31, 16777216
    v_add_u32 v15, s30, v1
    s_mov_b32 s25, 1
    s_add_u32 s26, s26, 4194304
    s_add_u32 s27, s27, 32768
    s_add_u32 s38, s38, 32768
    s_waitcnt vmcnt(0)
    s_mov_b64 exec, 1
    buffer_store_dword v11, v9, s[4:7], s0 offen offset:128
    s_mov_b64 exec, -1
M_l1:
    s_mov_b64 exec, 0xffffffff
S_23:
    buffer_load_dword v45, v10, s[4:7], s34 offen offset:0 sc1
    s_waitcnt vmcnt(0)
    v_cmp_ne_u32 vcc, v11, v45
    s_nop 0
    s_cbranch_vccz S_22
    s_add_u32 s39, s39, 1
    s_cmp_lt_u32 s39, 200000
    s_cbranch_scc1 S_23
S_22:
    s_mov_b64 exec, -1
    buffer_load_dwordx4 v[48:51], v15, s[4:7], s40 offen offset:0 sc1
    buffer_load_dwordx4 v[52:55], v15, s[4:7], s40 offen offset:1024 sc1
    buffer_load_dwordx4 v[56:59], v15, s[4:7], s40 offen offset:2048 sc1
    buffer_load_dwordx4 v[60:63], v15, s[4:7], s40 offen offset:3072 sc1
    buffer_load_dwordx2 v[240:241], v8, s[4:7], 0 offen offset:0 sc1
    buffer_load_dwordx2 v[242:243], v8, s[4:7], 0 offen offset:256 sc1
    buffer_load_dwordx2 v[244:245], v8, s[4:7], 0 offen offset:512 sc1
    buffer_load_dwordx2 v[246:247], v8, s[4:7], 0 offen offset:768 sc1
    buffer_load_dwordx4 v[64:67], v15, s[4:7], s41 offen offset:0 sc1
    buffer_load_dwordx4 v[68:71], v15, s[4:7], s41 offen offset:1024 sc1
    buffer_load_dwordx4 v[72:75], v15, s[4:7], s41 offen offset:2048 sc1
    buffer_load_dwordx4 v[76:79], v15, s[4:7], s41 offen offset:3072 sc1
    buffer_load_dwordx4 v[80:83], v15, s[4:7], s42 offen offset:0 sc1
    buffer_load_dwordx4 v[84:87], v15, s[4:7], s42 offen offset:1024 sc1
    v_lshrrev_b32 v200, 1, v0
    v_mul_u32_u24 v201, 4160, v200
    v_and_b32 v202, 1, v0
    v_mul_u32_u24 v202, 1056, v202
    v_add_u32 v201, v201, v202
    v_add_u32 v201, 101376, v201
    s_lshl_b32 s30, s21, 2
    v_add_u32 v200, s30, v200
    v_mov_b32 v202, 0x3f803f80
    v_cmp_le_u32 vcc, 8, v200
    s_nop 1
    v_cndmask_b32 v204, 0, v202, vcc
    v_mov_b32 v205, v204
    v_mov_b32 v206, v204
    v_mov_b32 v207, v204
    s_lshl_b32 s30, s22, 18
    s_lshl_b32 s31, s28, 12
    s_add_u32 s30, s30, s31
    s_add_u32 s96, s30, s26
    s_lshl_b32 s31, s22, 7
    s_add_u32 s30, s27, s31
    s_add_u32 s35, s30, 98304
    s_mov_b64 exec, 0xffffff
    ds_write_b128 v201, v[204:207]
    s_mov_b64 exec, -1
    v_mad_u32_u24 v46, s40, 3, v1
    ds_read_b128 v[160:163], v46 offset:4096
    ds_read_b128 v[164:167], v46 offset:8192
    ds_read_b128 v[168:171], v46 offset:5120
    ds_read_b128 v[172:175], v46 offset:9216
    ds_read_b128 v[176:179], v46 offset:6144
    ds_read_b128 v[180:183], v46 offset:10240
    s_waitcnt vmcnt(13) lgkmcnt(4)
    v_mfma_f32_32x32x16_bf16 v[208:223], v[160:163], v[48:51], 0
    ds_read_b128 v[184:187], v46 offset:7168
    buffer_load_dwordx4 v[88:91], v15, s[4:7], s42 offen offset:2048 sc1
    v_mfma_f32_32x32x16_bf16 v[224:239], v[48:51], v[164:167], 0
    ds_read_b128 v[188:191], v46 offset:11264
    s_waitcnt vmcnt(13) lgkmcnt(4)
    v_mfma_f32_32x32x16_bf16 v[208:223], v[168:171], v[52:55], v[208:223]
    v_mad_u32_u24 v47, s41, 3, v1
    ds_read_b128 v[160:163], v47 offset:4096
    buffer_load_dwordx4 v[92:95], v15, s[4:7], s42 offen offset:3072 sc1
    v_mfma_f32_32x32x16_bf16 v[224:239], v[52:55], v[172:175], v[224:239]
    ds_read_b128 v[164:167], v47 offset:8192
    s_waitcnt vmcnt(13) lgkmcnt(4)
    v_mfma_f32_32x32x16_bf16 v[208:223], v[176:179], v[56:59], v[208:223]
    ds_read_b128 v[168:171], v47 offset:5120
    buffer_load_dwordx4 v[96:99], v15, s[4:7], s43 offen offset:0 sc1
    v_mfma_f32_32x32x16_bf16 v[224:239], v[56:59], v[180:183], v[224:239]
    ds_read_b128 v[172:175], v47 offset:9216
    s_waitcnt vmcnt(13) lgkmcnt(4)
    v_mfma_f32_32x32x16_bf16 v[208:223], v[184:187], v[60:63], v[208:223]
    ds_read_b128 v[176:179], v47 offset:6144
    buffer_load_dwordx4 v[100:103], v15, s[4:7], s43 offen offset:1024 sc1
    v_mfma_f32_32x32x16_bf16 v[224:239], v[60:63], v[188:191], v[224:239]
    ds_read_b128 v[180:183], v47 offset:10240
    s_waitcnt vmcnt(9) lgkmcnt(4)
    v_mfma_f32_32x32x16_bf16 v[208:223], v[160:163], v[64:67], v[208:223]
    ds_read_b128 v[184:187], v47 offset:7168
    buffer_load_dwordx4 v[104:107], v15, s[4:7], s43 offen offset:2048 sc1
    v_mfma_f32_32x32x16_bf16 v[224:239], v[64:67], v[164:167], v[224:239]
    ds_read_b128 v[188:191], v47 offset:11264
    v_add_f32 v240, v240, v242
    s_waitcnt vmcnt(9) lgkmcnt(4)
    v_mfma_f32_32x32x16_bf16 v[208:223], v[168:171], v[68:71], v[208:223]
    v_mad_u32_u24 v46, s42, 3, v1
    ds_read_b128 v[160:163], v46 offset:4096
    buffer_load_dwordx4 v[108:111], v15, s[4:7], s43 offen offset:3072 sc1
    v_mfma_f32_32x32x16_bf16 v[224:239], v[68:71], v[172:175], v[224:239]
    ds_read_b128 v[164:167], v46 offset:8192
    v_add_f32 v244, v244, v246
    v_add_f32 v241, v241, v243
    s_waitcnt vmcnt(9) lgkmcnt(4)
    v_mfma_f32_32x32x16_bf16 v[208:223], v[176:179], v[72:75], v[208:223]
    ds_read_b128 v[168:171], v46 offset:5120
    buffer_load_dwordx4 v[112:115], v15, s[4:7], s44 offen offset:0 sc1
    v_mfma_f32_32x32x16_bf16 v[224:239], v[72:75], v[180:183], v[224:239]
    ds_read_b128 v[172:175], v46 offset:9216
    v_add_f32 v245, v245, v247
    v_add_f32 v240, v240, v244
    s_waitcnt vmcnt(9) lgkmcnt(4)
    v_mfma_f32_32x32x16_bf16 v[208:223], v[184:187], v[76:79], v[208:223]
    ds_read_b128 v[176:179], v46 offset:6144
    buffer_load_dwordx4 v[116:119], v15, s[4:7], s44 offen offset:1024 sc1
    v_mfma_f32_32x32x16_bf16 v[224:239], v[76:79], v[188:191], v[224:239]
    ds_read_b128 v[180:183], v46 offset:10240
    v_add_f32 v241, v241, v245
    v_mov_b32 v242, v240
    s_waitcnt vmcnt(9) lgkmcnt(4)
    v_mfma_f32_32x32x16_bf16 v[208:223], v[160:163], v[80:83], v[208:223]
    ds_read_b128 v[184:187], v46 offset:7168
    buffer_load_dwordx4 v[120:123], v15, s[4:7], s44 offen offset:2048 sc1
    v_mfma_f32_32x32x16_bf16 v[224:239], v[80:83], v[164:167], v[224:239]
    ds_read_b128 v[188:191], v46 offset:11264
    v_mov_b32 v243, v241
    v_mov_b32 v250, 0
    s_waitcnt vmcnt(9) lgkmcnt(4)
    v_mfma_f32_32x32x16_bf16 v[208:223], v[168:171], v[84:87], v[208:223]
    v_mad_u32_u24 v47, s43, 3, v1
    ds_read_b128 v[160:163], v47 offset:4096
    buffer_load_dwordx4 v[124:127], v15, s[4:7], s44 offen offset:3072 sc1
    v_mfma_f32_32x32x16_bf16 v[224:239], v[84:87], v[172:175], v[224:239]
    ds_read_b128 v[164:167], v47 offset:8192
    v_permlane32_swap_b32 v240, v242
    v_permlane32_swap_b32 v241, v243
    s_waitcnt vmcnt(9) lgkmcnt(4)
    v_mfma_f32_32x32x16_bf16 v[208:223], v[176:179], v[88:91], v[208:223]
    ds_read_b128 v[168:171], v47 offset:5120
    buffer_load_dwordx4 v[128:131], v15, s[4:7], s45 offen offset:0 sc1
    v_mfma_f32_32x32x16_bf16 v[224:239], v[88:91], v[180:183], v[224:239]
    ds_read_b128 v[172:175], v47 offset:9216
    v_add_f32 v240, v240, v242
    v_add_f32 v241, v241, v243
    s_waitcnt vmcnt(9) lgkmcnt(4)
    v_mfma_f32_32x32x16_bf16 v[208:223], v[184:187], v[92:95], v[208:223]
    ds_read_b128 v[176:179], v47 offset:6144
    buffer_load_dwordx4 v[132:135], v15, s[4:7], s45 offen offset:1024 sc1
    v_mfma_f32_32x32x16_bf16 v[224:239], v[92:95], v[188:191], v[224:239]
    ds_read_b128 v[180:183], v47 offset:10240
    v_mul_f32 v240, 0xbb000000, v240
    v_mul_f32 v241, 0x3b000000, v241
    s_waitcnt vmcnt(9) lgkmcnt(4)
    v_mfma_f32_32x32x16_bf16 v[208:223], v[160:163], v[96:99], v[208:223]
    ds_read_b128 v[184:187], v47 offset:7168
    buffer_load_dwordx4 v[136:139], v15, s[4:7], s45 offen offset:2048 sc1
    v_mfma_f32_32x32x16_bf16 v[224:239], v[96:99], v[164:167], v[224:239]
    ds_read_b128 v[188:191], v47 offset:11264
    v_fma_f32 v241, -v240, v240, v241
    v_max_f32 v241, 0, v241
    s_waitcnt vmcnt(9) lgkmcnt(4)
    v_mfma_f32_32x32x16_bf16 v[208:223], v[168:171], v[100:103], v[208:223]
    v_mad_u32_u24 v46, s44, 3, v1
    ds_read_b128 v[160:163], v46 offset:4096
    buffer_load_dwordx4 v[140:143], v15, s[4:7], s45 offen offset:3072 sc1
    v_mfma_f32_32x32x16_bf16 v[224:239], v[100:103], v[172:175], v[224:239]
    ds_read_b128 v[164:167], v46 offset:8192
    v_add_f32 v241, 0x3727c5ac, v241
    v_rsq_f32 v252, v241
    s_waitcnt vmcnt(9) lgkmcnt(4)
    v_mfma_f32_32x32x16_bf16 v[208:223], v[176:179], v[104:107], v[208:223]
    ds_read_b128 v[168:171], v46 offset:5120
    buffer_load_dwordx4 v[144:147], v15, s[4:7], s46 offen offset:0 sc1
    v_mfma_f32_32x32x16_bf16 v[224:239], v[104:107], v[180:183], v[224:239]
    ds_read_b128 v[172:175], v46 offset:9216
    v_cvt_pk_bf16_f32 v242, v240, v240
    v_and_b32 v243, 0xffff0000, v242
    s_waitcnt vmcnt(9) lgkmcnt(4)
    v_mfma_f32_32x32x16_bf16 v[208:223], v[184:187], v[108:111], v[208:223]
    ds_read_b128 v[176:179], v46 offset:6144
    buffer_load_dwordx4 v[148:151], v15, s[4:7], s46 offen offset:1024 sc1
    v_mfma_f32_32x32x16_bf16 v[224:239], v[108:111], v[188:191], v[224:239]
    ds_read_b128 v[180:183], v46 offset:10240
    v_sub_f32 v243, v240, v243
    v_lshrrev_b32 v249, 5, v0
    s_waitcnt vmcnt(9) lgkmcnt(4)
    v_mfma_f32_32x32x16_bf16 v[208:223], v[160:163], v[112:115], v[208:223]
    ds_read_b128 v[184:187], v46 offset:7168
    buffer_load_dwordx4 v[152:155], v15, s[4:7], s46 offen offset:2048 sc1
    v_mfma_f32_32x32x16_bf16 v[224:239], v[112:115], v[164:167], v[224:239]
    ds_read_b128 v[188:191], v46 offset:11264
    v_add_u32 v249, -1, v249
    v_cvt_pk_bf16_f32 v242, v240, v243
    s_waitcnt vmcnt(9) lgkmcnt(4)
    v_mfma_f32_32x32x16_bf16 v[208:223], v[168:171], v[116:119], v[208:223]
    v_mad_u32_u24 v47, s45, 3, v1
    ds_read_b128 v[160:163], v47 offset:4096
    buffer_load_dwordx4 v[156:159], v15, s[4:7], s46 offen offset:3072 sc1
    v_mfma_f32_32x32x16_bf16 v[224:239], v[116:119], v[172:175], v[224:239]
    ds_read_b128 v[164:167], v47 offset:8192
    v_mov_b32 v251, 0
    v_mov_b32 v253, v252
    s_waitcnt vmcnt(9) lgkmcnt(4)
    v_mfma_f32_32x32x16_bf16 v[208:223], v[176:179], v[120:123], v[208:223]
    ds_read_b128 v[168:171], v47 offset:5120
    buffer_load_dwordx4 a[240:243], v15, s[4:7], s47 offen offset:0 sc1
    v_mfma_f32_32x32x16_bf16 v[224:239], v[120:123], v[180:183], v[224:239]
    ds_read_b128 v[172:175], v47 offset:9216
    v_and_b32 v248, v249, v242
    v_mov_b32 v249, v248
    s_waitcnt vmcnt(9) lgkmcnt(4)
    v_mfma_f32_32x32x16_bf16 v[208:223], v[184:187], v[124:127], v[208:223]
    ds_read_b128 v[176:179], v47 offset:6144
    buffer_load_dwordx4 a[244:247], v15, s[4:7], s47 offen offset:1024 sc1
    v_mfma_f32_32x32x16_bf16 v[224:239], v[124:127], v[188:191], v[224:239]
    ds_read_b128 v[180:183], v47 offset:10240
    v_mul_f32 v254, 0x3eb8aa3b, v252
    v_mov_b32 v255, v254
    s_waitcnt vmcnt(9) lgkmcnt(4)
    v_mfma_f32_32x32x16_bf16 v[208:223], v[160:163], v[128:131], v[208:223]
    ds_read_b128 v[184:187], v47 offset:7168
    buffer_load_dwordx4 a[248:251], v15, s[4:7], s47 offen offset:2048 sc1
    v_mfma_f32_32x32x16_bf16 v[224:239], v[128:131], v[164:167], v[224:239]
    ds_read_b128 v[188:191], v47 offset:11264
    v_and_b32 v240, 124, v10
    s_lshl_b32 s30, s20, 7
    s_add_u32 s30, s30, 159744
    v_add_u32 v240, s30, v240
    ds_write_b32 v240, v252
    s_waitcnt vmcnt(9) lgkmcnt(5)
    v_mfma_f32_32x32x16_bf16 v[208:223], v[168:171], v[132:135], v[208:223]
    v_mad_u32_u24 v46, s46, 3, v1
    ds_read_b128 v[160:163], v46 offset:4096
    buffer_load_dwordx4 a[252:255], v15, s[4:7], s47 offen offset:3072 sc1
    v_mfma_f32_32x32x16_bf16 v[224:239], v[132:135], v[172:175], v[224:239]
    ds_read_b128 v[164:167], v46 offset:8192
    v_mfma_f32_32x32x16_bf16 v[208:223], a[226:229], v[248:251], v[208:223]
    v_mfma_f32_32x32x16_bf16 v[224:239], v[248:251], a[228:231], v[224:239]
    s_waitcnt vmcnt(9) lgkmcnt(5)
    v_mfma_f32_32x32x16_bf16 v[208:223], v[176:179], v[136:139], v[208:223]
    ds_read_b128 v[168:171], v46 offset:5120
    v_mfma_f32_32x32x16_bf16 v[224:239], v[136:139], v[180:183], v[224:239]
    ds_read_b128 v[172:175], v46 offset:9216
    ds_read_b128 v[240:243], v14 offset:0
    ds_read_b128 v[244:247], v14 offset:32
    ds_read_b128 v[192:195], v14 offset:64
    ds_read_b128 v[196:199], v14 offset:96
    s_waitcnt vmcnt(8) lgkmcnt(9)
    v_mfma_f32_32x32x16_bf16 v[208:223], v[184:187], v[140:143], v[208:223]
    ds_read_b128 v[176:179], v46 offset:6144
    v_mfma_f32_32x32x16_bf16 v[224:239], v[140:143], v[188:191], v[224:239]
    ds_read_b128 v[180:183], v46 offset:10240
    s_waitcnt vmcnt(7) lgkmcnt(8)
    v_mfma_f32_32x32x16_bf16 v[208:223], v[160:163], v[144:147], v[208:223]
    ds_read_b128 v[184:187], v46 offset:7168
    v_mfma_f32_32x32x16_bf16 v[224:239], v[144:147], v[164:167], v[224:239]
    ds_read_b128 v[188:191], v46 offset:11264
    s_waitcnt vmcnt(6) lgkmcnt(8)
    v_mfma_f32_32x32x16_bf16 v[208:223], v[168:171], v[148:151], v[208:223]
    v_mad_u32_u24 v47, s47, 3, v1
    ds_read_b128 v[160:163], v47 offset:4096
    v_mfma_f32_32x32x16_bf16 v[224:239], v[148:151], v[172:175], v[224:239]
    ds_read_b128 v[164:167], v47 offset:8192
    s_waitcnt vmcnt(5) lgkmcnt(4)
    v_mfma_f32_32x32x16_bf16 v[208:223], v[176:179], v[152:155], v[208:223]
    ds_read_b128 v[168:171], v47 offset:5120
    v_mfma_f32_32x32x16_bf16 v[224:239], v[152:155], v[180:183], v[224:239]
    ds_read_b128 v[172:175], v47 offset:9216
    s_waitcnt vmcnt(4) lgkmcnt(4)
    v_mfma_f32_32x32x16_bf16 v[208:223], v[184:187], v[156:159], v[208:223]
    ds_read_b128 v[176:179], v47 offset:6144
    v_mfma_f32_32x32x16_bf16 v[224:239], v[156:159], v[188:191], v[224:239]
    ds_read_b128 v[180:183], v47 offset:10240
    s_waitcnt vmcnt(3) lgkmcnt(4)
    v_mfma_f32_32x32x16_bf16 v[208:223], v[160:163], a[240:243], v[208:223]
    ds_read_b128 v[184:187], v47 offset:7168
    v_mfma_f32_32x32x16_bf16 v[224:239], a[240:243], v[164:167], v[224:239]
    ds_read_b128 v[188:191], v47 offset:11264
    s_waitcnt vmcnt(2) lgkmcnt(4)
    v_mfma_f32_32x32x16_bf16 v[208:223], v[168:171], a[244:247], v[208:223]
    v_mfma_f32_32x32x16_bf16 v[224:239], a[244:247], v[172:175], v[224:239]
    v_mad_u32_u24 v46, s40, 3, v1
    s_waitcnt vmcnt(1) lgkmcnt(2)
    v_mfma_f32_32x32x16_bf16 v[208:223], v[176:179], a[248:251], v[208:223]
    v_mfma_f32_32x32x16_bf16 v[224:239], a[248:251], v[180:183], v[224:239]
    s_waitcnt vmcnt(0) lgkmcnt(0)
    v_mfma_f32_32x32x16_bf16 v[208:223], v[184:187], a[252:255], v[208:223]
    v_mfma_f32_32x32x16_bf16 v[224:239], a[252:255], v[188:191], v[224:239]
    ds_read_b128 v[160:163], v46 offset:0
    ds_read_b128 v[164:167], v46 offset:1024
    ds_read_b128 v[168:171], v46 offset:2048
    ds_read_b128 v[172:175], v46 offset:3072
    v_mad_u32_u24 v47, s41, 3, v1
    ds_read_b128 v[176:179], v47 offset:0
    ds_read_b128 v[180:183], v47 offset:1024
    s_nop 3
    v_pk_mul_f32 v[208:209], v[252:253], v[208:209]
    v_pk_mul_f32 v[210:211], v[252:253], v[210:211]
    v_pk_mul_f32 v[212:213], v[252:253], v[212:213]
    v_pk_mul_f32 v[214:215], v[252:253], v[214:215]
    v_pk_mul_f32 v[216:217], v[252:253], v[216:217]
    v_pk_mul_f32 v[218:219], v[252:253], v[218:219]
    v_pk_mul_f32 v[220:221], v[252:253], v[220:221]
    v_pk_mul_f32 v[222:223], v[252:253], v[222:223]
    v_cvt_pk_bf16_f32 v208, v208, v209
    v_cvt_pk_bf16_f32 v209, v210, v211
    v_cvt_pk_bf16_f32 v210, v212, v213
    v_cvt_pk_bf16_f32 v211, v214, v215
    v_cvt_pk_bf16_f32 v212, v216, v217
    v_cvt_pk_bf16_f32 v213, v218, v219
    v_cvt_pk_bf16_f32 v214, v220, v221
    v_cvt_pk_bf16_f32 v215, v222, v223
    buffer_store_dwordx4 v[208:211], v1, s[4:7], s96 offen offset:0 sc1
    buffer_store_dwordx4 v[212:215], v1, s[4:7], s96 offen offset:1024 sc1
    v_pk_mul_f32 v[224:225], v[240:241], v[224:225]
    v_pk_mul_f32 v[226:227], v[242:243], v[226:227]
    v_pk_mul_f32 v[228:229], v[244:245], v[228:229]
    v_pk_mul_f32 v[230:231], v[246:247], v[230:231]
    v_pk_mul_f32 v[232:233], v[192:193], v[232:233]
    v_pk_mul_f32 v[234:235], v[194:195], v[234:235]
    v_pk_mul_f32 v[236:237], v[196:197], v[236:237]
    v_pk_mul_f32 v[238:239], v[198:199], v[238:239]
    v_cvt_pk_bf16_f32 v216, v224, v225
    v_cvt_pk_bf16_f32 v217, v226, v227
    v_cvt_pk_bf16_f32 v218, v228, v229
    v_cvt_pk_bf16_f32 v219, v230, v231
    v_cvt_pk_bf16_f32 v220, v232, v233
    v_cvt_pk_bf16_f32 v221, v234, v235
    v_cvt_pk_bf16_f32 v222, v236, v237
    v_cvt_pk_bf16_f32 v223, v238, v239
    buffer_store_dwordx4 v[216:219], v1, s[4:7], s96 offen offset:2048 sc1
    buffer_store_dwordx4 v[220:223], v1, s[4:7], s96 offen offset:3072 sc1
    v_mfma_f32_32x32x16_bf16 v[192:207], a[224:227], v[248:251], 0
    s_waitcnt lgkmcnt(4)
    v_mfma_f32_32x32x16_bf16 v[192:207], v[160:163], v[48:51], v[192:207]
    ds_read_b128 v[184:187], v47 offset:2048
    ds_write_b128 v40, v[208:211] offset:33280
    v_mfma_f32_32x32x16_bf16 v[192:207], v[164:167], v[52:55], v[192:207]
    ds_read_b128 v[188:191], v47 offset:3072
    ds_write_b128 v40, v[212:215] offset:34304
    s_waitcnt lgkmcnt(6)
    v_mfma_f32_32x32x16_bf16 v[192:207], v[168:171], v[56:59], v[192:207]
    v_mad_u32_u24 v46, s42, 3, v1
    ds_read_b128 v[160:163], v46 offset:0
    ds_write_b128 v40, v[216:219] offset:35328
    v_mfma_f32_32x32x16_bf16 v[192:207], v[172:175], v[60:63], v[192:207]
    ds_read_b128 v[164:167], v46 offset:1024
    ds_write_b128 v40, v[220:223] offset:36384
    s_waitcnt lgkmcnt(8)
    v_mfma_f32_32x32x16_bf16 v[192:207], v[176:179], v[64:67], v[192:207]
    ds_read_b128 v[168:171], v46 offset:2048
    s_lshl_b32 s33, s20, 2
    s_add_u32 s33, s33, s35
    v_mfma_f32_32x32x16_bf16 v[192:207], v[180:183], v[68:71], v[192:207]
    ds_read_b128 v[172:175], v46 offset:3072
    s_waitcnt lgkmcnt(7)
    v_mfma_f32_32x32x16_bf16 v[192:207], v[184:187], v[72:75], v[192:207]
    v_mad_u32_u24 v47, s43, 3, v1
    ds_read_b128 v[176:179], v47 offset:0
    v_mfma_f32_32x32x16_bf16 v[192:207], v[188:191], v[76:79], v[192:207]
    ds_read_b128 v[180:183], v47 offset:1024
    s_waitcnt lgkmcnt(5)
    v_mfma_f32_32x32x16_bf16 v[192:207], v[160:163], v[80:83], v[192:207]
    ds_read_b128 v[184:187], v47 offset:2048
    v_mfma_f32_32x32x16_bf16 v[192:207], v[164:167], v[84:87], v[192:207]
    ds_read_b128 v[188:191], v47 offset:3072
    s_waitcnt lgkmcnt(4)
    v_mfma_f32_32x32x16_bf16 v[192:207], v[168:171], v[88:91], v[192:207]
    v_mad_u32_u24 v46, s44, 3, v1
    ds_read_b128 v[160:163], v46 offset:0
    v_mfma_f32_32x32x16_bf16 v[192:207], v[172:175], v[92:95], v[192:207]
    ds_read_b128 v[164:167], v46 offset:1024
    s_waitcnt lgkmcnt(4)
    v_mfma_f32_32x32x16_bf16 v[192:207], v[176:179], v[96:99], v[192:207]
    ds_read_b128 v[168:171], v46 offset:2048
    v_mfma_f32_32x32x16_bf16 v[192:207], v[180:183], v[100:103], v[192:207]
    ds_read_b128 v[172:175], v46 offset:3072
    s_waitcnt lgkmcnt(4)
    v_mfma_f32_32x32x16_bf16 v[192:207], v[184:187], v[104:107], v[192:207]
    v_mad_u32_u24 v47, s45, 3, v1
    ds_read_b128 v[176:179], v47 offset:0
    v_mfma_f32_32x32x16_bf16 v[192:207], v[188:191], v[108:111], v[192:207]
    ds_read_b128 v[180:183], v47 offset:1024
    s_waitcnt lgkmcnt(4)
    v_mfma_f32_32x32x16_bf16 v[192:207], v[160:163], v[112:115], v[192:207]
    ds_read_b128 v[184:187], v47 offset:2048
    v_mfma_f32_32x32x16_bf16 v[192:207], v[164:167], v[116:119], v[192:207]
    ds_read_b128 v[188:191], v47 offset:3072
    s_waitcnt lgkmcnt(4)
    v_mfma_f32_32x32x16_bf16 v[192:207], v[168:171], v[120:123], v[192:207]
    v_mad_u32_u24 v46, s46, 3, v1
    ds_read_b128 v[160:163], v46 offset:0
    s_waitcnt vmcnt(0)
    s_mov_b64 exec, 1
    buffer_store_dword v11, v9, s[4:7], s33 offen offset:0 sc1
    s_mov_b64 exec, -1
    v_mfma_f32_32x32x16_bf16 v[192:207], v[172:175], v[124:127], v[192:207]
    ds_read_b128 v[164:167], v46 offset:1024
    s_waitcnt lgkmcnt(4)
    v_mfma_f32_32x32x16_bf16 v[192:207], v[176:179], v[128:131], v[192:207]
    ds_read_b128 v[168:171], v46 offset:2048
    v_mfma_f32_32x32x16_bf16 v[192:207], v[180:183], v[132:135], v[192:207]
    ds_read_b128 v[172:175], v46 offset:3072
    s_waitcnt lgkmcnt(4)
    v_mfma_f32_32x32x16_bf16 v[192:207], v[184:187], v[136:139], v[192:207]
    v_mad_u32_u24 v47, s47, 3, v1
    ds_read_b128 v[176:179], v47 offset:0
    v_mfma_f32_32x32x16_bf16 v[192:207], v[188:191], v[140:143], v[192:207]
    ds_read_b128 v[180:183], v47 offset:1024
    s_waitcnt lgkmcnt(4)
    v_mfma_f32_32x32x16_bf16 v[192:207], v[160:163], v[144:147], v[192:207]
    ds_read_b128 v[184:187], v47 offset:2048
    s_lshr_b32 s30, s20, 1
    s_sub_u32 s30, 2, s30
    s_min_u32 s31, s30, s21
    s_lshl_b32 s32, s31, 11
    s_sub_u32 s35, s35, s32
    v_mfma_f32_32x32x16_bf16 v[192:207], v[164:167], v[148:151], v[192:207]
    ds_read_b128 v[188:191], v47 offset:3072
    s_waitcnt lgkmcnt(4)
    v_mfma_f32_32x32x16_bf16 v[192:207], v[168:171], v[152:155], v[192:207]
    s_and_b32 s32, s20, 1
    s_lshl_b32 s32, s32, 1
    s_lshl_b32 s32, 3, s32
    s_cmp_eq_u32 s30, s31
    s_cselect_b32 s32, s32, 1
    s_mov_b32 s33, 0
    v_mfma_f32_32x32x16_bf16 v[192:207], v[172:175], v[156:159], v[192:207]
    s_waitcnt lgkmcnt(2)
    v_mfma_f32_32x32x16_bf16 v[192:207], v[176:179], a[240:243], v[192:207]
    s_lshl_b32 s100, s22, 18
    s_add_u32 s100, s100, s26
    s_mul_i32 s101, s20, 8320
    s_add_u32 s101, s101, 98304
    v_mfma_f32_32x32x16_bf16 v[192:207], v[180:183], a[244:247], v[192:207]
    s_waitcnt lgkmcnt(0)
    v_mfma_f32_32x32x16_bf16 v[192:207], v[184:187], a[248:251], v[192:207]
    v_mfma_f32_32x32x16_bf16 v[192:207], v[188:191], a[252:255], v[192:207]
    s_mov_b64 exec, s[32:33]
    buffer_load_dword v45, v10, s[4:7], s35 offen sc1
    s_mov_b64 exec, -1
    s_nop 8
    v_pk_mul_f32 v[192:193], v[254:255], v[192:193]
    v_pk_mul_f32 v[194:195], v[254:255], v[194:195]
    v_pk_mul_f32 v[196:197], v[254:255], v[196:197]
    v_pk_mul_f32 v[198:199], v[254:255], v[198:199]
    v_pk_mul_f32 v[200:201], v[254:255], v[200:201]
    v_pk_mul_f32 v[202:203], v[254:255], v[202:203]
    v_pk_mul_f32 v[204:205], v[254:255], v[204:205]
    v_pk_mul_f32 v[206:207], v[254:255], v[206:207]
    v_cvt_pk_bf16_f32 v48, v192, v193
    v_cvt_pk_bf16_f32 v49, v194, v195
    v_cvt_pk_bf16_f32 v50, v196, v197
    v_cvt_pk_bf16_f32 v51, v198, v199
    v_cvt_pk_bf16_f32 v52, v200, v201
    v_cvt_pk_bf16_f32 v53, v202, v203
    v_cvt_pk_bf16_f32 v54, v204, v205
    v_cvt_pk_bf16_f32 v55, v206, v207
    s_mov_b64 exec, s[32:33]
S_25:
    s_waitcnt vmcnt(0)
    v_cmp_ne_u32 vcc, v11, v45
    s_nop 0
    s_cbranch_vccz S_24
    buffer_load_dword v45, v10, s[4:7], s35 offen sc1
    s_add_u32 s39, s39, 1
    s_cmp_lt_u32 s39, 200000
    s_cbranch_scc1 S_25
S_24:
    s_mov_b64 exec, -1
    s_cmp_eq_u32 s30, s31
    s_cbranch_scc1 K_26
    v_mov_b32 v47, 0x7ff00000
    s_add_u32 m0, s101, 0
    s_nop 0
    buffer_load_dwordx4 v43, s[4:7], s100 offen offset:0 sc1 lds
    s_add_u32 m0, s101, 4160
    s_nop 0
    buffer_load_dwordx4 v43, s[4:7], s100 offen offset:0 sc1 lds
    s_add_u32 m0, s101, 0
    s_nop 0
    buffer_load_dwordx4 v43, s[4:7], s100 offen offset:1024 sc1 lds
    s_add_u32 m0, s101, 4160
    s_nop 0
    buffer_load_dwordx4 v43, s[4:7], s100 offen offset:1024 sc1 lds
    s_add_u32 m0, s101, 2048
    s_nop 0
    buffer_load_dwordx4 v47, s[4:7], 0 offen sc1 lds
    s_add_u32 m0, s101, 6208
    s_nop 0
    buffer_load_dwordx4 v47, s[4:7], 0 offen sc1 lds
    s_add_u32 m0, s101, 3104
    s_nop 0
    buffer_load_dwordx4 v47, s[4:7], 0 offen sc1 lds
    s_add_u32 m0, s101, 7264
    s_nop 0
    buffer_load_dwordx4 v47, s[4:7], 0 offen sc1 lds
    s_branch K_27
K_26:
    s_lshl_b32 s31, s21, 2
    s_lshl_b32 s32, s20, 1
    s_add_u32 s31, s31, s32
    s_sub_u32 s31, s31, 8
    s_lshl_b32 s31, s31, 12
    s_add_u32 s100, s100, s31
    s_add_u32 s33, s100, 4096
    s_add_u32 m0, s101, 0
    s_nop 0
    buffer_load_dwordx4 v1, s[4:7], s100 offen offset:0 sc1 lds
    s_add_u32 m0, s101, 4160
    s_nop 0
    buffer_load_dwordx4 v1, s[4:7], s33 offen offset:0 sc1 lds
    s_add_u32 m0, s101, 0
    s_nop 0
    buffer_load_dwordx4 v1, s[4:7], s100 offen offset:1024 sc1 lds
    s_add_u32 m0, s101, 4160
    s_nop 0
    buffer_load_dwordx4 v1, s[4:7], s33 offen offset:1024 sc1 lds
    s_add_u32 m0, s101, 0
    s_nop 0
    buffer_load_dwordx4 v1, s[4:7], s100 offen offset:2048 sc1 lds
    s_add_u32 m0, s101, 4160
    s_nop 0
    buffer_load_dwordx4 v1, s[4:7], s33 offen offset:2048 sc1 lds
    s_add_u32 m0, s101, 32
    s_nop 0
    buffer_load_dwordx4 v1, s[4:7], s100 offen offset:3072 sc1 lds
    s_add_u32 m0, s101, 4192
    s_nop 0
    buffer_load_dwordx4 v1, s[4:7], s33 offen offset:3072 sc1 lds
K_27:
    s_lshl_b32 s30, s28, 15
    s_lshl_b32 s31, s22, 11
    s_add_u32 s30, s30, s31
    s_add_u32 s96, s30, 19922944
    s_lshl_b32 s14, s24, 16
    s_and_b32 s30, s20, 1
    s_lshl_b32 s30, s30, 15
    s_add_u32 s14, s14, s30
    s_add_u32 s14, s14, 1048576
    s_waitcnt lgkmcnt(0)
    s_waitcnt vmcnt(6)
    s_barrier
    ds_read_b128 v[56:59], v40 offset:0
    ds_read_b128 v[60:63], v40 offset:33280
    ds_read_b128 v[64:67], v40 offset:4160
    ds_read_b128 v[68:71], v40 offset:8320
    ds_read_b128 v[72:75], v40 offset:12480
    ds_read_b128 v[76:79], v40 offset:16640
    ds_read_b128 a[240:243], v40 offset:20800
    ds_read_b128 a[244:247], v40 offset:24960
    ds_read_b128 a[248:251], v40 offset:29120
    s_waitcnt lgkmcnt(7)
    v_mfma_f32_32x32x16_bf16 v[80:95], v[56:59], v[48:51], 0
    v_mfma_f32_32x32x16_bf16 v[112:127], v[60:63], v[48:51], 0
    s_waitcnt lgkmcnt(3)
    v_mfma_f32_32x32x16_bf16 v[96:111], v[64:67], v[48:51], 0
    v_mfma_f32_32x32x16_bf16 v[128:143], v[68:71], v[48:51], 0
    s_nop 8
    v_cndmask_b32 v112, v80, v112, s[64:65]
    v_cndmask_b32 v113, v81, v113, s[66:67]
    v_cndmask_b32 v114, v82, v114, s[68:69]
    v_cndmask_b32 v115, v83, v115, s[70:71]
    v_cndmask_b32 v116, v84, v116, s[72:73]
    v_cndmask_b32 v117, v85, v117, s[74:75]
    v_cndmask_b32 v118, v86, v118, s[76:77]
    v_cndmask_b32 v119, v87, v119, s[78:79]
    v_mfma_f32_32x32x16_bf16 v[144:159], v[72:75], v[48:51], 0
    v_cndmask_b32 v120, v88, v120, s[80:81]
    v_cndmask_b32 v121, v89, v121, s[82:83]
    v_cndmask_b32 v122, v90, v122, s[84:85]
    v_cndmask_b32 v123, v91, v123, s[86:87]
    v_cndmask_b32 v124, v92, v124, s[88:89]
    v_cndmask_b32 v125, v93, v125, s[90:91]
    v_cndmask_b32 v126, v94, v126, s[92:93]
    v_cndmask_b32 v127, v95, v127, s[94:95]
    v_max_f32 v45, v112, v113
    v_mfma_f32_32x32x16_bf16 v[80:95], v[76:79], v[48:51], 0
    v_max3_f32 v45, v114, v115, v45
    v_max3_f32 v45, v116, v117, v45
    v_max3_f32 v45, v118, v119, v45
    v_max3_f32 v45, v120, v121, v45
    v_max3_f32 v45, v122, v123, v45
    v_max3_f32 v45, v124, v125, v45
    v_max3_f32 v45, v126, v127, v45
    v_max3_f32 v45, v96, v97, v45
    v_max3_f32 v45, v98, v99, v45
    v_max3_f32 v45, v100, v101, v45
    v_max3_f32 v45, v102, v103, v45
    v_max3_f32 v45, v104, v105, v45
    v_max3_f32 v45, v106, v107, v45
    v_max3_f32 v45, v108, v109, v45
    v_max3_f32 v45, v110, v111, v45
    s_waitcnt lgkmcnt(0)
    v_mfma_f32_32x32x16_bf16 v[96:111], a[240:243], v[48:51], 0
    v_max3_f32 v45, v128, v129, v45
    v_max3_f32 v45, v130, v131, v45
    v_max3_f32 v45, v132, v133, v45
    v_max3_f32 v45, v134, v135, v45
    v_max3_f32 v45, v136, v137, v45
    v_max3_f32 v45, v138, v139, v45
    v_max3_f32 v45, v140, v141, v45
    v_max3_f32 v45, v142, v143, v45
    v_mfma_f32_32x32x16_bf16 v[128:143], a[244:247], v[48:51], 0
    v_max3_f32 v45, v144, v145, v45
    v_max3_f32 v45, v146, v147, v45
    v_max3_f32 v45, v148, v149, v45
    v_max3_f32 v45, v150, v151, v45
    v_max3_f32 v45, v152, v153, v45
    v_max3_f32 v45, v154, v155, v45
    v_max3_f32 v45, v156, v157, v45
    v_max3_f32 v45, v158, v159, v45
    v_mfma_f32_32x32x16_bf16 v[144:159], a[248:251], v[48:51], 0
    v_max3_f32 v45, v80, v81, v45
    v_max3_f32 v45, v82, v83, v45
    v_max3_f32 v45, v84, v85, v45
    v_max3_f32 v45, v86, v87, v45
    v_max3_f32 v45, v88, v89, v45
    v_max3_f32 v45, v90, v91, v45
    v_max3_f32 v45, v92, v93, v45
    v_max3_f32 v45, v94, v95, v45
    v_max3_f32 v45, v96, v97, v45
    v_max3_f32 v45, v98, v99, v45
    v_max3_f32 v45, v100, v101, v45
    v_max3_f32 v45, v102, v103, v45
    v_max3_f32 v45, v104, v105, v45
    v_max3_f32 v45, v106, v107, v45
    v_max3_f32 v45, v108, v109, v45
    v_max3_f32 v45, v110, v111, v45
    v_max3_f32 v45, v128, v129, v45
    v_max3_f32 v45, v130, v131, v45
    v_max3_f32 v45, v132, v133, v45
    v_max3_f32 v45, v134, v135, v45
    v_max3_f32 v45, v136, v137, v45
    v_max3_f32 v45, v138, v139, v45
    v_max3_f32 v45, v140, v141, v45
    v_max3_f32 v45, v142, v143, v45
    s_waitcnt vmcnt(0)
    s_barrier
    v_max3_f32 v45, v144, v145, v45
    v_max3_f32 v45, v146, v147, v45
    v_max3_f32 v45, v148, v149, v45
    v_max3_f32 v45, v150, v151, v45
    v_max3_f32 v45, v152, v153, v45
    v_max3_f32 v45, v154, v155, v45
    v_max3_f32 v45, v156, v157, v45
    v_max3_f32 v45, v158, v159, v45
    v_mov_b32 v128, v45
    ds_read_b128 v[160:163], v41 offset:0
    ds_read_b128 v[164:167], v41 offset:1056
    v_permlane32_swap_b32 v128, v45
    v_max_f32 v45, v128, v45
    v_sub_f32 v128, 0, v45
    v_sub_f32 v129, 0, v45
    v_pk_mov_b32 v[130:131], v[128:129], v[128:129]
    v_pk_mov_b32 v[132:133], v[128:129], v[128:129]
    v_pk_mov_b32 v[134:135], v[128:129], v[128:129]
    v_pk_mov_b32 v[136:137], v[128:129], v[128:129]
    v_pk_mov_b32 v[138:139], v[128:129], v[128:129]
    v_pk_mov_b32 v[140:141], v[128:129], v[128:129]
    v_pk_mov_b32 v[142:143], v[128:129], v[128:129]
    v_pk_add_f32 v[112:113], v[112:113], v[128:129]
    v_pk_add_f32 v[114:115], v[114:115], v[128:129]
    v_pk_add_f32 v[116:117], v[116:117], v[128:129]
    v_pk_add_f32 v[118:119], v[118:119], v[128:129]
    v_pk_add_f32 v[120:121], v[120:121], v[128:129]
    v_pk_add_f32 v[122:123], v[122:123], v[128:129]
    v_pk_add_f32 v[124:125], v[124:125], v[128:129]
    v_pk_add_f32 v[126:127], v[126:127], v[128:129]
    ds_read_b128 v[168:171], v41 offset:33280
    ds_read_b128 v[172:175], v41 offset:34336
    v_mfma_f32_32x32x16_bf16 v[96:111], v[64:67], v[48:51], v[128:143]
    v_exp_f32 v112, v112
    v_exp_f32 v113, v113
    v_exp_f32 v114, v114
    v_cvt_pk_bf16_f32 v112, v112, v113
    s_mul_i32 s100, s20, 24576
    s_add_u32 m0, s100, 0
    s_mul_i32 s101, s22, 114688
    s_add_u32 s101, s101, s100
    s_add_u32 s101, s101, 3407872
    buffer_load_dwordx4 v1, s[4:7], s101 offen offset:0 lds
    v_exp_f32 v115, v115
    v_exp_f32 v116, v116
    v_cvt_pk_bf16_f32 v113, v114, v115
    v_exp_f32 v117, v117
    v_exp_f32 v118, v118
    v_cvt_pk_bf16_f32 v114, v116, v117
    v_exp_f32 v119, v119
    v_exp_f32 v120, v120
    v_cvt_pk_bf16_f32 v115, v118, v119
    buffer_load_dwordx4 v1, s[4:7], s101 offen offset:1024 lds
    v_exp_f32 v121, v121
    v_exp_f32 v122, v122
    v_cvt_pk_bf16_f32 v116, v120, v121
    v_exp_f32 v123, v123
    v_exp_f32 v124, v124
    v_cvt_pk_bf16_f32 v117, v122, v123
    v_exp_f32 v125, v125
    v_exp_f32 v126, v126
    v_cvt_pk_bf16_f32 v118, v124, v125
    buffer_load_dwordx4 v1, s[4:7], s101 offen offset:2048 lds
    v_exp_f32 v127, v127
    v_and_b32 v120, v32, v112
    v_cvt_pk_bf16_f32 v119, v126, v127
    v_xor_b32 v112, v120, v112
    v_and_b32 v121, v33, v113
    v_xor_b32 v113, v121, v113
    v_and_b32 v122, v34, v114
    v_xor_b32 v114, v122, v114
    v_and_b32 v123, v35, v115
    v_xor_b32 v115, v123, v115
    v_and_b32 v124, v36, v116
    v_xor_b32 v116, v124, v116
    v_and_b32 v125, v37, v117
    v_xor_b32 v117, v125, v117
    v_and_b32 v126, v38, v118
    v_xor_b32 v118, v126, v118
    v_and_b32 v127, v39, v119
    v_xor_b32 v119, v127, v119
    v_mfma_f32_32x32x16_bf16 v[80:95], v[68:71], v[48:51], v[128:143]
    v_exp_f32 v96, v96
    v_exp_f32 v97, v97
    buffer_load_dwordx4 v1, s[4:7], s101 offen offset:3072 lds
    v_exp_f32 v98, v98
    v_cvt_pk_bf16_f32 v152, v96, v97
    s_waitcnt lgkmcnt(0)
    v_mfma_f32_32x32x16_bf16 v[176:191], v[160:163], v[112:115], 0
    v_exp_f32 v99, v99
    v_exp_f32 v100, v100
    v_cvt_pk_bf16_f32 v153, v98, v99
    v_exp_f32 v101, v101
    v_mfma_f32_32x32x16_bf16 v[176:191], v[164:167], v[116:119], v[176:191]
    v_exp_f32 v102, v102
    v_cvt_pk_bf16_f32 v154, v100, v101
    ds_read_b128 v[160:163], v41 offset:4160
    v_exp_f32 v103, v103
    v_exp_f32 v104, v104
    v_cvt_pk_bf16_f32 v155, v102, v103
    v_mfma_f32_32x32x16_bf16 v[176:191], v[168:171], v[120:123], v[176:191]
    s_add_u32 m0, m0, 4096
    s_add_u32 s101, s101, 4096
    buffer_load_dwordx4 v1, s[4:7], s101 offen offset:0 lds
    v_exp_f32 v105, v105
    v_exp_f32 v106, v106
    v_cvt_pk_bf16_f32 v156, v104, v105
    v_exp_f32 v107, v107
    v_mfma_f32_32x32x16_bf16 v[176:191], v[172:175], v[124:127], v[176:191]
    v_exp_f32 v108, v108
    v_cvt_pk_bf16_f32 v157, v106, v107
    v_exp_f32 v109, v109
    buffer_load_dwordx4 v1, s[4:7], s101 offen offset:1024 lds
    v_exp_f32 v110, v110
    v_cvt_pk_bf16_f32 v158, v108, v109
    v_exp_f32 v111, v111
    ds_read_b128 v[164:167], v41 offset:5216
    v_cvt_pk_bf16_f32 v159, v110, v111
    v_mfma_f32_32x32x16_bf16 v[96:111], v[72:75], v[48:51], v[128:143]
    v_exp_f32 v80, v80
    v_exp_f32 v81, v81
    buffer_load_dwordx4 v1, s[4:7], s101 offen offset:2048 lds
    v_exp_f32 v82, v82
    v_cvt_pk_bf16_f32 v144, v80, v81
    v_exp_f32 v83, v83
    v_exp_f32 v84, v84
    v_cvt_pk_bf16_f32 v145, v82, v83
    s_waitcnt lgkmcnt(0)
    v_mfma_f32_32x32x16_bf16 v[176:191], v[160:163], v[152:155], v[176:191]
    v_exp_f32 v85, v85
    v_exp_f32 v86, v86
    v_cvt_pk_bf16_f32 v146, v84, v85
    ds_read_b128 v[168:171], v41 offset:8320
    v_exp_f32 v87, v87
    v_exp_f32 v88, v88
    v_cvt_pk_bf16_f32 v147, v86, v87
    buffer_load_dwordx4 v1, s[4:7], s101 offen offset:3072 lds
    v_exp_f32 v89, v89
    v_exp_f32 v90, v90
    v_cvt_pk_bf16_f32 v148, v88, v89
    v_mfma_f32_32x32x16_bf16 v[176:191], v[164:167], v[156:159], v[176:191]
    v_exp_f32 v91, v91
    v_exp_f32 v92, v92
    v_cvt_pk_bf16_f32 v149, v90, v91
    ds_read_b128 v[56:59], v40 offset:1024
    v_exp_f32 v93, v93
    s_add_u32 m0, m0, 4096
    s_add_u32 s101, s101, 4096
    buffer_load_dwordx4 v1, s[4:7], s101 offen offset:0 lds
    v_exp_f32 v94, v94
    v_cvt_pk_bf16_f32 v150, v92, v93
    v_exp_f32 v95, v95
    ds_read_b128 v[172:175], v41 offset:9376
    v_cvt_pk_bf16_f32 v151, v94, v95
    v_mfma_f32_32x32x16_bf16 v[80:95], v[76:79], v[48:51], v[128:143]
    v_exp_f32 v96, v96
    v_exp_f32 v97, v97
    buffer_load_dwordx4 v1, s[4:7], s101 offen offset:1024 lds
    v_exp_f32 v98, v98
    v_cvt_pk_bf16_f32 v152, v96, v97
    v_exp_f32 v99, v99
    v_exp_f32 v100, v100
    v_cvt_pk_bf16_f32 v153, v98, v99
    s_waitcnt lgkmcnt(0)
    v_mfma_f32_32x32x16_bf16 v[176:191], v[168:171], v[144:147], v[176:191]
    v_exp_f32 v101, v101
    v_exp_f32 v102, v102
    v_cvt_pk_bf16_f32 v154, v100, v101
    ds_read_b128 v[160:163], v41 offset:12480
    v_exp_f32 v103, v103
    v_exp_f32 v104, v104
    v_cvt_pk_bf16_f32 v155, v102, v103
    buffer_load_dwordx4 v1, s[4:7], s101 offen offset:2048 lds
    v_exp_f32 v105, v105
    v_exp_f32 v106, v106
    v_cvt_pk_bf16_f32 v156, v104, v105
    v_mfma_f32_32x32x16_bf16 v[176:191], v[172:175], v[148:151], v[176:191]
    v_exp_f32 v107, v107
    v_exp_f32 v108, v108
    v_cvt_pk_bf16_f32 v157, v106, v107
    ds_read_b128 v[60:63], v40 offset:34304
    ds_read_b128 a[252:255], v40 offset:5184
    v_exp_f32 v109, v109
    buffer_load_dwordx4 v1, s[4:7], s101 offen offset:3072 lds
    v_exp_f32 v110, v110
    v_cvt_pk_bf16_f32 v158, v108, v109
    v_exp_f32 v111, v111
    ds_read_b128 v[164:167], v41 offset:13536
    v_cvt_pk_bf16_f32 v159, v110, v111
    v_mfma_f32_32x32x16_bf16 v[96:111], a[240:243], v[48:51], v[128:143]
    v_exp_f32 v80, v80
    v_exp_f32 v81, v81
    s_add_u32 m0, m0, 4096
    s_add_u32 s101, s101, 4096
    buffer_load_dwordx4 v1, s[4:7], s101 offen offset:0 lds
    v_exp_f32 v82, v82
    v_cvt_pk_bf16_f32 v144, v80, v81
    v_exp_f32 v83, v83
    v_exp_f32 v84, v84
    v_cvt_pk_bf16_f32 v145, v82, v83
    s_waitcnt lgkmcnt(0)
    v_mfma_f32_32x32x16_bf16 v[176:191], v[160:163], v[152:155], v[176:191]
    v_exp_f32 v85, v85
    v_exp_f32 v86, v86
    v_cvt_pk_bf16_f32 v146, v84, v85
    ds_read_b128 v[168:171], v41 offset:16640
    v_exp_f32 v87, v87
    v_exp_f32 v88, v88
    v_cvt_pk_bf16_f32 v147, v86, v87
    buffer_load_dwordx4 v1, s[4:7], s101 offen offset:1024 lds
    v_exp_f32 v89, v89
    v_exp_f32 v90, v90
    v_cvt_pk_bf16_f32 v148, v88, v89
    v_mfma_f32_32x32x16_bf16 v[176:191], v[164:167], v[156:159], v[176:191]
    v_exp_f32 v91, v91
    v_exp_f32 v92, v92
    v_cvt_pk_bf16_f32 v149, v90, v91
    ds_read_b128 v[64:67], v40 offset:9344
    ds_read_b128 v[68:71], v40 offset:13504
    v_exp_f32 v93, v93
    buffer_load_dwordx4 v1, s[4:7], s101 offen offset:2048 lds
    v_exp_f32 v94, v94
    v_cvt_pk_bf16_f32 v150, v92, v93
    v_exp_f32 v95, v95
    ds_read_b128 v[172:175], v41 offset:17696
    v_cvt_pk_bf16_f32 v151, v94, v95
    v_mfma_f32_32x32x16_bf16 v[80:95], a[244:247], v[48:51], v[128:143]
    v_exp_f32 v96, v96
    v_exp_f32 v97, v97
    buffer_load_dwordx4 v1, s[4:7], s101 offen offset:3072 lds
    v_exp_f32 v98, v98
    v_cvt_pk_bf16_f32 v152, v96, v97
    v_exp_f32 v99, v99
    v_exp_f32 v100, v100
    v_cvt_pk_bf16_f32 v153, v98, v99
    s_waitcnt lgkmcnt(0)
    v_mfma_f32_32x32x16_bf16 v[176:191], v[168:171], v[144:147], v[176:191]
    v_exp_f32 v101, v101
    v_exp_f32 v102, v102
    v_cvt_pk_bf16_f32 v154, v100, v101
    ds_read_b128 v[160:163], v41 offset:20800
    v_exp_f32 v103, v103
    v_exp_f32 v104, v104
    v_cvt_pk_bf16_f32 v155, v102, v103
    s_add_u32 m0, m0, 4096
    s_add_u32 s101, s101, 4096
    buffer_load_dwordx4 v1, s[4:7], s101 offen offset:0 lds
    v_exp_f32 v105, v105
    v_exp_f32 v106, v106
    v_cvt_pk_bf16_f32 v156, v104, v105
    v_mfma_f32_32x32x16_bf16 v[176:191], v[172:175], v[148:151], v[176:191]
    v_exp_f32 v107, v107
    v_exp_f32 v108, v108
    v_cvt_pk_bf16_f32 v157, v106, v107
    ds_read_b128 v[72:75], v40 offset:17664
    ds_read_b128 v[76:79], v40 offset:21824
    v_exp_f32 v109, v109
    buffer_load_dwordx4 v1, s[4:7], s101 offen offset:1024 lds
    v_exp_f32 v110, v110
    v_cvt_pk_bf16_f32 v158, v108, v109
    v_exp_f32 v111, v111
    ds_read_b128 v[164:167], v41 offset:21856
    v_cvt_pk_bf16_f32 v159, v110, v111
    v_mfma_f32_32x32x16_bf16 v[96:111], a[248:251], v[48:51], v[128:143]
    v_exp_f32 v80, v80
    v_exp_f32 v81, v81
    buffer_load_dwordx4 v1, s[4:7], s101 offen offset:2048 lds
    v_exp_f32 v82, v82
    v_cvt_pk_bf16_f32 v144, v80, v81
    v_exp_f32 v83, v83
    v_exp_f32 v84, v84
    v_cvt_pk_bf16_f32 v145, v82, v83
    s_waitcnt lgkmcnt(0)
    v_mfma_f32_32x32x16_bf16 v[176:191], v[160:163], v[152:155], v[176:191]
    v_exp_f32 v85, v85
    v_exp_f32 v86, v86
    v_cvt_pk_bf16_f32 v146, v84, v85
    ds_read_b128 v[168:171], v41 offset:24960
    v_exp_f32 v87, v87
    v_exp_f32 v88, v88
    v_cvt_pk_bf16_f32 v147, v86, v87
    buffer_load_dwordx4 v1, s[4:7], s101 offen offset:3072 lds
    v_exp_f32 v89, v89
    v_exp_f32 v90, v90
    v_cvt_pk_bf16_f32 v148, v88, v89
    v_mfma_f32_32x32x16_bf16 v[176:191], v[164:167], v[156:159], v[176:191]
    v_exp_f32 v91, v91
    v_exp_f32 v92, v92
    v_cvt_pk_bf16_f32 v149, v90, v91
    ds_read_b128 a[240:243], v40 offset:25984
    ds_read_b128 a[244:247], v40 offset:30144
    v_exp_f32 v93, v93
    s_add_u32 m0, m0, 4096
    s_add_u32 s101, s101, 4096
    buffer_load_dwordx4 v1, s[4:7], s101 offen offset:0 lds
    v_exp_f32 v94, v94
    v_cvt_pk_bf16_f32 v150, v92, v93
    v_exp_f32 v95, v95
    ds_read_b128 v[172:175], v41 offset:26016
    v_cvt_pk_bf16_f32 v151, v94, v95
    v_exp_f32 v96, v96
    v_mfma_f32_32x32x16_bf16 v[80:95], v[56:59], v[52:55], 0
    v_exp_f32 v97, v97
    buffer_load_dwordx4 v1, s[4:7], s101 offen offset:1024 lds
    v_exp_f32 v98, v98
    v_cvt_pk_bf16_f32 v152, v96, v97
    v_exp_f32 v99, v99
    v_exp_f32 v100, v100
    v_cvt_pk_bf16_f32 v153, v98, v99
    s_waitcnt lgkmcnt(0)
    v_mfma_f32_32x32x16_bf16 v[176:191], v[168:171], v[144:147], v[176:191]
    v_exp_f32 v101, v101
    v_exp_f32 v102, v102
    v_cvt_pk_bf16_f32 v154, v100, v101
    ds_read_b128 v[160:163], v41 offset:29120
    ds_read_b128 v[164:167], v41 offset:30176
    v_exp_f32 v103, v103
    v_mfma_f32_32x32x16_bf16 v[112:127], v[60:63], v[52:55], 0
    v_exp_f32 v104, v104
    v_cvt_pk_bf16_f32 v155, v102, v103
    buffer_load_dwordx4 v1, s[4:7], s101 offen offset:2048 lds
    v_exp_f32 v105, v105
    v_exp_f32 v106, v106
    v_cvt_pk_bf16_f32 v156, v104, v105
    v_mfma_f32_32x32x16_bf16 v[176:191], v[172:175], v[148:151], v[176:191]
    v_exp_f32 v107, v107
    v_exp_f32 v108, v108
    v_cvt_pk_bf16_f32 v157, v106, v107
    v_exp_f32 v109, v109
    buffer_load_dwordx4 v1, s[4:7], s101 offen offset:3072 lds
    s_waitcnt lgkmcnt(0)
    v_mfma_f32_32x32x16_bf16 v[176:191], v[160:163], v[152:155], v[176:191]
    v_exp_f32 v110, v110
    v_cvt_pk_bf16_f32 v158, v108, v109
    v_exp_f32 v111, v111
    s_nop 0
    v_cvt_pk_bf16_f32 v159, v110, v111
    s_nop 1
    v_mfma_f32_32x32x16_bf16 v[176:191], v[164:167], v[156:159], v[176:191]
    v_mfma_f32_32x32x16_bf16 v[96:111], a[252:255], v[52:55], 0
    v_mfma_f32_32x32x16_bf16 v[128:143], v[64:67], v[52:55], 0
    v_cndmask_b32 v112, v80, v112, s[64:65]
    v_cndmask_b32 v113, v81, v113, s[66:67]
    v_cndmask_b32 v114, v82, v114, s[68:69]
    v_cndmask_b32 v115, v83, v115, s[70:71]
    v_cndmask_b32 v116, v84, v116, s[72:73]
    v_cndmask_b32 v117, v85, v117, s[74:75]
    v_cndmask_b32 v118, v86, v118, s[76:77]
    v_cndmask_b32 v119, v87, v119, s[78:79]
    v_mfma_f32_32x32x16_bf16 v[144:159], v[68:71], v[52:55], 0
    v_cndmask_b32 v120, v88, v120, s[80:81]
    v_cndmask_b32 v121, v89, v121, s[82:83]
    v_cndmask_b32 v122, v90, v122, s[84:85]
    v_cndmask_b32 v123, v91, v123, s[86:87]
    v_cndmask_b32 v124, v92, v124, s[88:89]
    v_cndmask_b32 v125, v93, v125, s[90:91]
    v_cndmask_b32 v126, v94, v126, s[92:93]
    v_cndmask_b32 v127, v95, v127, s[94:95]
    v_max_f32 v45, v112, v113
    v_mfma_f32_32x32x16_bf16 v[80:95], v[72:75], v[52:55], 0
    v_rcp_f32 v184, v184
    s_nop 0
    v_mul_f32 v176, v176, v184
    v_mul_f32 v177, v177, v184
    v_mul_f32 v178, v178, v184
    v_mul_f32 v179, v179, v184
    v_mul_f32 v180, v180, v184
    v_mul_f32 v181, v181, v184
    v_mul_f32 v182, v182, v184
    v_mul_f32 v183, v183, v184
    v_cvt_pk_bf16_f32 v188, v176, v177
    v_cvt_pk_bf16_f32 v189, v178, v179
    v_cvt_pk_bf16_f32 v190, v180, v181
    v_cvt_pk_bf16_f32 v191, v182, v183
    buffer_store_dwordx4 v[188:191], v1, s[4:7], s96 offen offset:0 sc1
    v_max3_f32 v45, v114, v115, v45
    v_max3_f32 v45, v116, v117, v45
    v_max3_f32 v45, v118, v119, v45
    v_max3_f32 v45, v120, v121, v45
    v_max3_f32 v45, v122, v123, v45
    v_max3_f32 v45, v124, v125, v45
    v_max3_f32 v45, v126, v127, v45
    v_max3_f32 v45, v96, v97, v45
    v_max3_f32 v45, v98, v99, v45
    v_max3_f32 v45, v100, v101, v45
    v_max3_f32 v45, v102, v103, v45
    v_max3_f32 v45, v104, v105, v45
    v_max3_f32 v45, v106, v107, v45
    v_max3_f32 v45, v108, v109, v45
    v_max3_f32 v45, v110, v111, v45
    v_mfma_f32_32x32x16_bf16 v[96:111], v[76:79], v[52:55], 0
    s_add_u32 s15, s14, 0
    buffer_load_dwordx4 v[192:195], v1, s[4:7], s15 offen offset:0
    v_max3_f32 v45, v128, v129, v45
    v_max3_f32 v45, v130, v131, v45
    v_max3_f32 v45, v132, v133, v45
    v_max3_f32 v45, v134, v135, v45
    v_max3_f32 v45, v136, v137, v45
    v_max3_f32 v45, v138, v139, v45
    v_max3_f32 v45, v140, v141, v45
    v_max3_f32 v45, v142, v143, v45
    v_mfma_f32_32x32x16_bf16 v[128:143], a[240:243], v[52:55], 0
    buffer_load_dwordx4 v[196:199], v1, s[4:7], s15 offen offset:1024
    v_max3_f32 v45, v144, v145, v45
    v_max3_f32 v45, v146, v147, v45
    v_max3_f32 v45, v148, v149, v45
    v_max3_f32 v45, v150, v151, v45
    v_max3_f32 v45, v152, v153, v45
    v_max3_f32 v45, v154, v155, v45
    v_max3_f32 v45, v156, v157, v45
    v_max3_f32 v45, v158, v159, v45
    v_mfma_f32_32x32x16_bf16 v[144:159], a[244:247], v[52:55], 0
    s_add_u32 s15, s14, 4096
    buffer_load_dwordx4 v[200:203], v1, s[4:7], s15 offen offset:0
    v_max3_f32 v45, v80, v81, v45
    v_max3_f32 v45, v82, v83, v45
    v_max3_f32 v45, v84, v85, v45
    v_max3_f32 v45, v86, v87, v45
    v_max3_f32 v45, v88, v89, v45
    v_max3_f32 v45, v90, v91, v45
    v_max3_f32 v45, v92, v93, v45
    v_max3_f32 v45, v94, v95, v45
    v_max3_f32 v45, v96, v97, v45
    v_max3_f32 v45, v98, v99, v45
    v_max3_f32 v45, v100, v101, v45
    v_max3_f32 v45, v102, v103, v45
    v_max3_f32 v45, v104, v105, v45
    v_max3_f32 v45, v106, v107, v45
    v_max3_f32 v45, v108, v109, v45
    v_max3_f32 v45, v110, v111, v45
    buffer_load_dwordx4 v[204:207], v1, s[4:7], s15 offen offset:1024
    v_max3_f32 v45, v128, v129, v45
    v_max3_f32 v45, v130, v131, v45
    v_max3_f32 v45, v132, v133, v45
    v_max3_f32 v45, v134, v135, v45
    v_max3_f32 v45, v136, v137, v45
    v_max3_f32 v45, v138, v139, v45
    v_max3_f32 v45, v140, v141, v45
    v_max3_f32 v45, v142, v143, v45
    s_add_u32 s15, s14, 8192
    buffer_load_dwordx4 v[208:211], v1, s[4:7], s15 offen offset:0
    v_max3_f32 v45, v144, v145, v45
    v_max3_f32 v45, v146, v147, v45
    v_max3_f32 v45, v148, v149, v45
    v_max3_f32 v45, v150, v151, v45
    v_max3_f32 v45, v152, v153, v45
    v_max3_f32 v45, v154, v155, v45
    v_max3_f32 v45, v156, v157, v45
    v_max3_f32 v45, v158, v159, v45
    buffer_load_dwordx4 v[212:215], v1, s[4:7], s15 offen offset:1024
    v_mov_b32 v128, v45
    ds_read_b128 v[160:163], v42 offset:0
    ds_read_b128 v[164:167], v42 offset:1056
    v_permlane32_swap_b32 v128, v45
    v_max_f32 v45, v128, v45
    v_sub_f32 v128, 0, v45
    v_sub_f32 v129, 0, v45
    v_pk_mov_b32 v[130:131], v[128:129], v[128:129]
    v_pk_mov_b32 v[132:133], v[128:129], v[128:129]
    v_pk_mov_b32 v[134:135], v[128:129], v[128:129]
    v_pk_mov_b32 v[136:137], v[128:129], v[128:129]
    v_pk_mov_b32 v[138:139], v[128:129], v[128:129]
    v_pk_mov_b32 v[140:141], v[128:129], v[128:129]
    v_pk_mov_b32 v[142:143], v[128:129], v[128:129]
    v_pk_add_f32 v[112:113], v[112:113], v[128:129]
    v_pk_add_f32 v[114:115], v[114:115], v[128:129]
    v_pk_add_f32 v[116:117], v[116:117], v[128:129]
    v_pk_add_f32 v[118:119], v[118:119], v[128:129]
    v_pk_add_f32 v[120:121], v[120:121], v[128:129]
    v_pk_add_f32 v[122:123], v[122:123], v[128:129]
    v_pk_add_f32 v[124:125], v[124:125], v[128:129]
    v_pk_add_f32 v[126:127], v[126:127], v[128:129]
    ds_read_b128 v[168:171], v42 offset:33280
    ds_read_b128 v[172:175], v42 offset:34336
    v_mfma_f32_32x32x16_bf16 v[96:111], a[252:255], v[52:55], v[128:143]
    v_exp_f32 v112, v112
    v_exp_f32 v113, v113
    v_exp_f32 v114, v114
    v_cvt_pk_bf16_f32 v112, v112, v113
    s_add_u32 s15, s14, 12288
    buffer_load_dwordx4 v[216:219], v1, s[4:7], s15 offen offset:0
    v_exp_f32 v115, v115
    v_exp_f32 v116, v116
    v_cvt_pk_bf16_f32 v113, v114, v115
    v_exp_f32 v117, v117
    v_exp_f32 v118, v118
    v_cvt_pk_bf16_f32 v114, v116, v117
    v_exp_f32 v119, v119
    v_exp_f32 v120, v120
    v_cvt_pk_bf16_f32 v115, v118, v119
    buffer_load_dwordx4 v[220:223], v1, s[4:7], s15 offen offset:1024
    v_exp_f32 v121, v121
    v_exp_f32 v122, v122
    v_cvt_pk_bf16_f32 v116, v120, v121
    v_exp_f32 v123, v123
    v_exp_f32 v124, v124
    v_cvt_pk_bf16_f32 v117, v122, v123
    v_exp_f32 v125, v125
    v_exp_f32 v126, v126
    v_cvt_pk_bf16_f32 v118, v124, v125
    s_add_u32 s15, s14, 16384
    buffer_load_dwordx4 v[224:227], v1, s[4:7], s15 offen offset:0
    v_exp_f32 v127, v127
    v_and_b32 v120, v32, v112
    v_cvt_pk_bf16_f32 v119, v126, v127
    v_xor_b32 v112, v120, v112
    v_and_b32 v121, v33, v113
    v_xor_b32 v113, v121, v113
    v_and_b32 v122, v34, v114
    v_xor_b32 v114, v122, v114
    v_and_b32 v123, v35, v115
    v_xor_b32 v115, v123, v115
    v_and_b32 v124, v36, v116
    v_xor_b32 v116, v124, v116
    v_and_b32 v125, v37, v117
    v_xor_b32 v117, v125, v117
    v_and_b32 v126, v38, v118
    v_xor_b32 v118, v126, v118
    v_and_b32 v127, v39, v119
    v_xor_b32 v119, v127, v119
    v_mfma_f32_32x32x16_bf16 v[80:95], v[64:67], v[52:55], v[128:143]
    v_exp_f32 v96, v96
    v_exp_f32 v97, v97
    buffer_load_dwordx4 v[228:231], v1, s[4:7], s15 offen offset:1024
    v_exp_f32 v98, v98
    v_cvt_pk_bf16_f32 v152, v96, v97
    s_waitcnt lgkmcnt(0)
    v_mfma_f32_32x32x16_bf16 v[176:191], v[160:163], v[112:115], 0
    v_exp_f32 v99, v99
    v_exp_f32 v100, v100
    v_cvt_pk_bf16_f32 v153, v98, v99
    v_exp_f32 v101, v101
    v_mfma_f32_32x32x16_bf16 v[176:191], v[164:167], v[116:119], v[176:191]
    v_exp_f32 v102, v102
    v_cvt_pk_bf16_f32 v154, v100, v101
    ds_read_b128 v[160:163], v42 offset:4160
    v_exp_f32 v103, v103
    v_exp_f32 v104, v104
    v_cvt_pk_bf16_f32 v155, v102, v103
    v_mfma_f32_32x32x16_bf16 v[176:191], v[168:171], v[120:123], v[176:191]
    s_add_u32 s15, s14, 20480
    buffer_load_dwordx4 v[232:235], v1, s[4:7], s15 offen offset:0
    v_exp_f32 v105, v105
    v_exp_f32 v106, v106
    v_cvt_pk_bf16_f32 v156, v104, v105
    v_exp_f32 v107, v107
    v_mfma_f32_32x32x16_bf16 v[176:191], v[172:175], v[124:127], v[176:191]
    v_exp_f32 v108, v108
    v_cvt_pk_bf16_f32 v157, v106, v107
    v_exp_f32 v109, v109
    buffer_load_dwordx4 v[236:239], v1, s[4:7], s15 offen offset:1024
    v_exp_f32 v110, v110
    v_cvt_pk_bf16_f32 v158, v108, v109
    v_exp_f32 v111, v111
    ds_read_b128 v[164:167], v42 offset:5216
    v_cvt_pk_bf16_f32 v159, v110, v111
    s_waitcnt vmcnt(12)
    s_mov_b64 exec, 1
    buffer_store_dword v11, v9, s[4:7], s38 offen offset:512
    s_mov_b64 exec, -1
    v_mfma_f32_32x32x16_bf16 v[96:111], v[68:71], v[52:55], v[128:143]
    v_exp_f32 v80, v80
    v_exp_f32 v81, v81
    s_add_u32 s15, s14, 24576
    buffer_load_dwordx4 v[240:243], v1, s[4:7], s15 offen offset:0
    v_exp_f32 v82, v82
    v_cvt_pk_bf16_f32 v144, v80, v81
    v_exp_f32 v83, v83
    v_exp_f32 v84, v84
    v_cvt_pk_bf16_f32 v145, v82, v83
    s_waitcnt lgkmcnt(0)
    v_mfma_f32_32x32x16_bf16 v[176:191], v[160:163], v[152:155], v[176:191]
    v_exp_f32 v85, v85
    v_exp_f32 v86, v86
    v_cvt_pk_bf16_f32 v146, v84, v85
    ds_read_b128 v[168:171], v42 offset:8320
    v_exp_f32 v87, v87
    v_exp_f32 v88, v88
    v_cvt_pk_bf16_f32 v147, v86, v87
    buffer_load_dwordx4 v[244:247], v1, s[4:7], s15 offen offset:1024
    v_exp_f32 v89, v89
    v_exp_f32 v90, v90
    v_cvt_pk_bf16_f32 v148, v88, v89
    v_mfma_f32_32x32x16_bf16 v[176:191], v[164:167], v[156:159], v[176:191]
    v_exp_f32 v91, v91
    v_exp_f32 v92, v92
    v_cvt_pk_bf16_f32 v149, v90, v91
    v_exp_f32 v93, v93
    s_add_u32 s15, s14, 28672
    buffer_load_dwordx4 v[248:251], v1, s[4:7], s15 offen offset:0
    v_exp_f32 v94, v94
    v_cvt_pk_bf16_f32 v150, v92, v93
    v_exp_f32 v95, v95
    ds_read_b128 v[172:175], v42 offset:9376
    v_cvt_pk_bf16_f32 v151, v94, v95
    v_mfma_f32_32x32x16_bf16 v[80:95], v[72:75], v[52:55], v[128:143]
    v_exp_f32 v96, v96
    v_exp_f32 v97, v97
    buffer_load_dwordx4 v[252:255], v1, s[4:7], s15 offen offset:1024
    v_exp_f32 v98, v98
    v_cvt_pk_bf16_f32 v152, v96, v97
    v_exp_f32 v99, v99
    s_add_u32 s62, s14, 0
    buffer_load_dwordx4 v[112:115], v1, s[4:7], s62 offen offset:2048
    v_exp_f32 v100, v100
    v_cvt_pk_bf16_f32 v153, v98, v99
    s_waitcnt lgkmcnt(0)
    v_mfma_f32_32x32x16_bf16 v[176:191], v[168:171], v[144:147], v[176:191]
    v_exp_f32 v101, v101
    v_exp_f32 v102, v102
    v_cvt_pk_bf16_f32 v154, v100, v101
    ds_read_b128 v[160:163], v42 offset:12480
    v_exp_f32 v103, v103
    v_exp_f32 v104, v104
    v_cvt_pk_bf16_f32 v155, v102, v103
    v_exp_f32 v105, v105
    v_exp_f32 v106, v106
    v_cvt_pk_bf16_f32 v156, v104, v105
    v_mfma_f32_32x32x16_bf16 v[176:191], v[172:175], v[148:151], v[176:191]
    v_exp_f32 v107, v107
    buffer_load_dwordx4 v[116:119], v1, s[4:7], s62 offen offset:3072
    v_exp_f32 v108, v108
    v_cvt_pk_bf16_f32 v157, v106, v107
    v_exp_f32 v109, v109
    v_exp_f32 v110, v110
    v_cvt_pk_bf16_f32 v158, v108, v109
    v_exp_f32 v111, v111
    ds_read_b128 v[164:167], v42 offset:13536
    v_cvt_pk_bf16_f32 v159, v110, v111
    v_mfma_f32_32x32x16_bf16 v[96:111], v[76:79], v[52:55], v[128:143]
    v_exp_f32 v80, v80
    v_exp_f32 v81, v81
    v_exp_f32 v82, v82
    v_cvt_pk_bf16_f32 v144, v80, v81
    v_exp_f32 v83, v83
    s_add_u32 s62, s14, 4096
    buffer_load_dwordx4 v[120:123], v1, s[4:7], s62 offen offset:2048
    v_exp_f32 v84, v84
    v_cvt_pk_bf16_f32 v145, v82, v83
    s_waitcnt lgkmcnt(0)
    v_mfma_f32_32x32x16_bf16 v[176:191], v[160:163], v[152:155], v[176:191]
    v_exp_f32 v85, v85
    v_exp_f32 v86, v86
    v_cvt_pk_bf16_f32 v146, v84, v85
    ds_read_b128 v[168:171], v42 offset:16640
    v_exp_f32 v87, v87
    v_exp_f32 v88, v88
    v_cvt_pk_bf16_f32 v147, v86, v87
    v_exp_f32 v89, v89
    v_exp_f32 v90, v90
    v_cvt_pk_bf16_f32 v148, v88, v89
    v_mfma_f32_32x32x16_bf16 v[176:191], v[164:167], v[156:159], v[176:191]
    v_exp_f32 v91, v91
    buffer_load_dwordx4 v[124:127], v1, s[4:7], s62 offen offset:3072
    v_exp_f32 v92, v92
    v_cvt_pk_bf16_f32 v149, v90, v91
    v_exp_f32 v93, v93
    v_exp_f32 v94, v94
    v_cvt_pk_bf16_f32 v150, v92, v93
    v_exp_f32 v95, v95
    ds_read_b128 v[172:175], v42 offset:17696
    v_cvt_pk_bf16_f32 v151, v94, v95
    v_mfma_f32_32x32x16_bf16 v[80:95], a[240:243], v[52:55], v[128:143]
    v_exp_f32 v96, v96
    v_exp_f32 v97, v97
    s_add_u32 s62, s14, 8192
    buffer_load_dwordx4 v[56:59], v1, s[4:7], s62 offen offset:2048
    v_exp_f32 v98, v98
    v_cvt_pk_bf16_f32 v152, v96, v97
    v_exp_f32 v99, v99
    buffer_load_dwordx4 v[60:63], v1, s[4:7], s62 offen offset:3072
    v_exp_f32 v100, v100
    v_cvt_pk_bf16_f32 v153, v98, v99
    s_waitcnt lgkmcnt(0)
    v_mfma_f32_32x32x16_bf16 v[176:191], v[168:171], v[144:147], v[176:191]
    v_exp_f32 v101, v101
    v_exp_f32 v102, v102
    v_cvt_pk_bf16_f32 v154, v100, v101
    ds_read_b128 v[160:163], v42 offset:20800
    v_exp_f32 v103, v103
    s_add_u32 s62, s14, 12288
    buffer_load_dwordx4 v[64:67], v1, s[4:7], s62 offen offset:2048
    v_exp_f32 v104, v104
    v_cvt_pk_bf16_f32 v155, v102, v103
    v_exp_f32 v105, v105
    buffer_load_dwordx4 v[68:71], v1, s[4:7], s62 offen offset:3072
    v_exp_f32 v106, v106
    v_cvt_pk_bf16_f32 v156, v104, v105
    v_mfma_f32_32x32x16_bf16 v[176:191], v[172:175], v[148:151], v[176:191]
    v_exp_f32 v107, v107
    v_exp_f32 v108, v108
    v_cvt_pk_bf16_f32 v157, v106, v107
    v_exp_f32 v109, v109
    v_exp_f32 v110, v110
    v_cvt_pk_bf16_f32 v158, v108, v109
    v_exp_f32 v111, v111
    ds_read_b128 v[164:167], v42 offset:21856
    v_cvt_pk_bf16_f32 v159, v110, v111
    v_mfma_f32_32x32x16_bf16 v[96:111], a[244:247], v[52:55], v[128:143]
    v_exp_f32 v80, v80
    v_exp_f32 v81, v81
    s_add_u32 s62, s14, 16384
    buffer_load_dwordx4 v[72:75], v1, s[4:7], s62 offen offset:2048
    v_exp_f32 v82, v82
    v_cvt_pk_bf16_f32 v144, v80, v81
    v_exp_f32 v83, v83
    buffer_load_dwordx4 v[76:79], v1, s[4:7], s62 offen offset:3072
    v_exp_f32 v84, v84
    v_cvt_pk_bf16_f32 v145, v82, v83
    s_waitcnt lgkmcnt(0)
    v_mfma_f32_32x32x16_bf16 v[176:191], v[160:163], v[152:155], v[176:191]
    v_exp_f32 v85, v85
    v_exp_f32 v86, v86
    v_cvt_pk_bf16_f32 v146, v84, v85
    ds_read_b128 v[168:171], v42 offset:24960
    v_exp_f32 v87, v87
    v_exp_f32 v88, v88
    v_cvt_pk_bf16_f32 v147, v86, v87
    v_exp_f32 v89, v89
    v_exp_f32 v90, v90
    v_cvt_pk_bf16_f32 v148, v88, v89
    v_mfma_f32_32x32x16_bf16 v[176:191], v[164:167], v[156:159], v[176:191]
    v_exp_f32 v91, v91
    v_exp_f32 v92, v92
    v_cvt_pk_bf16_f32 v149, v90, v91
    v_exp_f32 v93, v93
    v_exp_f32 v94, v94
    v_cvt_pk_bf16_f32 v150, v92, v93
    v_exp_f32 v95, v95
    ds_read_b128 v[172:175], v42 offset:26016
    v_cvt_pk_bf16_f32 v151, v94, v95
    v_exp_f32 v96, v96
    v_exp_f32 v97, v97
    s_add_u32 s62, s14, 20480
    buffer_load_dwordx4 v[80:83], v1, s[4:7], s62 offen offset:2048
    v_exp_f32 v98, v98
    v_cvt_pk_bf16_f32 v152, v96, v97
    v_exp_f32 v99, v99
    buffer_load_dwordx4 v[84:87], v1, s[4:7], s62 offen offset:3072
    v_exp_f32 v100, v100
    v_cvt_pk_bf16_f32 v153, v98, v99
    s_waitcnt lgkmcnt(0)
    v_mfma_f32_32x32x16_bf16 v[176:191], v[168:171], v[144:147], v[176:191]
    v_exp_f32 v101, v101
    v_exp_f32 v102, v102
    v_cvt_pk_bf16_f32 v154, v100, v101
    ds_read_b128 v[160:163], v42 offset:29120
    ds_read_b128 v[164:167], v42 offset:30176
    v_exp_f32 v103, v103
    s_add_u32 s62, s14, 24576
    buffer_load_dwordx4 v[88:91], v1, s[4:7], s62 offen offset:2048
    v_exp_f32 v104, v104
    v_cvt_pk_bf16_f32 v155, v102, v103
    v_exp_f32 v105, v105
    buffer_load_dwordx4 v[92:95], v1, s[4:7], s62 offen offset:3072
    v_exp_f32 v106, v106
    v_cvt_pk_bf16_f32 v156, v104, v105
    v_mfma_f32_32x32x16_bf16 v[176:191], v[172:175], v[148:151], v[176:191]
    v_exp_f32 v107, v107
    v_exp_f32 v108, v108
    v_cvt_pk_bf16_f32 v157, v106, v107
    s_add_u32 s62, s14, 28672
    buffer_load_dwordx4 v[128:131], v1, s[4:7], s62 offen offset:2048
    v_exp_f32 v109, v109
    s_waitcnt lgkmcnt(0)
    v_mfma_f32_32x32x16_bf16 v[176:191], v[160:163], v[152:155], v[176:191]
    v_exp_f32 v110, v110
    v_cvt_pk_bf16_f32 v158, v108, v109
    buffer_load_dwordx4 v[132:135], v1, s[4:7], s62 offen offset:3072
    v_exp_f32 v111, v111
    s_nop 0
    v_cvt_pk_bf16_f32 v159, v110, v111
    s_nop 1
    v_mfma_f32_32x32x16_bf16 v[176:191], v[164:167], v[156:159], v[176:191]
    s_lshr_b32 s30, s20, 1
    s_add_u32 s30, s30, s29
    s_lshl_b32 s30, s30, 15
    s_and_b32 s31, s20, 1
    s_lshl_b32 s31, s31, 14
    s_add_u32 s30, s30, s31
    s_add_u32 s30, s30, 19922944
    v_add_u32 v15, s30, v1
    s_mov_b32 s31, 4096
    s_mov_b32 s32, 8192
    s_mov_b32 s33, 12288
    buffer_load_dword v46, v10, s[4:7], s27 offen offset:512 sc1
    v_rcp_f32 v184, v184
    s_nop 0
    v_mul_f32 v176, v176, v184
    v_mul_f32 v177, v177, v184
    v_mul_f32 v178, v178, v184
    v_mul_f32 v179, v179, v184
    v_mul_f32 v180, v180, v184
    v_mul_f32 v181, v181, v184
    v_mul_f32 v182, v182, v184
    v_mul_f32 v183, v183, v184
    v_cvt_pk_bf16_f32 v188, v176, v177
    v_cvt_pk_bf16_f32 v189, v178, v179
    v_cvt_pk_bf16_f32 v190, v180, v181
    v_cvt_pk_bf16_f32 v191, v182, v183
    buffer_store_dwordx4 v[188:191], v1, s[4:7], s96 offen offset:1024 sc1
    s_waitcnt vmcnt(1)
    v_cmp_ne_u32 vcc, v11, v46
    s_nop 0
    s_and_b64 vcc, vcc, s[60:61]
    s_cbranch_scc0 S_28
    s_mov_b64 exec, s[60:61]
    buffer_load_dword v45, v10, s[4:7], s27 offen offset:512 sc1
    s_waitcnt vmcnt(0)
    v_cmp_ne_u32 vcc, v11, v45
    s_mov_b64 exec, 1
    buffer_store_dword v11, v9, s[4:7], s38 offen offset:768
    s_mov_b64 exec, -1
    s_cbranch_vccz S_29
    s_mov_b64 exec, s[60:61]
S_30:
    buffer_load_dword v45, v10, s[4:7], s27 offen offset:512 sc1
    s_waitcnt vmcnt(0)
    v_cmp_ne_u32 vcc, v11, v45
    s_nop 0
    s_cbranch_vccz S_29
    s_add_u32 s39, s39, 1
    s_cmp_lt_u32 s39, 200000
    s_cbranch_scc1 S_30
S_29:
    s_mov_b64 exec, -1
S_28:
    buffer_load_dwordx4 v[96:99], v15, s[4:7], 0 offen offset:0 sc1
    buffer_load_dwordx4 v[100:103], v15, s[4:7], 0 offen offset:2048 sc1
    buffer_load_dwordx4 v[104:107], v15, s[4:7], s31 offen offset:0 sc1
    buffer_load_dwordx4 v[108:111], v15, s[4:7], s31 offen offset:2048 sc1
    buffer_load_dwordx4 v[136:139], v15, s[4:7], s32 offen offset:0 sc1
    buffer_load_dwordx4 v[140:143], v15, s[4:7], s32 offen offset:2048 sc1
    buffer_load_dwordx4 v[144:147], v15, s[4:7], s33 offen offset:0 sc1
    buffer_load_dwordx4 v[148:151], v15, s[4:7], s33 offen offset:2048 sc1
    s_waitcnt vmcnt(8)
    s_mov_b64 exec, 1
    buffer_store_dword v11, v9, s[4:7], s38 offen offset:768
    s_mov_b64 exec, -1
    s_mov_b64 exec, s[60:61]
S_32:
    buffer_load_dword v45, v10, s[4:7], s27 offen offset:768 sc1
    s_waitcnt vmcnt(0)
    v_cmp_ne_u32 vcc, v11, v45
    s_nop 0
    s_cbranch_vccz S_31
    s_add_u32 s39, s39, 1
    s_cmp_lt_u32 s39, 200000
    s_cbranch_scc1 S_32
S_31:
    s_mov_b64 exec, -1
    buffer_load_dwordx4 v[152:155], v15, s[4:7], 0 offen offset:1024 sc1
    buffer_load_dwordx4 v[156:159], v15, s[4:7], 0 offen offset:3072 sc1
    buffer_load_dwordx4 v[48:51], v15, s[4:7], s31 offen offset:1024 sc1
    buffer_load_dwordx4 v[52:55], v15, s[4:7], s31 offen offset:3072 sc1
    buffer_load_dwordx4 a[240:243], v15, s[4:7], s32 offen offset:1024 sc1
    buffer_load_dwordx4 a[244:247], v15, s[4:7], s32 offen offset:3072 sc1
    buffer_load_dwordx4 a[248:251], v15, s[4:7], s33 offen offset:1024 sc1
    buffer_load_dwordx4 a[252:255], v15, s[4:7], s33 offen offset:3072 sc1
    s_barrier
    v_mfma_f32_32x32x16_bf16 v[160:175], v[192:195], v[96:99], 0
    v_mfma_f32_32x32x16_bf16 v[176:191], v[196:199], v[96:99], 0
    v_mfma_f32_32x32x16_bf16 v[160:175], v[200:203], v[100:103], v[160:175]
    v_mfma_f32_32x32x16_bf16 v[176:191], v[204:207], v[100:103], v[176:191]
    v_mfma_f32_32x32x16_bf16 v[160:175], v[208:211], v[104:107], v[160:175]
    v_mfma_f32_32x32x16_bf16 v[176:191], v[212:215], v[104:107], v[176:191]
    v_mfma_f32_32x32x16_bf16 v[160:175], v[216:219], v[108:111], v[160:175]
    v_mfma_f32_32x32x16_bf16 v[176:191], v[220:223], v[108:111], v[176:191]
    v_mfma_f32_32x32x16_bf16 v[160:175], v[224:227], v[136:139], v[160:175]
    v_mfma_f32_32x32x16_bf16 v[176:191], v[228:231], v[136:139], v[176:191]
    v_mfma_f32_32x32x16_bf16 v[160:175], v[232:235], v[140:143], v[160:175]
    v_mfma_f32_32x32x16_bf16 v[176:191], v[236:239], v[140:143], v[176:191]
    v_mfma_f32_32x32x16_bf16 v[160:175], v[240:243], v[144:147], v[160:175]
    v_mfma_f32_32x32x16_bf16 v[176:191], v[244:247], v[144:147], v[176:191]
    v_mfma_f32_32x32x16_bf16 v[160:175], v[248:251], v[148:151], v[160:175]
    v_mfma_f32_32x32x16_bf16 v[176:191], v[252:255], v[148:151], v[176:191]
    s_mul_i32 s100, s20, 4096
    s_add_u32 m0, s100, 98304
    s_mul_i32 s101, s22, 114688
    s_add_u32 s101, s101, s100
    s_add_u32 s101, s101, 3506176
    buffer_load_dwordx4 v1, s[4:7], s101 offen offset:0 lds
    buffer_load_dwordx4 v1, s[4:7], s101 offen offset:1024 lds
    buffer_load_dwordx4 v1, s[4:7], s101 offen offset:2048 lds
    buffer_load_dwordx4 v1, s[4:7], s101 offen offset:3072 lds
    s_waitcnt vmcnt(11)
    v_mfma_f32_32x32x16_bf16 v[160:175], v[112:115], v[152:155], v[160:175]
    v_mfma_f32_32x32x16_bf16 v[176:191], v[116:119], v[152:155], v[176:191]
    s_waitcnt vmcnt(10)
    v_mfma_f32_32x32x16_bf16 v[160:175], v[120:123], v[156:159], v[160:175]
    v_mfma_f32_32x32x16_bf16 v[176:191], v[124:127], v[156:159], v[176:191]
    s_waitcnt vmcnt(9)
    v_mfma_f32_32x32x16_bf16 v[160:175], v[56:59], v[48:51], v[160:175]
    v_mfma_f32_32x32x16_bf16 v[176:191], v[60:63], v[48:51], v[176:191]
    s_waitcnt vmcnt(8)
    v_mfma_f32_32x32x16_bf16 v[160:175], v[64:67], v[52:55], v[160:175]
    v_mfma_f32_32x32x16_bf16 v[176:191], v[68:71], v[52:55], v[176:191]
    s_waitcnt vmcnt(7)
    v_mfma_f32_32x32x16_bf16 v[160:175], v[72:75], a[240:243], v[160:175]
    v_mfma_f32_32x32x16_bf16 v[176:191], v[76:79], a[240:243], v[176:191]
    s_waitcnt vmcnt(6)
    v_mfma_f32_32x32x16_bf16 v[160:175], v[80:83], a[244:247], v[160:175]
    v_mfma_f32_32x32x16_bf16 v[176:191], v[84:87], a[244:247], v[176:191]
    s_waitcnt vmcnt(5)
    v_mfma_f32_32x32x16_bf16 v[160:175], v[88:91], a[248:251], v[160:175]
    v_mfma_f32_32x32x16_bf16 v[176:191], v[92:95], a[248:251], v[176:191]
    s_waitcnt vmcnt(4)
    v_mfma_f32_32x32x16_bf16 v[160:175], v[128:131], a[252:255], v[160:175]
    v_mfma_f32_32x32x16_bf16 v[176:191], v[132:135], a[252:255], v[176:191]
    s_lshl_b32 s31, s28, 15
    s_add_u32 s30, s31, 16777216
    v_add_u32 v15, s30, v1
    s_nop 7
    ds_write_b128 v12, v[160:163] offset:0
    ds_write_b128 v12, v[164:167] offset:32
    ds_write_b128 v12, v[168:171] offset:64
    ds_write_b128 v12, v[172:175] offset:96
    ds_write_b128 v12, v[176:179] offset:128
    ds_write_b128 v12, v[180:183] offset:160
    ds_write_b128 v12, v[184:187] offset:192
    ds_write_b128 v12, v[188:191] offset:224
    s_waitcnt lgkmcnt(0)
    s_barrier
    ds_read_b128 v[48:51], v13 offset:0
    ds_read_b128 v[52:55], v13 offset:16
    ds_read_b128 v[56:59], v13 offset:8704
    ds_read_b128 v[60:63], v13 offset:8720
    ds_read_b128 v[64:67], v13 offset:17408
    ds_read_b128 v[68:71], v13 offset:17424
    ds_read_b128 v[72:75], v13 offset:26112
    ds_read_b128 v[76:79], v13 offset:26128
    s_waitcnt lgkmcnt(4)
    v_pk_add_f32 v[16:17], v[16:17], v[48:49]
    v_pk_add_f32 v[18:19], v[18:19], v[50:51]
    v_pk_add_f32 v[20:21], v[20:21], v[52:53]
    v_pk_add_f32 v[22:23], v[22:23], v[54:55]
    v_pk_add_f32 v[16:17], v[16:17], v[56:57]
    v_pk_add_f32 v[18:19], v[18:19], v[58:59]
    v_pk_add_f32 v[20:21], v[20:21], v[60:61]
    v_pk_add_f32 v[22:23], v[22:23], v[62:63]
    v_cvt_pk_bf16_f32 v112, v16, v17
    v_cvt_pk_bf16_f32 v113, v18, v19
    v_cvt_pk_bf16_f32 v114, v20, v21
    v_cvt_pk_bf16_f32 v115, v22, v23
    buffer_store_dwordx4 v[112:115], v5, s[4:7], 0 offen
    s_waitcnt lgkmcnt(0)
    v_pk_add_f32 v[24:25], v[24:25], v[64:65]
    v_pk_add_f32 v[26:27], v[26:27], v[66:67]
    v_pk_add_f32 v[28:29], v[28:29], v[68:69]
    v_pk_add_f32 v[30:31], v[30:31], v[70:71]
    v_pk_add_f32 v[24:25], v[24:25], v[72:73]
    v_pk_add_f32 v[26:27], v[26:27], v[74:75]
    v_pk_add_f32 v[28:29], v[28:29], v[76:77]
    v_pk_add_f32 v[30:31], v[30:31], v[78:79]
    v_cvt_pk_bf16_f32 v120, v24, v25
    v_cvt_pk_bf16_f32 v121, v26, v27
    v_cvt_pk_bf16_f32 v122, v28, v29
    v_cvt_pk_bf16_f32 v123, v30, v31
    buffer_store_dwordx4 v[120:123], v5, s[4:7], s63 offen
    v_pk_add_f32 v[116:117], v[16:17], v[18:19]
    v_pk_add_f32 v[124:125], v[24:25], v[26:27]
    v_pk_mul_f32 v[118:119], v[16:17], v[16:17]
    v_pk_mul_f32 v[126:127], v[24:25], v[24:25]
    v_pk_fma_f32 v[118:119], v[18:19], v[18:19], v[118:119]
    v_pk_fma_f32 v[126:127], v[26:27], v[26:27], v[126:127]
    v_pk_add_f32 v[116:117], v[116:117], v[20:21]
    v_pk_add_f32 v[124:125], v[124:125], v[28:29]
    v_pk_fma_f32 v[118:119], v[20:21], v[20:21], v[118:119]
    v_pk_fma_f32 v[126:127], v[28:29], v[28:29], v[126:127]
    v_pk_add_f32 v[116:117], v[116:117], v[22:23]
    v_pk_add_f32 v[124:125], v[124:125], v[30:31]
    v_pk_fma_f32 v[118:119], v[22:23], v[22:23], v[118:119]
    v_pk_fma_f32 v[126:127], v[30:31], v[30:31], v[126:127]
    v_add_f32 v116, v116, v117
    v_add_f32 v124, v124, v125
    v_add_f32 v118, v118, v119
    v_add_f32 v126, v126, v127
    s_nop 0
    v_permlane16_swap_b32 v116, v118
    v_permlane16_swap_b32 v124, v126
    v_add_f32 v116, v116, v118
    v_add_f32 v124, v124, v126
    s_nop 0
    v_add_f32_dpp v116, v116, v116 row_ror:8 row_mask:0xf bank_mask:0xf
    v_add_f32_dpp v124, v124, v124 row_ror:8 row_mask:0xf bank_mask:0xf
    v_mov_b32 v118, v116
    v_mov_b32 v126, v124
    s_nop 0
    v_permlane32_swap_b32 v116, v118
    v_permlane32_swap_b32 v124, v126
    v_add_f32 v116, v116, v118
    v_add_f32 v124, v124, v126
    s_mov_b64 exec, 0xff00ff
    buffer_store_dword v116, v7, s[4:7], 0 offen offset:0
    s_mov_b64 exec, -1
    s_mov_b64 exec, 0xff00ff
    buffer_store_dword v124, v7, s[4:7], 0 offen offset:2048
    s_mov_b64 exec, -1
    s_waitcnt vmcnt(0)
    s_mov_b32 exec_lo, 1
    s_mov_b32 exec_hi, 1
    buffer_store_dword v11, v10, s[4:7], s0 offen offset:1024
    s_mov_b64 exec, -1
    s_barrier
    s_mov_b64 exec, 0xffffffff
S_34:
    buffer_load_dword v45, v10, s[4:7], s34 offen offset:1024 sc1
    s_waitcnt vmcnt(0)
    v_cmp_ne_u32 vcc, v11, v45
    s_nop 0
    s_cbranch_vccz S_33
    s_add_u32 s39, s39, 1
    s_cmp_lt_u32 s39, 200000
    s_cbranch_scc1 S_34
S_33:
    s_mov_b64 exec, -1
    buffer_load_dwordx4 v[48:51], v15, s[4:7], s40 offen offset:0 sc1
    buffer_load_dwordx4 v[52:55], v15, s[4:7], s40 offen offset:1024 sc1
    buffer_load_dwordx4 v[56:59], v15, s[4:7], s40 offen offset:2048 sc1
    buffer_load_dwordx4 v[60:63], v15, s[4:7], s40 offen offset:3072 sc1
    buffer_load_dwordx2 v[240:241], v8, s[4:7], 0 offen offset:0 sc1
    buffer_load_dwordx2 v[242:243], v8, s[4:7], 0 offen offset:256 sc1
    buffer_load_dwordx2 v[244:245], v8, s[4:7], 0 offen offset:512 sc1
    buffer_load_dwordx2 v[246:247], v8, s[4:7], 0 offen offset:768 sc1
    buffer_load_dwordx4 v[64:67], v15, s[4:7], s41 offen offset:0 sc1
    buffer_load_dwordx4 v[68:71], v15, s[4:7], s41 offen offset:1024 sc1
    buffer_load_dwordx4 v[72:75], v15, s[4:7], s41 offen offset:2048 sc1
    buffer_load_dwordx4 v[76:79], v15, s[4:7], s41 offen offset:3072 sc1
    buffer_load_dwordx4 v[80:83], v15, s[4:7], s42 offen offset:0 sc1
    buffer_load_dwordx4 v[84:87], v15, s[4:7], s42 offen offset:1024 sc1
    v_mad_u32_u24 v46, s48, 7, v6
    ds_read_b128 v[160:163], v46 offset:0
    ds_read_b128 v[164:167], v46 offset:1024
    ds_read_b128 v[168:171], v46 offset:2048
    ds_read_b128 v[172:175], v46 offset:3584
    ds_read_b128 v[176:179], v46 offset:4608
    ds_read_b128 v[180:183], v46 offset:5632
    s_waitcnt vmcnt(13) lgkmcnt(3)
    v_mfma_f32_32x32x16_bf16 v[192:207], v[160:163], v[48:51], 0
    ds_read_b128 v[184:187], v46 offset:7168
    v_mfma_f32_32x32x16_bf16 v[208:223], v[164:167], v[48:51], 0
    ds_read_b128 v[188:191], v46 offset:8192
    buffer_load_dwordx4 v[88:91], v15, s[4:7], s42 offen offset:2048 sc1
    v_mfma_f32_32x32x16_bf16 v[224:239], v[168:171], v[48:51], 0
    ds_read_b128 v[160:163], v46 offset:9216
    s_waitcnt vmcnt(13) lgkmcnt(3)
    v_mfma_f32_32x32x16_bf16 v[192:207], v[172:175], v[52:55], v[192:207]
    ds_read_b128 v[164:167], v46 offset:10752
    v_mfma_f32_32x32x16_bf16 v[208:223], v[176:179], v[52:55], v[208:223]
    ds_read_b128 v[168:171], v46 offset:11776
    buffer_load_dwordx4 v[92:95], v15, s[4:7], s42 offen offset:3072 sc1
    v_mfma_f32_32x32x16_bf16 v[224:239], v[180:183], v[52:55], v[224:239]
    ds_read_b128 v[172:175], v46 offset:12800
    s_waitcnt vmcnt(13) lgkmcnt(3)
    v_mfma_f32_32x32x16_bf16 v[192:207], v[184:187], v[56:59], v[192:207]
    v_mad_u32_u24 v47, s49, 7, v6
    ds_read_b128 v[176:179], v47 offset:0
    v_mfma_f32_32x32x16_bf16 v[208:223], v[188:191], v[56:59], v[208:223]
    ds_read_b128 v[180:183], v47 offset:1024
    buffer_load_dwordx4 v[96:99], v15, s[4:7], s43 offen offset:0 sc1
    v_mfma_f32_32x32x16_bf16 v[224:239], v[160:163], v[56:59], v[224:239]
    ds_read_b128 v[184:187], v47 offset:2048
    s_waitcnt vmcnt(13) lgkmcnt(3)
    v_mfma_f32_32x32x16_bf16 v[192:207], v[164:167], v[60:63], v[192:207]
    ds_read_b128 v[188:191], v47 offset:3584
    v_mfma_f32_32x32x16_bf16 v[208:223], v[168:171], v[60:63], v[208:223]
    ds_read_b128 v[160:163], v47 offset:4608
    buffer_load_dwordx4 v[100:103], v15, s[4:7], s43 offen offset:1024 sc1
    v_mfma_f32_32x32x16_bf16 v[224:239], v[172:175], v[60:63], v[224:239]
    ds_read_b128 v[164:167], v47 offset:5632
    s_waitcnt vmcnt(9) lgkmcnt(3)
    v_mfma_f32_32x32x16_bf16 v[192:207], v[176:179], v[64:67], v[192:207]
    ds_read_b128 v[168:171], v47 offset:7168
    v_mfma_f32_32x32x16_bf16 v[208:223], v[180:183], v[64:67], v[208:223]
    ds_read_b128 v[172:175], v47 offset:8192
    buffer_load_dwordx4 v[104:107], v15, s[4:7], s43 offen offset:2048 sc1
    v_add_f32 v240, v240, v242
    v_mfma_f32_32x32x16_bf16 v[224:239], v[184:187], v[64:67], v[224:239]
    ds_read_b128 v[176:179], v47 offset:9216
    v_add_f32 v244, v244, v246
    s_waitcnt vmcnt(9) lgkmcnt(3)
    v_mfma_f32_32x32x16_bf16 v[192:207], v[188:191], v[68:71], v[192:207]
    ds_read_b128 v[180:183], v47 offset:10752
    v_add_f32 v241, v241, v243
    v_mfma_f32_32x32x16_bf16 v[208:223], v[160:163], v[68:71], v[208:223]
    ds_read_b128 v[184:187], v47 offset:11776
    buffer_load_dwordx4 v[108:111], v15, s[4:7], s43 offen offset:3072 sc1
    v_add_f32 v245, v245, v247
    v_mfma_f32_32x32x16_bf16 v[224:239], v[164:167], v[68:71], v[224:239]
    ds_read_b128 v[188:191], v47 offset:12800
    v_add_f32 v240, v240, v244
    s_waitcnt vmcnt(9) lgkmcnt(3)
    v_mfma_f32_32x32x16_bf16 v[192:207], v[168:171], v[72:75], v[192:207]
    v_mad_u32_u24 v46, s50, 7, v6
    ds_read_b128 v[160:163], v46 offset:0
    v_add_f32 v241, v241, v245
    v_mfma_f32_32x32x16_bf16 v[208:223], v[172:175], v[72:75], v[208:223]
    ds_read_b128 v[164:167], v46 offset:1024
    buffer_load_dwordx4 v[112:115], v15, s[4:7], s44 offen offset:0 sc1
    v_mov_b32 v242, v240
    v_mfma_f32_32x32x16_bf16 v[224:239], v[176:179], v[72:75], v[224:239]
    ds_read_b128 v[168:171], v46 offset:2048
    v_mov_b32 v243, v241
    s_waitcnt vmcnt(9) lgkmcnt(3)
    v_mfma_f32_32x32x16_bf16 v[192:207], v[180:183], v[76:79], v[192:207]
    ds_read_b128 v[172:175], v46 offset:3584
    v_mov_b32 v250, 0
    v_mfma_f32_32x32x16_bf16 v[208:223], v[184:187], v[76:79], v[208:223]
    ds_read_b128 v[176:179], v46 offset:4608
    buffer_load_dwordx4 v[116:119], v15, s[4:7], s44 offen offset:1024 sc1
    v_permlane32_swap_b32 v240, v242
    v_mfma_f32_32x32x16_bf16 v[224:239], v[188:191], v[76:79], v[224:239]
    ds_read_b128 v[180:183], v46 offset:5632
    v_permlane32_swap_b32 v241, v243
    s_waitcnt vmcnt(9) lgkmcnt(3)
    v_mfma_f32_32x32x16_bf16 v[192:207], v[160:163], v[80:83], v[192:207]
    ds_read_b128 v[184:187], v46 offset:7168
    v_add_f32 v240, v240, v242
    v_mfma_f32_32x32x16_bf16 v[208:223], v[164:167], v[80:83], v[208:223]
    ds_read_b128 v[188:191], v46 offset:8192
    buffer_load_dwordx4 v[120:123], v15, s[4:7], s44 offen offset:2048 sc1
    v_add_f32 v241, v241, v243
    v_mfma_f32_32x32x16_bf16 v[224:239], v[168:171], v[80:83], v[224:239]
    ds_read_b128 v[160:163], v46 offset:9216
    v_mul_f32 v240, 0xbb000000, v240
    s_waitcnt vmcnt(9) lgkmcnt(3)
    v_mfma_f32_32x32x16_bf16 v[192:207], v[172:175], v[84:87], v[192:207]
    ds_read_b128 v[164:167], v46 offset:10752
    v_mul_f32 v241, 0x3b000000, v241
    v_mfma_f32_32x32x16_bf16 v[208:223], v[176:179], v[84:87], v[208:223]
    ds_read_b128 v[168:171], v46 offset:11776
    buffer_load_dwordx4 v[124:127], v15, s[4:7], s44 offen offset:3072 sc1
    v_fma_f32 v241, -v240, v240, v241
    v_mfma_f32_32x32x16_bf16 v[224:239], v[180:183], v[84:87], v[224:239]
    ds_read_b128 v[172:175], v46 offset:12800
    v_max_f32 v241, 0, v241
    s_waitcnt vmcnt(9) lgkmcnt(3)
    v_mfma_f32_32x32x16_bf16 v[192:207], v[184:187], v[88:91], v[192:207]
    v_mad_u32_u24 v47, s51, 7, v6
    ds_read_b128 v[176:179], v47 offset:0
    v_add_f32 v241, 0x3727c5ac, v241
    v_mfma_f32_32x32x16_bf16 v[208:223], v[188:191], v[88:91], v[208:223]
    ds_read_b128 v[180:183], v47 offset:1024
    buffer_load_dwordx4 v[128:131], v15, s[4:7], s45 offen offset:0 sc1
    v_rsq_f32 v252, v241
    v_mfma_f32_32x32x16_bf16 v[224:239], v[160:163], v[88:91], v[224:239]
    ds_read_b128 v[184:187], v47 offset:2048
    v_cvt_pk_bf16_f32 v242, v240, v240
    s_waitcnt vmcnt(9) lgkmcnt(3)
    v_mfma_f32_32x32x16_bf16 v[192:207], v[164:167], v[92:95], v[192:207]
    ds_read_b128 v[188:191], v47 offset:3584
    v_and_b32 v243, 0xffff0000, v242
    v_mfma_f32_32x32x16_bf16 v[208:223], v[168:171], v[92:95], v[208:223]
    ds_read_b128 v[160:163], v47 offset:4608
    buffer_load_dwordx4 v[132:135], v15, s[4:7], s45 offen offset:1024 sc1
    v_sub_f32 v243, v240, v243
    v_mfma_f32_32x32x16_bf16 v[224:239], v[172:175], v[92:95], v[224:239]
    ds_read_b128 v[164:167], v47 offset:5632
    v_lshrrev_b32 v249, 5, v0
    s_waitcnt vmcnt(9) lgkmcnt(3)
    v_mfma_f32_32x32x16_bf16 v[192:207], v[176:179], v[96:99], v[192:207]
    ds_read_b128 v[168:171], v47 offset:7168
    v_add_u32 v249, -1, v249
    v_mfma_f32_32x32x16_bf16 v[208:223], v[180:183], v[96:99], v[208:223]
    ds_read_b128 v[172:175], v47 offset:8192
    buffer_load_dwordx4 v[136:139], v15, s[4:7], s45 offen offset:2048 sc1
    v_cvt_pk_bf16_f32 v242, v240, v243
    v_mfma_f32_32x32x16_bf16 v[224:239], v[184:187], v[96:99], v[224:239]
    ds_read_b128 v[176:179], v47 offset:9216
    v_mov_b32 v251, 0
    s_waitcnt vmcnt(9) lgkmcnt(3)
    v_mfma_f32_32x32x16_bf16 v[192:207], v[188:191], v[100:103], v[192:207]
    ds_read_b128 v[180:183], v47 offset:10752
    v_mov_b32 v253, v252
    v_mfma_f32_32x32x16_bf16 v[208:223], v[160:163], v[100:103], v[208:223]
    ds_read_b128 v[184:187], v47 offset:11776
    buffer_load_dwordx4 v[140:143], v15, s[4:7], s45 offen offset:3072 sc1
    v_and_b32 v248, v249, v242
    v_mfma_f32_32x32x16_bf16 v[224:239], v[164:167], v[100:103], v[224:239]
    ds_read_b128 v[188:191], v47 offset:12800
    v_mov_b32 v249, v248
    s_waitcnt vmcnt(9) lgkmcnt(3)
    v_mfma_f32_32x32x16_bf16 v[192:207], v[168:171], v[104:107], v[192:207]
    v_mad_u32_u24 v46, s52, 7, v6
    ds_read_b128 v[160:163], v46 offset:0
    v_mul_f32 v254, 0xbfb8aa3b, v252
    v_mfma_f32_32x32x16_bf16 v[208:223], v[172:175], v[104:107], v[208:223]
    ds_read_b128 v[164:167], v46 offset:1024
    buffer_load_dwordx4 v[144:147], v15, s[4:7], s46 offen offset:0 sc1
    v_mov_b32 v255, v254
    v_mfma_f32_32x32x16_bf16 v[224:239], v[176:179], v[104:107], v[224:239]
    ds_read_b128 v[168:171], v46 offset:2048
    s_waitcnt vmcnt(9) lgkmcnt(3)
    v_mfma_f32_32x32x16_bf16 v[192:207], v[180:183], v[108:111], v[192:207]
    ds_read_b128 v[172:175], v46 offset:3584
    v_mfma_f32_32x32x16_bf16 v[208:223], v[184:187], v[108:111], v[208:223]
    ds_read_b128 v[176:179], v46 offset:4608
    buffer_load_dwordx4 v[148:151], v15, s[4:7], s46 offen offset:1024 sc1
    v_mfma_f32_32x32x16_bf16 v[224:239], v[188:191], v[108:111], v[224:239]
    ds_read_b128 v[180:183], v46 offset:5632
    s_waitcnt vmcnt(9) lgkmcnt(3)
    v_mfma_f32_32x32x16_bf16 v[192:207], v[160:163], v[112:115], v[192:207]
    ds_read_b128 v[184:187], v46 offset:7168
    v_mfma_f32_32x32x16_bf16 v[208:223], v[164:167], v[112:115], v[208:223]
    ds_read_b128 v[188:191], v46 offset:8192
    buffer_load_dwordx4 v[152:155], v15, s[4:7], s46 offen offset:2048 sc1
    v_mfma_f32_32x32x16_bf16 v[224:239], v[168:171], v[112:115], v[224:239]
    ds_read_b128 v[160:163], v46 offset:9216
    v_mfma_f32_32x32x16_bf16 v[192:207], a[230:233], v[248:251], v[192:207]
    v_mfma_f32_32x32x16_bf16 v[208:223], a[232:235], v[248:251], v[208:223]
    v_mfma_f32_32x32x16_bf16 v[224:239], a[234:237], v[248:251], v[224:239]
    s_waitcnt vmcnt(9) lgkmcnt(3)
    v_mfma_f32_32x32x16_bf16 v[192:207], v[172:175], v[116:119], v[192:207]
    ds_read_b128 v[164:167], v46 offset:10752
    v_mfma_f32_32x32x16_bf16 v[208:223], v[176:179], v[116:119], v[208:223]
    ds_read_b128 v[168:171], v46 offset:11776
    buffer_load_dwordx4 v[156:159], v15, s[4:7], s46 offen offset:3072 sc1
    v_mfma_f32_32x32x16_bf16 v[224:239], v[180:183], v[116:119], v[224:239]
    ds_read_b128 v[172:175], v46 offset:12800
    s_waitcnt vmcnt(9) lgkmcnt(3)
    v_mfma_f32_32x32x16_bf16 v[192:207], v[184:187], v[120:123], v[192:207]
    v_mad_u32_u24 v47, s53, 7, v6
    ds_read_b128 v[176:179], v47 offset:0
    v_mfma_f32_32x32x16_bf16 v[208:223], v[188:191], v[120:123], v[208:223]
    ds_read_b128 v[180:183], v47 offset:1024
    buffer_load_dwordx4 a[240:243], v15, s[4:7], s47 offen offset:0 sc1
    v_mfma_f32_32x32x16_bf16 v[224:239], v[160:163], v[120:123], v[224:239]
    ds_read_b128 v[184:187], v47 offset:2048
    s_waitcnt vmcnt(9) lgkmcnt(3)
    v_mfma_f32_32x32x16_bf16 v[192:207], v[164:167], v[124:127], v[192:207]
    ds_read_b128 v[188:191], v47 offset:3584
    v_mfma_f32_32x32x16_bf16 v[208:223], v[168:171], v[124:127], v[208:223]
    ds_read_b128 v[160:163], v47 offset:4608
    buffer_load_dwordx4 a[244:247], v15, s[4:7], s47 offen offset:1024 sc1
    v_mfma_f32_32x32x16_bf16 v[224:239], v[172:175], v[124:127], v[224:239]
    ds_read_b128 v[164:167], v47 offset:5632
    s_waitcnt vmcnt(9) lgkmcnt(3)
    v_mfma_f32_32x32x16_bf16 v[192:207], v[176:179], v[128:131], v[192:207]
    ds_read_b128 v[168:171], v47 offset:7168
    v_mfma_f32_32x32x16_bf16 v[208:223], v[180:183], v[128:131], v[208:223]
    ds_read_b128 v[172:175], v47 offset:8192
    buffer_load_dwordx4 a[248:251], v15, s[4:7], s47 offen offset:2048 sc1
    v_mfma_f32_32x32x16_bf16 v[224:239], v[184:187], v[128:131], v[224:239]
    ds_read_b128 v[176:179], v47 offset:9216
    s_waitcnt vmcnt(9) lgkmcnt(3)
    v_mfma_f32_32x32x16_bf16 v[192:207], v[188:191], v[132:135], v[192:207]
    ds_read_b128 v[180:183], v47 offset:10752
    v_mfma_f32_32x32x16_bf16 v[208:223], v[160:163], v[132:135], v[208:223]
    ds_read_b128 v[184:187], v47 offset:11776
    buffer_load_dwordx4 a[252:255], v15, s[4:7], s47 offen offset:3072 sc1
    v_mfma_f32_32x32x16_bf16 v[224:239], v[164:167], v[132:135], v[224:239]
    ds_read_b128 v[188:191], v47 offset:12800
    s_waitcnt vmcnt(9) lgkmcnt(3)
    v_mfma_f32_32x32x16_bf16 v[192:207], v[168:171], v[136:139], v[192:207]
    v_mad_u32_u24 v46, s54, 7, v6
    ds_read_b128 v[160:163], v46 offset:0
    v_mfma_f32_32x32x16_bf16 v[208:223], v[172:175], v[136:139], v[208:223]
    ds_read_b128 v[164:167], v46 offset:1024
    v_mfma_f32_32x32x16_bf16 v[224:239], v[176:179], v[136:139], v[224:239]
    ds_read_b128 v[168:171], v46 offset:2048
    s_waitcnt vmcnt(8) lgkmcnt(3)
    v_mfma_f32_32x32x16_bf16 v[192:207], v[180:183], v[140:143], v[192:207]
    ds_read_b128 v[172:175], v46 offset:3584
    v_mfma_f32_32x32x16_bf16 v[208:223], v[184:187], v[140:143], v[208:223]
    ds_read_b128 v[176:179], v46 offset:4608
    v_mfma_f32_32x32x16_bf16 v[224:239], v[188:191], v[140:143], v[224:239]
    ds_read_b128 v[180:183], v46 offset:5632
    s_waitcnt vmcnt(7) lgkmcnt(3)
    v_mfma_f32_32x32x16_bf16 v[192:207], v[160:163], v[144:147], v[192:207]
    ds_read_b128 v[184:187], v46 offset:7168
    v_mfma_f32_32x32x16_bf16 v[208:223], v[164:167], v[144:147], v[208:223]
    ds_read_b128 v[188:191], v46 offset:8192
    v_mfma_f32_32x32x16_bf16 v[224:239], v[168:171], v[144:147], v[224:239]
    ds_read_b128 v[160:163], v46 offset:9216
    s_mul_i32 s30, s28, 114688
    s_mul_i32 s31, s22, 7168
    s_add_u32 s30, s30, s31
    s_add_u32 s96, s30, 22020096
    s_add_u32 s97, s96, 4096
    s_waitcnt vmcnt(6) lgkmcnt(3)
    v_mfma_f32_32x32x16_bf16 v[192:207], v[172:175], v[148:151], v[192:207]
    ds_read_b128 v[164:167], v46 offset:10752
    v_mfma_f32_32x32x16_bf16 v[208:223], v[176:179], v[148:151], v[208:223]
    ds_read_b128 v[168:171], v46 offset:11776
    v_mfma_f32_32x32x16_bf16 v[224:239], v[180:183], v[148:151], v[224:239]
    ds_read_b128 v[172:175], v46 offset:12800
    s_waitcnt vmcnt(5) lgkmcnt(3)
    v_mfma_f32_32x32x16_bf16 v[192:207], v[184:187], v[152:155], v[192:207]
    v_mad_u32_u24 v47, s55, 7, v6
    ds_read_b128 v[176:179], v47 offset:0
    v_mfma_f32_32x32x16_bf16 v[208:223], v[188:191], v[152:155], v[208:223]
    ds_read_b128 v[180:183], v47 offset:1024
    v_mfma_f32_32x32x16_bf16 v[224:239], v[160:163], v[152:155], v[224:239]
    ds_read_b128 v[184:187], v47 offset:2048
    s_waitcnt vmcnt(4) lgkmcnt(3)
    v_mfma_f32_32x32x16_bf16 v[192:207], v[164:167], v[156:159], v[192:207]
    ds_read_b128 v[188:191], v47 offset:3584
    v_mfma_f32_32x32x16_bf16 v[208:223], v[168:171], v[156:159], v[208:223]
    ds_read_b128 v[160:163], v47 offset:4608
    v_mfma_f32_32x32x16_bf16 v[224:239], v[172:175], v[156:159], v[224:239]
    ds_read_b128 v[164:167], v47 offset:5632
    s_waitcnt vmcnt(3) lgkmcnt(3)
    v_mfma_f32_32x32x16_bf16 v[192:207], v[176:179], a[240:243], v[192:207]
    ds_read_b128 v[168:171], v47 offset:7168
    v_mfma_f32_32x32x16_bf16 v[208:223], v[180:183], a[240:243], v[208:223]
    ds_read_b128 v[172:175], v47 offset:8192
    v_mfma_f32_32x32x16_bf16 v[224:239], v[184:187], a[240:243], v[224:239]
    ds_read_b128 v[176:179], v47 offset:9216
    s_waitcnt vmcnt(2) lgkmcnt(3)
    v_mfma_f32_32x32x16_bf16 v[192:207], v[188:191], a[244:247], v[192:207]
    ds_read_b128 v[180:183], v47 offset:10752
    v_mfma_f32_32x32x16_bf16 v[208:223], v[160:163], a[244:247], v[208:223]
    ds_read_b128 v[184:187], v47 offset:11776
    v_mfma_f32_32x32x16_bf16 v[224:239], v[164:167], a[244:247], v[224:239]
    ds_read_b128 v[188:191], v47 offset:12800
    s_waitcnt vmcnt(1) lgkmcnt(3)
    v_mfma_f32_32x32x16_bf16 v[192:207], v[168:171], a[248:251], v[192:207]
    v_mfma_f32_32x32x16_bf16 v[208:223], v[172:175], a[248:251], v[208:223]
    v_mfma_f32_32x32x16_bf16 v[224:239], v[176:179], a[248:251], v[224:239]
    v_mad_u32_u24 v46, s48, 7, v6
    s_waitcnt vmcnt(0) lgkmcnt(0)
    v_mfma_f32_32x32x16_bf16 v[192:207], v[180:183], a[252:255], v[192:207]
    v_mfma_f32_32x32x16_bf16 v[208:223], v[184:187], a[252:255], v[208:223]
    v_mfma_f32_32x32x16_bf16 v[224:239], v[188:191], a[252:255], v[224:239]
    ds_read_b128 v[160:163], v46 offset:3072
    ds_read_b128 v[164:167], v46 offset:6656
    ds_read_b128 v[168:171], v46 offset:10240
    v_mfma_f32_32x32x16_bf16 v[176:191], a[236:239], v[248:251], 0
    s_waitcnt lgkmcnt(1)
    v_mfma_f32_32x32x16_bf16 v[176:191], v[160:163], v[48:51], v[176:191]
    ds_read_b128 v[172:175], v46 offset:13824
    v_mfma_f32_32x32x16_bf16 v[176:191], v[164:167], v[52:55], v[176:191]
    v_mad_u32_u24 v47, s49, 7, v6
    ds_read_b128 v[160:163], v47 offset:3072
    v_mul_f32 v240, v254, v192
    v_mul_f32 v241, v254, v193
    v_mul_f32 v242, v254, v194
    v_mul_f32 v243, v254, v195
    v_mul_f32 v244, v254, v196
    v_mul_f32 v245, v254, v197
    s_waitcnt lgkmcnt(1)
    v_mfma_f32_32x32x16_bf16 v[176:191], v[168:171], v[56:59], v[176:191]
    ds_read_b128 v[164:167], v47 offset:6656
    v_mul_f32 v246, v254, v198
    v_mul_f32 v247, v254, v199
    v_exp_f32 v240, v240
    v_mul_f32 v192, v252, v192
    v_exp_f32 v241, v241
    v_mul_f32 v193, v252, v193
    v_mfma_f32_32x32x16_bf16 v[176:191], v[172:175], v[60:63], v[176:191]
    ds_read_b128 v[168:171], v47 offset:10240
    v_exp_f32 v242, v242
    v_mul_f32 v194, v252, v194
    v_exp_f32 v243, v243
    v_mul_f32 v195, v252, v195
    v_exp_f32 v244, v244
    v_mul_f32 v196, v252, v196
    s_waitcnt lgkmcnt(1)
    v_mfma_f32_32x32x16_bf16 v[176:191], v[160:163], v[64:67], v[176:191]
    ds_read_b128 v[172:175], v47 offset:13824
    v_exp_f32 v245, v245
    v_mul_f32 v197, v252, v197
    v_exp_f32 v246, v246
    v_mul_f32 v198, v252, v198
    v_exp_f32 v247, v247
    v_mul_f32 v199, v252, v199
    v_mfma_f32_32x32x16_bf16 v[176:191], v[164:167], v[68:71], v[176:191]
    v_mad_u32_u24 v46, s50, 7, v6
    ds_read_b128 v[160:163], v46 offset:3072
    v_add_f32 v240, 1.0, v240
    v_add_f32 v241, 1.0, v241
    v_add_f32 v242, 1.0, v242
    v_add_f32 v243, 1.0, v243
    v_add_f32 v244, 1.0, v244
    v_add_f32 v245, 1.0, v245
    s_waitcnt lgkmcnt(1)
    v_mfma_f32_32x32x16_bf16 v[176:191], v[168:171], v[72:75], v[176:191]
    ds_read_b128 v[164:167], v46 offset:6656
    v_add_f32 v246, 1.0, v246
    v_add_f32 v247, 1.0, v247
    v_rcp_f32 v240, v240
    v_rcp_f32 v241, v241
    v_rcp_f32 v242, v242
    v_rcp_f32 v243, v243
    v_mfma_f32_32x32x16_bf16 v[176:191], v[172:175], v[76:79], v[176:191]
    ds_read_b128 v[168:171], v46 offset:10240
    v_rcp_f32 v244, v244
    v_rcp_f32 v245, v245
    v_rcp_f32 v246, v246
    v_rcp_f32 v247, v247
    v_mul_f32 v192, v192, v240
    v_mul_f32 v193, v193, v241
    s_waitcnt lgkmcnt(1)
    v_mfma_f32_32x32x16_bf16 v[176:191], v[160:163], v[80:83], v[176:191]
    ds_read_b128 v[172:175], v46 offset:13824
    v_mul_f32 v194, v194, v242
    v_mul_f32 v195, v195, v243
    v_mul_f32 v196, v196, v244
    v_mul_f32 v197, v197, v245
    v_mul_f32 v198, v198, v246
    v_mul_f32 v199, v199, v247
    v_mfma_f32_32x32x16_bf16 v[176:191], v[164:167], v[84:87], v[176:191]
    v_mad_u32_u24 v47, s51, 7, v6
    ds_read_b128 v[160:163], v47 offset:3072
    v_cvt_pk_bf16_f32 v192, v192, v193
    v_cvt_pk_bf16_f32 v193, v194, v195
    v_cvt_pk_bf16_f32 v194, v196, v197
    v_cvt_pk_bf16_f32 v195, v198, v199
    buffer_store_dwordx4 v[192:195], v1, s[4:7], s96 offen offset:0 sc1
    v_mul_f32 v240, v254, v200
    s_waitcnt lgkmcnt(1)
    v_mfma_f32_32x32x16_bf16 v[176:191], v[168:171], v[88:91], v[176:191]
    ds_read_b128 v[164:167], v47 offset:6656
    v_mul_f32 v241, v254, v201
    v_mul_f32 v242, v254, v202
    v_mul_f32 v243, v254, v203
    v_mul_f32 v244, v254, v204
    v_mul_f32 v245, v254, v205
    v_mul_f32 v246, v254, v206
    v_mfma_f32_32x32x16_bf16 v[176:191], v[172:175], v[92:95], v[176:191]
    ds_read_b128 v[168:171], v47 offset:10240
    v_mul_f32 v247, v254, v207
    v_exp_f32 v240, v240
    v_mul_f32 v200, v252, v200
    v_exp_f32 v241, v241
    v_mul_f32 v201, v252, v201
    v_exp_f32 v242, v242
    s_waitcnt lgkmcnt(1)
    v_mfma_f32_32x32x16_bf16 v[176:191], v[160:163], v[96:99], v[176:191]
    ds_read_b128 v[172:175], v47 offset:13824
    v_mul_f32 v202, v252, v202
    v_exp_f32 v243, v243
    v_mul_f32 v203, v252, v203
    v_exp_f32 v244, v244
    v_mul_f32 v204, v252, v204
    v_exp_f32 v245, v245
    v_mfma_f32_32x32x16_bf16 v[176:191], v[164:167], v[100:103], v[176:191]
    v_mad_u32_u24 v46, s52, 7, v6
    ds_read_b128 v[160:163], v46 offset:3072
    v_mul_f32 v205, v252, v205
    v_exp_f32 v246, v246
    v_mul_f32 v206, v252, v206
    v_exp_f32 v247, v247
    v_mul_f32 v207, v252, v207
    v_add_f32 v240, 1.0, v240
    s_waitcnt lgkmcnt(1)
    v_mfma_f32_32x32x16_bf16 v[176:191], v[168:171], v[104:107], v[176:191]
    ds_read_b128 v[164:167], v46 offset:6656
    v_add_f32 v241, 1.0, v241
    v_add_f32 v242, 1.0, v242
    v_add_f32 v243, 1.0, v243
    v_add_f32 v244, 1.0, v244
    v_add_f32 v245, 1.0, v245
    v_add_f32 v246, 1.0, v246
    v_mfma_f32_32x32x16_bf16 v[176:191], v[172:175], v[108:111], v[176:191]
    ds_read_b128 v[168:171], v46 offset:10240
    v_add_f32 v247, 1.0, v247
    v_rcp_f32 v240, v240
    v_rcp_f32 v241, v241
    v_rcp_f32 v242, v242
    v_rcp_f32 v243, v243
    v_rcp_f32 v244, v244
    s_waitcnt lgkmcnt(1)
    v_mfma_f32_32x32x16_bf16 v[176:191], v[160:163], v[112:115], v[176:191]
    ds_read_b128 v[172:175], v46 offset:13824
    v_rcp_f32 v245, v245
    v_rcp_f32 v246, v246
    v_rcp_f32 v247, v247
    v_mul_f32 v200, v200, v240
    v_mul_f32 v201, v201, v241
    v_mul_f32 v202, v202, v242
    v_mfma_f32_32x32x16_bf16 v[176:191], v[164:167], v[116:119], v[176:191]
    v_mad_u32_u24 v47, s53, 7, v6
    ds_read_b128 v[160:163], v47 offset:3072
    v_mul_f32 v203, v203, v243
    v_mul_f32 v204, v204, v244
    v_mul_f32 v205, v205, v245
    v_mul_f32 v206, v206, v246
    v_mul_f32 v207, v207, v247
    v_cvt_pk_bf16_f32 v200, v200, v201
    s_waitcnt lgkmcnt(1)
    v_mfma_f32_32x32x16_bf16 v[176:191], v[168:171], v[120:123], v[176:191]
    ds_read_b128 v[164:167], v47 offset:6656
    v_cvt_pk_bf16_f32 v201, v202, v203
    v_cvt_pk_bf16_f32 v202, v204, v205
    v_cvt_pk_bf16_f32 v203, v206, v207
    buffer_store_dwordx4 v[200:203], v1, s[4:7], s96 offen offset:1024 sc1
    v_mul_f32 v240, v254, v208
    v_mul_f32 v241, v254, v209
    v_mfma_f32_32x32x16_bf16 v[176:191], v[172:175], v[124:127], v[176:191]
    ds_read_b128 v[168:171], v47 offset:10240
    v_mul_f32 v242, v254, v210
    v_mul_f32 v243, v254, v211
    v_mul_f32 v244, v254, v212
    v_mul_f32 v245, v254, v213
    v_mul_f32 v246, v254, v214
    v_mul_f32 v247, v254, v215
    s_waitcnt lgkmcnt(1)
    v_mfma_f32_32x32x16_bf16 v[176:191], v[160:163], v[128:131], v[176:191]
    ds_read_b128 v[172:175], v47 offset:13824
    v_exp_f32 v240, v240
    v_mul_f32 v208, v252, v208
    v_exp_f32 v241, v241
    v_mul_f32 v209, v252, v209
    v_exp_f32 v242, v242
    v_mul_f32 v210, v252, v210
    v_mfma_f32_32x32x16_bf16 v[176:191], v[164:167], v[132:135], v[176:191]
    v_mad_u32_u24 v46, s54, 7, v6
    ds_read_b128 v[160:163], v46 offset:3072
    v_exp_f32 v243, v243
    v_mul_f32 v211, v252, v211
    v_exp_f32 v244, v244
    v_mul_f32 v212, v252, v212
    v_exp_f32 v245, v245
    v_mul_f32 v213, v252, v213
    s_waitcnt lgkmcnt(1)
    v_mfma_f32_32x32x16_bf16 v[176:191], v[168:171], v[136:139], v[176:191]
    ds_read_b128 v[164:167], v46 offset:6656
    v_exp_f32 v246, v246
    v_mul_f32 v214, v252, v214
    v_exp_f32 v247, v247
    v_mul_f32 v215, v252, v215
    v_add_f32 v240, 1.0, v240
    v_add_f32 v241, 1.0, v241
    v_mfma_f32_32x32x16_bf16 v[176:191], v[172:175], v[140:143], v[176:191]
    ds_read_b128 v[168:171], v46 offset:10240
    v_add_f32 v242, 1.0, v242
    v_add_f32 v243, 1.0, v243
    v_add_f32 v244, 1.0, v244
    v_add_f32 v245, 1.0, v245
    v_add_f32 v246, 1.0, v246
    v_add_f32 v247, 1.0, v247
    s_waitcnt lgkmcnt(1)
    v_mfma_f32_32x32x16_bf16 v[176:191], v[160:163], v[144:147], v[176:191]
    ds_read_b128 v[172:175], v46 offset:13824
    v_rcp_f32 v240, v240
    v_rcp_f32 v241, v241
    v_rcp_f32 v242, v242
    v_rcp_f32 v243, v243
    v_rcp_f32 v244, v244
    v_rcp_f32 v245, v245
    v_mfma_f32_32x32x16_bf16 v[176:191], v[164:167], v[148:151], v[176:191]
    v_mad_u32_u24 v47, s55, 7, v6
    ds_read_b128 v[160:163], v47 offset:3072
    v_rcp_f32 v246, v246
    v_rcp_f32 v247, v247
    v_mul_f32 v208, v208, v240
    v_mul_f32 v209, v209, v241
    v_mul_f32 v210, v210, v242
    v_mul_f32 v211, v211, v243
    s_waitcnt lgkmcnt(1)
    v_mfma_f32_32x32x16_bf16 v[176:191], v[168:171], v[152:155], v[176:191]
    ds_read_b128 v[164:167], v47 offset:6656
    v_mul_f32 v212, v212, v244
    v_mul_f32 v213, v213, v245
    v_mul_f32 v214, v214, v246
    v_mul_f32 v215, v215, v247
    v_cvt_pk_bf16_f32 v208, v208, v209
    v_cvt_pk_bf16_f32 v209, v210, v211
    v_mfma_f32_32x32x16_bf16 v[176:191], v[172:175], v[156:159], v[176:191]
    ds_read_b128 v[168:171], v47 offset:10240
    v_cvt_pk_bf16_f32 v210, v212, v213
    v_cvt_pk_bf16_f32 v211, v214, v215
    buffer_store_dwordx4 v[208:211], v1, s[4:7], s96 offen offset:2048 sc1
    s_waitcnt lgkmcnt(1)
    v_mfma_f32_32x32x16_bf16 v[176:191], v[160:163], a[240:243], v[176:191]
    ds_read_b128 v[172:175], v47 offset:13824
    v_mfma_f32_32x32x16_bf16 v[176:191], v[164:167], a[244:247], v[176:191]
    s_waitcnt lgkmcnt(0)
    v_mfma_f32_32x32x16_bf16 v[176:191], v[168:171], a[248:251], v[176:191]
    v_mfma_f32_32x32x16_bf16 v[176:191], v[172:175], a[252:255], v[176:191]
    s_mul_i32 s30, s29, 114688
    s_mul_i32 s31, s20, 28672
    s_add_u32 s30, s30, s31
    s_add_u32 s30, s30, 22020096
    v_add_u32 v15, s30, v1
    v_add_u32 v47, 4096, v15
    v_add_u32 v2, 114688, v15
    v_add_u32 v3, 118784, v15
    v_pk_mul_f32 v[240:241], v[254:255], v[216:217]
    v_pk_mul_f32 v[242:243], v[254:255], v[218:219]
    v_pk_mul_f32 v[244:245], v[254:255], v[220:221]
    v_pk_mul_f32 v[246:247], v[254:255], v[222:223]
    v_exp_f32 v240, v240
    v_exp_f32 v241, v241
    v_pk_mul_f32 v[216:217], v[252:253], v[216:217]
    v_exp_f32 v242, v242
    v_exp_f32 v243, v243
    v_pk_mul_f32 v[218:219], v[252:253], v[218:219]
    v_exp_f32 v244, v244
    v_exp_f32 v245, v245
    v_pk_mul_f32 v[220:221], v[252:253], v[220:221]
    v_exp_f32 v246, v246
    v_exp_f32 v247, v247
    v_pk_mul_f32 v[222:223], v[252:253], v[222:223]
    v_pk_add_f32 v[240:241], v[240:241], 1.0 op_sel_hi:[1,0]
    v_pk_add_f32 v[242:243], v[242:243], 1.0 op_sel_hi:[1,0]
    v_pk_add_f32 v[244:245], v[244:245], 1.0 op_sel_hi:[1,0]
    v_pk_add_f32 v[246:247], v[246:247], 1.0 op_sel_hi:[1,0]
    v_rcp_f32 v240, v240
    v_rcp_f32 v241, v241
    v_rcp_f32 v242, v242
    v_rcp_f32 v243, v243
    v_rcp_f32 v244, v244
    v_rcp_f32 v245, v245
    v_rcp_f32 v246, v246
    v_rcp_f32 v247, v247
    v_pk_mul_f32 v[216:217], v[216:217], v[240:241]
    v_pk_mul_f32 v[218:219], v[218:219], v[242:243]
    v_pk_mul_f32 v[220:221], v[220:221], v[244:245]
    v_pk_mul_f32 v[222:223], v[222:223], v[246:247]
    v_cvt_pk_bf16_f32 v216, v216, v217
    v_cvt_pk_bf16_f32 v217, v218, v219
    v_cvt_pk_bf16_f32 v218, v220, v221
    v_cvt_pk_bf16_f32 v219, v222, v223
    buffer_store_dwordx4 v[216:219], v1, s[4:7], s96 offen offset:3072 sc1
    s_waitcnt vmcnt(1)
    s_mov_b64 exec, 1
    buffer_store_dword v11, v9, s[4:7], s38 offen offset:1536
    s_mov_b64 exec, -1
    v_pk_mul_f32 v[240:241], v[254:255], v[224:225]
    v_pk_mul_f32 v[242:243], v[254:255], v[226:227]
    v_pk_mul_f32 v[244:245], v[254:255], v[228:229]
    v_pk_mul_f32 v[246:247], v[254:255], v[230:231]
    v_exp_f32 v240, v240
    v_exp_f32 v241, v241
    v_pk_mul_f32 v[224:225], v[252:253], v[224:225]
    v_exp_f32 v242, v242
    v_exp_f32 v243, v243
    v_pk_mul_f32 v[226:227], v[252:253], v[226:227]
    v_exp_f32 v244, v244
    v_exp_f32 v245, v245
    v_pk_mul_f32 v[228:229], v[252:253], v[228:229]
    v_exp_f32 v246, v246
    v_exp_f32 v247, v247
    v_pk_mul_f32 v[230:231], v[252:253], v[230:231]
    v_pk_add_f32 v[240:241], v[240:241], 1.0 op_sel_hi:[1,0]
    v_pk_add_f32 v[242:243], v[242:243], 1.0 op_sel_hi:[1,0]
    v_pk_add_f32 v[244:245], v[244:245], 1.0 op_sel_hi:[1,0]
    v_pk_add_f32 v[246:247], v[246:247], 1.0 op_sel_hi:[1,0]
    v_rcp_f32 v240, v240
    v_rcp_f32 v241, v241
    v_rcp_f32 v242, v242
    v_rcp_f32 v243, v243
    v_rcp_f32 v244, v244
    v_rcp_f32 v245, v245
    v_rcp_f32 v246, v246
    v_rcp_f32 v247, v247
    v_pk_mul_f32 v[224:225], v[224:225], v[240:241]
    v_pk_mul_f32 v[226:227], v[226:227], v[242:243]
    v_pk_mul_f32 v[228:229], v[228:229], v[244:245]
    v_pk_mul_f32 v[230:231], v[230:231], v[246:247]
    v_cvt_pk_bf16_f32 v224, v224, v225
    v_cvt_pk_bf16_f32 v225, v226, v227
    v_cvt_pk_bf16_f32 v226, v228, v229
    v_cvt_pk_bf16_f32 v227, v230, v231
    buffer_store_dwordx4 v[224:227], v1, s[4:7], s97 offen offset:0 sc1
    v_pk_mul_f32 v[240:241], v[254:255], v[232:233]
    v_pk_mul_f32 v[242:243], v[254:255], v[234:235]
    v_pk_mul_f32 v[244:245], v[254:255], v[236:237]
    v_pk_mul_f32 v[246:247], v[254:255], v[238:239]
    v_exp_f32 v240, v240
    v_exp_f32 v241, v241
    v_pk_mul_f32 v[232:233], v[252:253], v[232:233]
    v_exp_f32 v242, v242
    v_exp_f32 v243, v243
    v_pk_mul_f32 v[234:235], v[252:253], v[234:235]
    v_exp_f32 v244, v244
    v_exp_f32 v245, v245
    v_pk_mul_f32 v[236:237], v[252:253], v[236:237]
    v_exp_f32 v246, v246
    v_exp_f32 v247, v247
    v_pk_mul_f32 v[238:239], v[252:253], v[238:239]
    v_pk_add_f32 v[240:241], v[240:241], 1.0 op_sel_hi:[1,0]
    v_pk_add_f32 v[242:243], v[242:243], 1.0 op_sel_hi:[1,0]
    v_pk_add_f32 v[244:245], v[244:245], 1.0 op_sel_hi:[1,0]
    v_pk_add_f32 v[246:247], v[246:247], 1.0 op_sel_hi:[1,0]
    v_rcp_f32 v240, v240
    v_rcp_f32 v241, v241
    v_rcp_f32 v242, v242
    v_rcp_f32 v243, v243
    v_rcp_f32 v244, v244
    v_rcp_f32 v245, v245
    v_rcp_f32 v246, v246
    v_rcp_f32 v247, v247
    v_pk_mul_f32 v[232:233], v[232:233], v[240:241]
    v_pk_mul_f32 v[234:235], v[234:235], v[242:243]
    v_pk_mul_f32 v[236:237], v[236:237], v[244:245]
    v_pk_mul_f32 v[238:239], v[238:239], v[246:247]
    v_cvt_pk_bf16_f32 v232, v232, v233
    v_cvt_pk_bf16_f32 v233, v234, v235
    v_cvt_pk_bf16_f32 v234, v236, v237
    v_cvt_pk_bf16_f32 v235, v238, v239
    buffer_store_dwordx4 v[232:235], v1, s[4:7], s97 offen offset:1024 sc1
    buffer_load_dword v45, v10, s[4:7], s27 offen offset:1536 sc1
    v_pk_mul_f32 v[240:241], v[254:255], v[176:177]
    v_pk_mul_f32 v[242:243], v[254:255], v[178:179]
    v_pk_mul_f32 v[244:245], v[254:255], v[180:181]
    v_pk_mul_f32 v[246:247], v[254:255], v[182:183]
    v_exp_f32 v240, v240
    v_exp_f32 v241, v241
    v_pk_mul_f32 v[176:177], v[252:253], v[176:177]
    v_exp_f32 v242, v242
    v_exp_f32 v243, v243
    v_pk_mul_f32 v[178:179], v[252:253], v[178:179]
    v_exp_f32 v244, v244
    v_exp_f32 v245, v245
    v_pk_mul_f32 v[180:181], v[252:253], v[180:181]
    v_exp_f32 v246, v246
    v_exp_f32 v247, v247
    v_pk_mul_f32 v[182:183], v[252:253], v[182:183]
    v_pk_add_f32 v[240:241], v[240:241], 1.0 op_sel_hi:[1,0]
    v_pk_add_f32 v[242:243], v[242:243], 1.0 op_sel_hi:[1,0]
    v_pk_add_f32 v[244:245], v[244:245], 1.0 op_sel_hi:[1,0]
    v_pk_add_f32 v[246:247], v[246:247], 1.0 op_sel_hi:[1,0]
    v_rcp_f32 v240, v240
    v_rcp_f32 v241, v241
    v_rcp_f32 v242, v242
    v_rcp_f32 v243, v243
    v_rcp_f32 v244, v244
    v_rcp_f32 v245, v245
    v_rcp_f32 v246, v246
    v_rcp_f32 v247, v247
    v_pk_mul_f32 v[176:177], v[176:177], v[240:241]
    v_pk_mul_f32 v[178:179], v[178:179], v[242:243]
    v_pk_mul_f32 v[180:181], v[180:181], v[244:245]
    v_pk_mul_f32 v[182:183], v[182:183], v[246:247]
    v_cvt_pk_bf16_f32 v176, v176, v177
    v_cvt_pk_bf16_f32 v177, v178, v179
    v_cvt_pk_bf16_f32 v178, v180, v181
    v_cvt_pk_bf16_f32 v179, v182, v183
    buffer_store_dwordx4 v[176:179], v1, s[4:7], s97 offen offset:2048 sc1
    s_waitcnt vmcnt(1)
    v_cmp_ne_u32 vcc, v11, v45
    s_nop 0
    s_and_b64 vcc, vcc, s[36:37]
    s_cbranch_scc0 S_35
    s_mov_b64 exec, s[36:37]
    buffer_load_dword v45, v10, s[4:7], s27 offen offset:1536 sc1
    s_waitcnt vmcnt(0)
    v_cmp_ne_u32 vcc, v11, v45
    s_mov_b64 exec, 1
    buffer_store_dword v11, v9, s[4:7], s38 offen offset:1792
    s_mov_b64 exec, -1
    s_cbranch_vccz S_36
    s_mov_b64 exec, s[36:37]
S_37:
    buffer_load_dword v45, v10, s[4:7], s27 offen offset:1536 sc1
    s_waitcnt vmcnt(0)
    v_cmp_ne_u32 vcc, v11, v45
    s_nop 0
    s_cbranch_vccz S_36
    s_add_u32 s39, s39, 1
    s_cmp_lt_u32 s39, 200000
    s_cbranch_scc1 S_37
S_36:
    s_mov_b64 exec, -1
S_35:
    buffer_load_dwordx4 v[48:51], v15, s[4:7], s56 offen offset:0 sc1
    buffer_load_dwordx4 v[52:55], v15, s[4:7], s56 offen offset:1024 sc1
    buffer_load_dwordx4 v[56:59], v15, s[4:7], s56 offen offset:2048 sc1
    buffer_load_dwordx4 v[60:63], v15, s[4:7], s57 offen offset:0 sc1
    buffer_load_dwordx4 v[64:67], v15, s[4:7], s57 offen offset:1024 sc1
    buffer_load_dwordx4 v[68:71], v15, s[4:7], s57 offen offset:2048 sc1
    buffer_load_dwordx4 v[72:75], v15, s[4:7], s58 offen offset:0 sc1
    buffer_load_dwordx4 v[76:79], v15, s[4:7], s58 offen offset:1024 sc1
    s_waitcnt vmcnt(8)
    s_mov_b64 exec, 1
    buffer_store_dword v11, v9, s[4:7], s38 offen offset:1792
    s_mov_b64 exec, -1
    buffer_load_dwordx4 v[80:83], v15, s[4:7], s58 offen offset:2048 sc1
    buffer_load_dwordx4 v[84:87], v15, s[4:7], s59 offen offset:0 sc1
    buffer_load_dwordx4 v[88:91], v15, s[4:7], s59 offen offset:1024 sc1
    buffer_load_dwordx4 v[92:95], v15, s[4:7], s59 offen offset:2048 sc1
    buffer_load_dwordx4 v[96:99], v2, s[4:7], s56 offen offset:0 sc1
    buffer_load_dwordx4 v[100:103], v2, s[4:7], s56 offen offset:1024 sc1
    buffer_load_dwordx4 v[104:107], v2, s[4:7], s56 offen offset:2048 sc1
    buffer_load_dwordx4 v[108:111], v2, s[4:7], s57 offen offset:0 sc1
    s_add_u32 s0, s0, 32768
    s_add_u32 s34, s34, 32768
    s_waitcnt vmcnt(16)
    v_mfma_f32_32x32x16_bf16 v[112:127], a[0:3], v[48:51], 0
    v_mfma_f32_32x32x16_bf16 v[128:143], a[4:7], v[48:51], 0
    buffer_load_dwordx4 v[48:51], v2, s[4:7], s57 offen offset:1024 sc1
    s_waitcnt vmcnt(16)
    v_mfma_f32_32x32x16_bf16 v[112:127], a[8:11], v[52:55], v[112:127]
    v_mfma_f32_32x32x16_bf16 v[128:143], a[12:15], v[52:55], v[128:143]
    buffer_load_dwordx4 v[52:55], v2, s[4:7], s57 offen offset:2048 sc1
    s_waitcnt vmcnt(16)
    v_mfma_f32_32x32x16_bf16 v[112:127], a[16:19], v[56:59], v[112:127]
    v_mfma_f32_32x32x16_bf16 v[128:143], a[20:23], v[56:59], v[128:143]
    buffer_load_dwordx4 v[56:59], v2, s[4:7], s58 offen offset:0 sc1
    buffer_load_dword v45, v10, s[4:7], s27 offen offset:1792 sc1
    s_waitcnt vmcnt(17)
    v_mfma_f32_32x32x16_bf16 v[112:127], a[56:59], v[60:63], v[112:127]
    v_mfma_f32_32x32x16_bf16 v[128:143], a[60:63], v[60:63], v[128:143]
    buffer_load_dwordx4 v[60:63], v2, s[4:7], s58 offen offset:1024 sc1
    s_waitcnt vmcnt(17)
    v_mfma_f32_32x32x16_bf16 v[112:127], a[64:67], v[64:67], v[112:127]
    v_mfma_f32_32x32x16_bf16 v[128:143], a[68:71], v[64:67], v[128:143]
    buffer_load_dwordx4 v[64:67], v2, s[4:7], s58 offen offset:2048 sc1
    s_waitcnt vmcnt(17)
    v_mfma_f32_32x32x16_bf16 v[112:127], a[72:75], v[68:71], v[112:127]
    v_mfma_f32_32x32x16_bf16 v[128:143], a[76:79], v[68:71], v[128:143]
    buffer_load_dwordx4 v[68:71], v2, s[4:7], s59 offen offset:0 sc1
    s_waitcnt vmcnt(17)
    v_mfma_f32_32x32x16_bf16 v[112:127], a[112:115], v[72:75], v[112:127]
    v_mfma_f32_32x32x16_bf16 v[128:143], a[116:119], v[72:75], v[128:143]
    buffer_load_dwordx4 v[72:75], v2, s[4:7], s59 offen offset:1024 sc1
    s_waitcnt vmcnt(17)
    v_mfma_f32_32x32x16_bf16 v[112:127], a[120:123], v[76:79], v[112:127]
    v_mfma_f32_32x32x16_bf16 v[128:143], a[124:127], v[76:79], v[128:143]
    buffer_load_dwordx4 v[76:79], v2, s[4:7], s59 offen offset:2048 sc1
    s_waitcnt vmcnt(5)
    v_cmp_ne_u32 vcc, v11, v45
    s_nop 0
    s_and_b64 vcc, vcc, s[36:37]
    s_cbranch_scc0 S_38
    s_mov_b64 exec, s[36:37]
S_40:
    buffer_load_dword v45, v10, s[4:7], s27 offen offset:1792 sc1
    s_waitcnt vmcnt(0)
    v_cmp_ne_u32 vcc, v11, v45
    s_nop 0
    s_cbranch_vccz S_39
    s_add_u32 s39, s39, 1
    s_cmp_lt_u32 s39, 200000
    s_cbranch_scc1 S_40
S_39:
    s_mov_b64 exec, -1
S_38:
    v_mfma_f32_32x32x16_bf16 v[112:127], a[128:131], v[80:83], v[112:127]
    v_mfma_f32_32x32x16_bf16 v[128:143], a[132:135], v[80:83], v[128:143]
    buffer_load_dwordx4 v[80:83], v15, s[4:7], s56 offen offset:3072 sc1
    v_mfma_f32_32x32x16_bf16 v[112:127], a[168:171], v[84:87], v[112:127]
    v_mfma_f32_32x32x16_bf16 v[128:143], a[172:175], v[84:87], v[128:143]
    buffer_load_dwordx4 v[84:87], v47, s[4:7], s56 offen offset:0 sc1
    v_mfma_f32_32x32x16_bf16 v[112:127], a[176:179], v[88:91], v[112:127]
    v_mfma_f32_32x32x16_bf16 v[128:143], a[180:183], v[88:91], v[128:143]
    buffer_load_dwordx4 v[88:91], v47, s[4:7], s56 offen offset:1024 sc1
    v_mfma_f32_32x32x16_bf16 v[112:127], a[184:187], v[92:95], v[112:127]
    v_mfma_f32_32x32x16_bf16 v[128:143], a[188:191], v[92:95], v[128:143]
    buffer_load_dwordx4 v[92:95], v47, s[4:7], s56 offen offset:2048 sc1
    v_mfma_f32_32x32x16_bf16 v[144:159], a[0:3], v[96:99], 0
    v_mfma_f32_32x32x16_bf16 v[160:175], a[4:7], v[96:99], 0
    buffer_load_dwordx4 v[96:99], v15, s[4:7], s57 offen offset:3072 sc1
    v_mfma_f32_32x32x16_bf16 v[144:159], a[8:11], v[100:103], v[144:159]
    v_mfma_f32_32x32x16_bf16 v[160:175], a[12:15], v[100:103], v[160:175]
    buffer_load_dwordx4 v[100:103], v47, s[4:7], s57 offen offset:0 sc1
    v_mfma_f32_32x32x16_bf16 v[144:159], a[16:19], v[104:107], v[144:159]
    v_mfma_f32_32x32x16_bf16 v[160:175], a[20:23], v[104:107], v[160:175]
    buffer_load_dwordx4 v[104:107], v47, s[4:7], s57 offen offset:1024 sc1
    v_mfma_f32_32x32x16_bf16 v[144:159], a[56:59], v[108:111], v[144:159]
    v_mfma_f32_32x32x16_bf16 v[160:175], a[60:63], v[108:111], v[160:175]
    buffer_load_dwordx4 v[108:111], v47, s[4:7], s57 offen offset:2048 sc1
    v_mfma_f32_32x32x16_bf16 v[144:159], a[64:67], v[48:51], v[144:159]
    v_mfma_f32_32x32x16_bf16 v[160:175], a[68:71], v[48:51], v[160:175]
    buffer_load_dwordx4 v[48:51], v15, s[4:7], s58 offen offset:3072 sc1
    v_mfma_f32_32x32x16_bf16 v[144:159], a[72:75], v[52:55], v[144:159]
    v_mfma_f32_32x32x16_bf16 v[160:175], a[76:79], v[52:55], v[160:175]
    buffer_load_dwordx4 v[52:55], v47, s[4:7], s58 offen offset:0 sc1
    v_mfma_f32_32x32x16_bf16 v[144:159], a[112:115], v[56:59], v[144:159]
    v_mfma_f32_32x32x16_bf16 v[160:175], a[116:119], v[56:59], v[160:175]
    buffer_load_dwordx4 v[56:59], v47, s[4:7], s58 offen offset:1024 sc1
    s_waitcnt vmcnt(15)
    v_mfma_f32_32x32x16_bf16 v[144:159], a[120:123], v[60:63], v[144:159]
    v_mfma_f32_32x32x16_bf16 v[160:175], a[124:127], v[60:63], v[160:175]
    buffer_load_dwordx4 v[60:63], v47, s[4:7], s58 offen offset:2048 sc1
    s_waitcnt vmcnt(15)
    v_mfma_f32_32x32x16_bf16 v[144:159], a[128:131], v[64:67], v[144:159]
    v_mfma_f32_32x32x16_bf16 v[160:175], a[132:135], v[64:67], v[160:175]
    buffer_load_dwordx4 v[64:67], v15, s[4:7], s59 offen offset:3072 sc1
    s_waitcnt vmcnt(15)
    v_mfma_f32_32x32x16_bf16 v[144:159], a[168:171], v[68:71], v[144:159]
    v_mfma_f32_32x32x16_bf16 v[160:175], a[172:175], v[68:71], v[160:175]
    buffer_load_dwordx4 v[68:71], v47, s[4:7], s59 offen offset:0 sc1
    s_waitcnt vmcnt(15)
    v_mfma_f32_32x32x16_bf16 v[144:159], a[176:179], v[72:75], v[144:159]
    v_mfma_f32_32x32x16_bf16 v[160:175], a[180:183], v[72:75], v[160:175]
    buffer_load_dwordx4 v[72:75], v47, s[4:7], s59 offen offset:1024 sc1
    s_waitcnt vmcnt(15)
    v_mfma_f32_32x32x16_bf16 v[144:159], a[184:187], v[76:79], v[144:159]
    v_mfma_f32_32x32x16_bf16 v[160:175], a[188:191], v[76:79], v[160:175]
    buffer_load_dwordx4 v[76:79], v47, s[4:7], s59 offen offset:2048 sc1
    s_waitcnt vmcnt(15)
    v_mfma_f32_32x32x16_bf16 v[112:127], a[24:27], v[80:83], v[112:127]
    v_mfma_f32_32x32x16_bf16 v[128:143], a[28:31], v[80:83], v[128:143]
    buffer_load_dwordx4 v[80:83], v2, s[4:7], s56 offen offset:3072 sc1
    s_waitcnt vmcnt(15)
    v_mfma_f32_32x32x16_bf16 v[112:127], a[32:35], v[84:87], v[112:127]
    v_mfma_f32_32x32x16_bf16 v[128:143], a[36:39], v[84:87], v[128:143]
    buffer_load_dwordx4 v[84:87], v3, s[4:7], s56 offen offset:0 sc1
    s_waitcnt vmcnt(15)
    v_mfma_f32_32x32x16_bf16 v[112:127], a[40:43], v[88:91], v[112:127]
    v_mfma_f32_32x32x16_bf16 v[128:143], a[44:47], v[88:91], v[128:143]
    buffer_load_dwordx4 v[88:91], v3, s[4:7], s56 offen offset:1024 sc1
    s_waitcnt vmcnt(15)
    v_mfma_f32_32x32x16_bf16 v[112:127], a[48:51], v[92:95], v[112:127]
    v_mfma_f32_32x32x16_bf16 v[128:143], a[52:55], v[92:95], v[128:143]
    buffer_load_dwordx4 v[92:95], v3, s[4:7], s56 offen offset:2048 sc1
    s_waitcnt vmcnt(15)
    v_mfma_f32_32x32x16_bf16 v[112:127], a[80:83], v[96:99], v[112:127]
    v_mfma_f32_32x32x16_bf16 v[128:143], a[84:87], v[96:99], v[128:143]
    buffer_load_dwordx4 v[96:99], v2, s[4:7], s57 offen offset:3072 sc1
    s_waitcnt vmcnt(15)
    v_mfma_f32_32x32x16_bf16 v[112:127], a[88:91], v[100:103], v[112:127]
    v_mfma_f32_32x32x16_bf16 v[128:143], a[92:95], v[100:103], v[128:143]
    buffer_load_dwordx4 v[100:103], v3, s[4:7], s57 offen offset:0 sc1
    s_waitcnt vmcnt(15)
    v_mfma_f32_32x32x16_bf16 v[112:127], a[96:99], v[104:107], v[112:127]
    v_mfma_f32_32x32x16_bf16 v[128:143], a[100:103], v[104:107], v[128:143]
    buffer_load_dwordx4 v[104:107], v3, s[4:7], s57 offen offset:1024 sc1
    s_waitcnt vmcnt(15)
    v_mfma_f32_32x32x16_bf16 v[112:127], a[104:107], v[108:111], v[112:127]
    v_mfma_f32_32x32x16_bf16 v[128:143], a[108:111], v[108:111], v[128:143]
    buffer_load_dwordx4 v[108:111], v3, s[4:7], s57 offen offset:2048 sc1
    s_waitcnt vmcnt(15)
    v_mfma_f32_32x32x16_bf16 v[112:127], a[136:139], v[48:51], v[112:127]
    v_mfma_f32_32x32x16_bf16 v[128:143], a[140:143], v[48:51], v[128:143]
    buffer_load_dwordx4 v[48:51], v2, s[4:7], s58 offen offset:3072 sc1
    s_waitcnt vmcnt(15)
    v_mfma_f32_32x32x16_bf16 v[112:127], a[144:147], v[52:55], v[112:127]
    v_mfma_f32_32x32x16_bf16 v[128:143], a[148:151], v[52:55], v[128:143]
    buffer_load_dwordx4 v[52:55], v3, s[4:7], s58 offen offset:0 sc1
    s_waitcnt vmcnt(15)
    v_mfma_f32_32x32x16_bf16 v[112:127], a[152:155], v[56:59], v[112:127]
    v_mfma_f32_32x32x16_bf16 v[128:143], a[156:159], v[56:59], v[128:143]
    buffer_load_dwordx4 v[56:59], v3, s[4:7], s58 offen offset:1024 sc1
    s_waitcnt vmcnt(15)
    v_mfma_f32_32x32x16_bf16 v[112:127], a[160:163], v[60:63], v[112:127]
    v_mfma_f32_32x32x16_bf16 v[128:143], a[164:167], v[60:63], v[128:143]
    buffer_load_dwordx4 v[60:63], v3, s[4:7], s58 offen offset:2048 sc1
    s_waitcnt vmcnt(15)
    v_mfma_f32_32x32x16_bf16 v[112:127], a[192:195], v[64:67], v[112:127]
    v_mfma_f32_32x32x16_bf16 v[128:143], a[196:199], v[64:67], v[128:143]
    buffer_load_dwordx4 v[64:67], v2, s[4:7], s59 offen offset:3072 sc1
    s_waitcnt vmcnt(15)
    v_mfma_f32_32x32x16_bf16 v[112:127], a[200:203], v[68:71], v[112:127]
    v_mfma_f32_32x32x16_bf16 v[128:143], a[204:207], v[68:71], v[128:143]
    buffer_load_dwordx4 v[68:71], v3, s[4:7], s59 offen offset:0 sc1
    s_waitcnt vmcnt(15)
    v_mfma_f32_32x32x16_bf16 v[112:127], a[208:211], v[72:75], v[112:127]
    v_mfma_f32_32x32x16_bf16 v[128:143], a[212:215], v[72:75], v[128:143]
    buffer_load_dwordx4 v[72:75], v3, s[4:7], s59 offen offset:1024 sc1
    s_waitcnt vmcnt(15)
    v_mfma_f32_32x32x16_bf16 v[112:127], a[216:219], v[76:79], v[112:127]
    v_mfma_f32_32x32x16_bf16 v[128:143], a[220:223], v[76:79], v[128:143]
    buffer_load_dwordx4 v[76:79], v3, s[4:7], s59 offen offset:2048 sc1
    s_waitcnt vmcnt(15)
    v_mfma_f32_32x32x16_bf16 v[144:159], a[24:27], v[80:83], v[144:159]
    v_mfma_f32_32x32x16_bf16 v[160:175], a[28:31], v[80:83], v[160:175]
    s_waitcnt vmcnt(14)
    v_mfma_f32_32x32x16_bf16 v[144:159], a[32:35], v[84:87], v[144:159]
    s_nop 4
    ds_write_b128 v12, v[112:115] offset:0
    v_mfma_f32_32x32x16_bf16 v[160:175], a[36:39], v[84:87], v[160:175]
    ds_write_b128 v12, v[116:119] offset:32
    s_waitcnt vmcnt(13)
    v_mfma_f32_32x32x16_bf16 v[144:159], a[40:43], v[88:91], v[144:159]
    ds_write_b128 v12, v[120:123] offset:64
    v_mfma_f32_32x32x16_bf16 v[160:175], a[44:47], v[88:91], v[160:175]
    ds_write_b128 v12, v[124:127] offset:96
    s_waitcnt vmcnt(12)
    v_mfma_f32_32x32x16_bf16 v[144:159], a[48:51], v[92:95], v[144:159]
    ds_write_b128 v12, v[128:131] offset:128
    v_mfma_f32_32x32x16_bf16 v[160:175], a[52:55], v[92:95], v[160:175]
    ds_write_b128 v12, v[132:135] offset:160
    s_waitcnt vmcnt(11)
    v_mfma_f32_32x32x16_bf16 v[144:159], a[80:83], v[96:99], v[144:159]
    ds_write_b128 v12, v[136:139] offset:192
    v_mfma_f32_32x32x16_bf16 v[160:175], a[84:87], v[96:99], v[160:175]
    ds_write_b128 v12, v[140:143] offset:224
    s_waitcnt vmcnt(10)
    v_mfma_f32_32x32x16_bf16 v[144:159], a[88:91], v[100:103], v[144:159]
    v_mfma_f32_32x32x16_bf16 v[160:175], a[92:95], v[100:103], v[160:175]
    s_waitcnt lgkmcnt(0)
    s_barrier
    s_waitcnt vmcnt(9)
    v_mfma_f32_32x32x16_bf16 v[144:159], a[96:99], v[104:107], v[144:159]
    ds_read_b128 v[176:179], v13 offset:0
    ds_read_b128 v[180:183], v13 offset:16
    ds_read_b128 v[184:187], v13 offset:8704
    ds_read_b128 v[188:191], v13 offset:8720
    ds_read_b128 v[192:195], v13 offset:17408
    v_mfma_f32_32x32x16_bf16 v[160:175], a[100:103], v[104:107], v[160:175]
    ds_read_b128 v[196:199], v13 offset:17424
    ds_read_b128 v[200:203], v13 offset:26112
    ds_read_b128 v[204:207], v13 offset:26128
    s_nop 0
    s_nop 0
    s_waitcnt vmcnt(8)
    v_mfma_f32_32x32x16_bf16 v[144:159], a[104:107], v[108:111], v[144:159]
    s_waitcnt lgkmcnt(4)
    v_add_f32 v16, v16, v176
    v_add_f32 v17, v17, v177
    v_add_f32 v18, v18, v178
    v_add_f32 v19, v19, v179
    v_mfma_f32_32x32x16_bf16 v[160:175], a[108:111], v[108:111], v[160:175]
    v_add_f32 v20, v20, v180
    v_add_f32 v21, v21, v181
    v_add_f32 v22, v22, v182
    v_add_f32 v23, v23, v183
    v_add_f32 v16, v16, v184
    s_waitcnt vmcnt(7)
    v_mfma_f32_32x32x16_bf16 v[144:159], a[136:139], v[48:51], v[144:159]
    v_add_f32 v17, v17, v185
    v_add_f32 v18, v18, v186
    v_add_f32 v19, v19, v187
    v_add_f32 v20, v20, v188
    v_add_f32 v21, v21, v189
    v_mfma_f32_32x32x16_bf16 v[160:175], a[140:143], v[48:51], v[160:175]
    v_add_f32 v22, v22, v190
    v_add_f32 v23, v23, v191
    s_waitcnt lgkmcnt(0)
    v_add_f32 v16, v16, v192
    v_add_f32 v17, v17, v193
    s_waitcnt vmcnt(6)
    v_mfma_f32_32x32x16_bf16 v[144:159], a[144:147], v[52:55], v[144:159]
    v_add_f32 v18, v18, v194
    v_add_f32 v19, v19, v195
    v_add_f32 v20, v20, v196
    v_add_f32 v21, v21, v197
    v_add_f32 v22, v22, v198
    v_mfma_f32_32x32x16_bf16 v[160:175], a[148:151], v[52:55], v[160:175]
    v_add_f32 v23, v23, v199
    v_add_f32 v16, v16, v200
    v_add_f32 v17, v17, v201
    v_add_f32 v18, v18, v202
    v_add_f32 v19, v19, v203
    s_waitcnt vmcnt(5)
    v_mfma_f32_32x32x16_bf16 v[144:159], a[152:155], v[56:59], v[144:159]
    v_add_f32 v20, v20, v204
    v_add_f32 v21, v21, v205
    v_add_f32 v22, v22, v206
    v_add_f32 v23, v23, v207
    v_cvt_pk_bf16_f32 v212, v16, v17
    v_mfma_f32_32x32x16_bf16 v[160:175], a[156:159], v[56:59], v[160:175]
    v_cvt_pk_bf16_f32 v213, v18, v19
    v_cvt_pk_bf16_f32 v214, v20, v21
    v_cvt_pk_bf16_f32 v215, v22, v23
    buffer_store_dwordx4 v[212:215], v4, s[16:19], 0 offen
    s_waitcnt vmcnt(5)
    v_mfma_f32_32x32x16_bf16 v[144:159], a[160:163], v[60:63], v[144:159]
    v_mfma_f32_32x32x16_bf16 v[160:175], a[164:167], v[60:63], v[160:175]
    s_waitcnt vmcnt(4)
    v_mfma_f32_32x32x16_bf16 v[144:159], a[192:195], v[64:67], v[144:159]
    v_mfma_f32_32x32x16_bf16 v[160:175], a[196:199], v[64:67], v[160:175]
    s_waitcnt vmcnt(3)
    v_mfma_f32_32x32x16_bf16 v[144:159], a[200:203], v[68:71], v[144:159]
    v_mfma_f32_32x32x16_bf16 v[160:175], a[204:207], v[68:71], v[160:175]
    s_waitcnt vmcnt(2)
    v_mfma_f32_32x32x16_bf16 v[144:159], a[208:211], v[72:75], v[144:159]
    v_mfma_f32_32x32x16_bf16 v[160:175], a[212:215], v[72:75], v[160:175]
    s_waitcnt vmcnt(1)
    v_mfma_f32_32x32x16_bf16 v[144:159], a[216:219], v[76:79], v[144:159]
    v_mfma_f32_32x32x16_bf16 v[160:175], a[220:223], v[76:79], v[160:175]
    s_barrier
    s_nop 9
    ds_write_b128 v12, v[144:147] offset:0
    ds_write_b128 v12, v[148:151] offset:32
    ds_write_b128 v12, v[152:155] offset:64
    ds_write_b128 v12, v[156:159] offset:96
    ds_write_b128 v12, v[160:163] offset:128
    ds_write_b128 v12, v[164:167] offset:160
    ds_write_b128 v12, v[168:171] offset:192
    ds_write_b128 v12, v[172:175] offset:224
    s_waitcnt lgkmcnt(0)
    s_barrier
    ds_read_b128 v[176:179], v13 offset:0
    ds_read_b128 v[180:183], v13 offset:16
    ds_read_b128 v[184:187], v13 offset:8704
    ds_read_b128 v[188:191], v13 offset:8720
    ds_read_b128 v[192:195], v13 offset:17408
    ds_read_b128 v[196:199], v13 offset:17424
    ds_read_b128 v[200:203], v13 offset:26112
    ds_read_b128 v[204:207], v13 offset:26128
    s_waitcnt lgkmcnt(4)
    v_pk_add_f32 v[24:25], v[24:25], v[176:177]
    v_pk_add_f32 v[26:27], v[26:27], v[178:179]
    v_pk_add_f32 v[28:29], v[28:29], v[180:181]
    v_pk_add_f32 v[30:31], v[30:31], v[182:183]
    v_pk_add_f32 v[24:25], v[24:25], v[184:185]
    v_pk_add_f32 v[26:27], v[26:27], v[186:187]
    v_pk_add_f32 v[28:29], v[28:29], v[188:189]
    v_pk_add_f32 v[30:31], v[30:31], v[190:191]
    s_waitcnt lgkmcnt(0)
    v_pk_add_f32 v[24:25], v[24:25], v[192:193]
    v_pk_add_f32 v[26:27], v[26:27], v[194:195]
    v_pk_add_f32 v[28:29], v[28:29], v[196:197]
    v_pk_add_f32 v[30:31], v[30:31], v[198:199]
    v_pk_add_f32 v[24:25], v[24:25], v[200:201]
    v_pk_add_f32 v[26:27], v[26:27], v[202:203]
    v_pk_add_f32 v[28:29], v[28:29], v[204:205]
    v_pk_add_f32 v[30:31], v[30:31], v[206:207]
    v_cvt_pk_bf16_f32 v212, v24, v25
    v_cvt_pk_bf16_f32 v213, v26, v27
    v_cvt_pk_bf16_f32 v214, v28, v29
    v_cvt_pk_bf16_f32 v215, v30, v31
    buffer_store_dwordx4 v[212:215], v4, s[16:19], s63 offen
    s_branch M_done
M_slow:
M_layer_slow:
    s_mov_b64 exec, 0xffffffff
S_42:
    buffer_load_dword v45, v10, s[4:7], s34 offen offset:0 sc1
    s_waitcnt vmcnt(0)
    v_cmp_ne_u32 vcc, v11, v45
    s_nop 0
    s_cbranch_vccz S_41
    s_add_u32 s39, s39, 1
    s_cmp_lt_u32 s39, 200000
    s_cbranch_scc1 S_42
S_41:
    s_mov_b64 exec, -1
    buffer_load_dwordx4 v[48:51], v15, s[4:7], s40 offen offset:0 sc1
    buffer_load_dwordx4 v[52:55], v15, s[4:7], s40 offen offset:1024 sc1
    buffer_load_dwordx4 v[56:59], v15, s[4:7], s40 offen offset:2048 sc1
    buffer_load_dwordx4 v[60:63], v15, s[4:7], s40 offen offset:3072 sc1
    buffer_load_dwordx2 v[240:241], v8, s[4:7], 0 offen offset:0 sc1
    buffer_load_dwordx2 v[242:243], v8, s[4:7], 0 offen offset:256 sc1
    buffer_load_dwordx2 v[244:245], v8, s[4:7], 0 offen offset:512 sc1
    buffer_load_dwordx2 v[246:247], v8, s[4:7], 0 offen offset:768 sc1
    buffer_load_dwordx4 v[64:67], v15, s[4:7], s41 offen offset:0 sc1
    buffer_load_dwordx4 v[68:71], v15, s[4:7], s41 offen offset:1024 sc1
    buffer_load_dwordx4 v[72:75], v15, s[4:7], s41 offen offset:2048 sc1
    buffer_load_dwordx4 v[76:79], v15, s[4:7], s41 offen offset:3072 sc1
    buffer_load_dwordx4 v[80:83], v15, s[4:7], s42 offen offset:0 sc1
    buffer_load_dwordx4 v[84:87], v15, s[4:7], s42 offen offset:1024 sc1
    v_lshrrev_b32 v200, 1, v0
    v_mul_u32_u24 v201, 4160, v200
    v_and_b32 v202, 1, v0
    v_mul_u32_u24 v202, 1056, v202
    v_add_u32 v201, v201, v202
    v_add_u32 v201, 101376, v201
    s_lshl_b32 s30, s21, 2
    v_add_u32 v200, s30, v200
    v_mov_b32 v202, 0x3f803f80
    v_cmp_le_u32 vcc, 8, v200
    s_nop 1
    v_cndmask_b32 v204, 0, v202, vcc
    v_mov_b32 v205, v204
    v_mov_b32 v206, v204
    v_mov_b32 v207, v204
    s_lshl_b32 s30, s22, 18
    s_lshl_b32 s31, s28, 12
    s_add_u32 s30, s30, s31
    s_add_u32 s96, s30, s26
    s_lshl_b32 s31, s22, 7
    s_add_u32 s30, s27, s31
    s_add_u32 s35, s30, 98304
    s_barrier
    s_mov_b64 exec, 0xffffff
    ds_write_b128 v201, v[204:207]
    s_mov_b64 exec, -1
    v_mad_u32_u24 v46, s40, 3, v1
    ds_read_b128 v[160:163], v46 offset:4096
    ds_read_b128 v[164:167], v46 offset:8192
    ds_read_b128 v[168:171], v46 offset:5120
    ds_read_b128 v[172:175], v46 offset:9216
    ds_read_b128 v[176:179], v46 offset:6144
    ds_read_b128 v[180:183], v46 offset:10240
    s_waitcnt vmcnt(13) lgkmcnt(4)
    v_mfma_f32_32x32x16_bf16 v[208:223], v[160:163], v[48:51], 0
    ds_read_b128 v[184:187], v46 offset:7168
    buffer_load_dwordx4 v[88:91], v15, s[4:7], s42 offen offset:2048 sc1
    v_mfma_f32_32x32x16_bf16 v[224:239], v[48:51], v[164:167], 0
    ds_read_b128 v[188:191], v46 offset:11264
    s_waitcnt vmcnt(13) lgkmcnt(4)
    v_mfma_f32_32x32x16_bf16 v[208:223], v[168:171], v[52:55], v[208:223]
    v_mad_u32_u24 v47, s41, 3, v1
    ds_read_b128 v[160:163], v47 offset:4096
    buffer_load_dwordx4 v[92:95], v15, s[4:7], s42 offen offset:3072 sc1
    v_mfma_f32_32x32x16_bf16 v[224:239], v[52:55], v[172:175], v[224:239]
    ds_read_b128 v[164:167], v47 offset:8192
    s_waitcnt vmcnt(13) lgkmcnt(4)
    v_mfma_f32_32x32x16_bf16 v[208:223], v[176:179], v[56:59], v[208:223]
    ds_read_b128 v[168:171], v47 offset:5120
    buffer_load_dwordx4 v[96:99], v15, s[4:7], s43 offen offset:0 sc1
    v_mfma_f32_32x32x16_bf16 v[224:239], v[56:59], v[180:183], v[224:239]
    ds_read_b128 v[172:175], v47 offset:9216
    s_waitcnt vmcnt(13) lgkmcnt(4)
    v_mfma_f32_32x32x16_bf16 v[208:223], v[184:187], v[60:63], v[208:223]
    ds_read_b128 v[176:179], v47 offset:6144
    buffer_load_dwordx4 v[100:103], v15, s[4:7], s43 offen offset:1024 sc1
    v_mfma_f32_32x32x16_bf16 v[224:239], v[60:63], v[188:191], v[224:239]
    ds_read_b128 v[180:183], v47 offset:10240
    s_waitcnt vmcnt(9) lgkmcnt(4)
    v_mfma_f32_32x32x16_bf16 v[208:223], v[160:163], v[64:67], v[208:223]
    ds_read_b128 v[184:187], v47 offset:7168
    buffer_load_dwordx4 v[104:107], v15, s[4:7], s43 offen offset:2048 sc1
    v_mfma_f32_32x32x16_bf16 v[224:239], v[64:67], v[164:167], v[224:239]
    ds_read_b128 v[188:191], v47 offset:11264
    v_add_f32 v240, v240, v242
    s_waitcnt vmcnt(9) lgkmcnt(4)
    v_mfma_f32_32x32x16_bf16 v[208:223], v[168:171], v[68:71], v[208:223]
    v_mad_u32_u24 v46, s42, 3, v1
    ds_read_b128 v[160:163], v46 offset:4096
    buffer_load_dwordx4 v[108:111], v15, s[4:7], s43 offen offset:3072 sc1
    v_mfma_f32_32x32x16_bf16 v[224:239], v[68:71], v[172:175], v[224:239]
    ds_read_b128 v[164:167], v46 offset:8192
    v_add_f32 v244, v244, v246
    v_add_f32 v241, v241, v243
    s_waitcnt vmcnt(9) lgkmcnt(4)
    v_mfma_f32_32x32x16_bf16 v[208:223], v[176:179], v[72:75], v[208:223]
    ds_read_b128 v[168:171], v46 offset:5120
    buffer_load_dwordx4 v[112:115], v15, s[4:7], s44 offen offset:0 sc1
    v_mfma_f32_32x32x16_bf16 v[224:239], v[72:75], v[180:183], v[224:239]
    ds_read_b128 v[172:175], v46 offset:9216
    v_add_f32 v245, v245, v247
    v_add_f32 v240, v240, v244
    s_waitcnt vmcnt(9) lgkmcnt(4)
    v_mfma_f32_32x32x16_bf16 v[208:223], v[184:187], v[76:79], v[208:223]
    ds_read_b128 v[176:179], v46 offset:6144
    buffer_load_dwordx4 v[116:119], v15, s[4:7], s44 offen offset:1024 sc1
    v_mfma_f32_32x32x16_bf16 v[224:239], v[76:79], v[188:191], v[224:239]
    ds_read_b128 v[180:183], v46 offset:10240
    v_add_f32 v241, v241, v245
    v_mov_b32 v242, v240
    s_waitcnt vmcnt(9) lgkmcnt(4)
    v_mfma_f32_32x32x16_bf16 v[208:223], v[160:163], v[80:83], v[208:223]
    ds_read_b128 v[184:187], v46 offset:7168
    buffer_load_dwordx4 v[120:123], v15, s[4:7], s44 offen offset:2048 sc1
    v_mfma_f32_32x32x16_bf16 v[224:239], v[80:83], v[164:167], v[224:239]
    ds_read_b128 v[188:191], v46 offset:11264
    v_mov_b32 v243, v241
    v_mov_b32 v250, 0
    s_waitcnt vmcnt(9) lgkmcnt(4)
    v_mfma_f32_32x32x16_bf16 v[208:223], v[168:171], v[84:87], v[208:223]
    v_mad_u32_u24 v47, s43, 3, v1
    ds_read_b128 v[160:163], v47 offset:4096
    buffer_load_dwordx4 v[124:127], v15, s[4:7], s44 offen offset:3072 sc1
    v_mfma_f32_32x32x16_bf16 v[224:239], v[84:87], v[172:175], v[224:239]
    ds_read_b128 v[164:167], v47 offset:8192
    v_permlane32_swap_b32 v240, v242
    v_permlane32_swap_b32 v241, v243
    s_waitcnt vmcnt(9) lgkmcnt(4)
    v_mfma_f32_32x32x16_bf16 v[208:223], v[176:179], v[88:91], v[208:223]
    ds_read_b128 v[168:171], v47 offset:5120
    buffer_load_dwordx4 v[128:131], v15, s[4:7], s45 offen offset:0 sc1
    v_mfma_f32_32x32x16_bf16 v[224:239], v[88:91], v[180:183], v[224:239]
    ds_read_b128 v[172:175], v47 offset:9216
    v_add_f32 v240, v240, v242
    v_add_f32 v241, v241, v243
    s_waitcnt vmcnt(9) lgkmcnt(4)
    v_mfma_f32_32x32x16_bf16 v[208:223], v[184:187], v[92:95], v[208:223]
    ds_read_b128 v[176:179], v47 offset:6144
    buffer_load_dwordx4 v[132:135], v15, s[4:7], s45 offen offset:1024 sc1
    v_mfma_f32_32x32x16_bf16 v[224:239], v[92:95], v[188:191], v[224:239]
    ds_read_b128 v[180:183], v47 offset:10240
    v_mul_f32 v240, 0xbb000000, v240
    v_mul_f32 v241, 0x3b000000, v241
    s_waitcnt vmcnt(9) lgkmcnt(4)
    v_mfma_f32_32x32x16_bf16 v[208:223], v[160:163], v[96:99], v[208:223]
    ds_read_b128 v[184:187], v47 offset:7168
    buffer_load_dwordx4 v[136:139], v15, s[4:7], s45 offen offset:2048 sc1
    v_mfma_f32_32x32x16_bf16 v[224:239], v[96:99], v[164:167], v[224:239]
    ds_read_b128 v[188:191], v47 offset:11264
    v_fma_f32 v241, -v240, v240, v241
    v_max_f32 v241, 0, v241
    s_waitcnt vmcnt(9) lgkmcnt(4)
    v_mfma_f32_32x32x16_bf16 v[208:223], v[168:171], v[100:103], v[208:223]
    v_mad_u32_u24 v46, s44, 3, v1
    ds_read_b128 v[160:163], v46 offset:4096
    buffer_load_dwordx4 v[140:143], v15, s[4:7], s45 offen offset:3072 sc1
    v_mfma_f32_32x32x16_bf16 v[224:239], v[100:103], v[172:175], v[224:239]
    ds_read_b128 v[164:167], v46 offset:8192
    v_add_f32 v241, 0x3727c5ac, v241
    v_rsq_f32 v252, v241
    s_waitcnt vmcnt(9) lgkmcnt(4)
    v_mfma_f32_32x32x16_bf16 v[208:223], v[176:179], v[104:107], v[208:223]
    ds_read_b128 v[168:171], v46 offset:5120
    buffer_load_dwordx4 v[144:147], v15, s[4:7], s46 offen offset:0 sc1
    v_mfma_f32_32x32x16_bf16 v[224:239], v[104:107], v[180:183], v[224:239]
    ds_read_b128 v[172:175], v46 offset:9216
    v_cvt_pk_bf16_f32 v242, v240, v240
    v_and_b32 v243, 0xffff0000, v242
    s_waitcnt vmcnt(9) lgkmcnt(4)
    v_mfma_f32_32x32x16_bf16 v[208:223], v[184:187], v[108:111], v[208:223]
    ds_read_b128 v[176:179], v46 offset:6144
    buffer_load_dwordx4 v[148:151], v15, s[4:7], s46 offen offset:1024 sc1
    v_mfma_f32_32x32x16_bf16 v[224:239], v[108:111], v[188:191], v[224:239]
    ds_read_b128 v[180:183], v46 offset:10240
    v_sub_f32 v243, v240, v243
    v_lshrrev_b32 v249, 5, v0
    s_waitcnt vmcnt(9) lgkmcnt(4)
    v_mfma_f32_32x32x16_bf16 v[208:223], v[160:163], v[112:115], v[208:223]
    ds_read_b128 v[184:187], v46 offset:7168
    buffer_load_dwordx4 v[152:155], v15, s[4:7], s46 offen offset:2048 sc1
    v_mfma_f32_32x32x16_bf16 v[224:239], v[112:115], v[164:167], v[224:239]
    ds_read_b128 v[188:191], v46 offset:11264
    v_add_u32 v249, -1, v249
    v_cvt_pk_bf16_f32 v242, v240, v243
    s_waitcnt vmcnt(9) lgkmcnt(4)
    v_mfma_f32_32x32x16_bf16 v[208:223], v[168:171], v[116:119], v[208:223]
    v_mad_u32_u24 v47, s45, 3, v1
    ds_read_b128 v[160:163], v47 offset:4096
    buffer_load_dwordx4 v[156:159], v15, s[4:7], s46 offen offset:3072 sc1
    v_mfma_f32_32x32x16_bf16 v[224:239], v[116:119], v[172:175], v[224:239]
    ds_read_b128 v[164:167], v47 offset:8192
    v_mov_b32 v251, 0
    v_mov_b32 v253, v252
    s_waitcnt vmcnt(9) lgkmcnt(4)
    v_mfma_f32_32x32x16_bf16 v[208:223], v[176:179], v[120:123], v[208:223]
    ds_read_b128 v[168:171], v47 offset:5120
    buffer_load_dwordx4 a[240:243], v15, s[4:7], s47 offen offset:0 sc1
    v_mfma_f32_32x32x16_bf16 v[224:239], v[120:123], v[180:183], v[224:239]
    ds_read_b128 v[172:175], v47 offset:9216
    v_and_b32 v248, v249, v242
    v_mov_b32 v249, v248
    s_waitcnt vmcnt(9) lgkmcnt(4)
    v_mfma_f32_32x32x16_bf16 v[208:223], v[184:187], v[124:127], v[208:223]
    ds_read_b128 v[176:179], v47 offset:6144
    buffer_load_dwordx4 a[244:247], v15, s[4:7], s47 offen offset:1024 sc1
    v_mfma_f32_32x32x16_bf16 v[224:239], v[124:127], v[188:191], v[224:239]
    ds_read_b128 v[180:183], v47 offset:10240
    v_mul_f32 v254, 0x3eb8aa3b, v252
    v_mov_b32 v255, v254
    s_waitcnt vmcnt(9) lgkmcnt(4)
    v_mfma_f32_32x32x16_bf16 v[208:223], v[160:163], v[128:131], v[208:223]
    ds_read_b128 v[184:187], v47 offset:7168
    buffer_load_dwordx4 a[248:251], v15, s[4:7], s47 offen offset:2048 sc1
    v_mfma_f32_32x32x16_bf16 v[224:239], v[128:131], v[164:167], v[224:239]
    ds_read_b128 v[188:191], v47 offset:11264
    v_and_b32 v240, 124, v10
    s_lshl_b32 s30, s20, 7
    s_add_u32 s30, s30, 159744
    v_add_u32 v240, s30, v240
    ds_write_b32 v240, v252
    s_waitcnt vmcnt(9) lgkmcnt(5)
    v_mfma_f32_32x32x16_bf16 v[208:223], v[168:171], v[132:135], v[208:223]
    v_mad_u32_u24 v46, s46, 3, v1
    ds_read_b128 v[160:163], v46 offset:4096
    buffer_load_dwordx4 a[252:255], v15, s[4:7], s47 offen offset:3072 sc1
    v_mfma_f32_32x32x16_bf16 v[224:239], v[132:135], v[172:175], v[224:239]
    ds_read_b128 v[164:167], v46 offset:8192
    v_mfma_f32_32x32x16_bf16 v[208:223], a[226:229], v[248:251], v[208:223]
    v_mfma_f32_32x32x16_bf16 v[224:239], v[248:251], a[228:231], v[224:239]
    s_waitcnt vmcnt(9) lgkmcnt(5)
    v_mfma_f32_32x32x16_bf16 v[208:223], v[176:179], v[136:139], v[208:223]
    ds_read_b128 v[168:171], v46 offset:5120
    v_mfma_f32_32x32x16_bf16 v[224:239], v[136:139], v[180:183], v[224:239]
    ds_read_b128 v[172:175], v46 offset:9216
    ds_read_b128 v[240:243], v14 offset:0
    ds_read_b128 v[244:247], v14 offset:32
    ds_read_b128 v[192:195], v14 offset:64
    ds_read_b128 v[196:199], v14 offset:96
    s_waitcnt vmcnt(8) lgkmcnt(9)
    v_mfma_f32_32x32x16_bf16 v[208:223], v[184:187], v[140:143], v[208:223]
    ds_read_b128 v[176:179], v46 offset:6144
    v_mfma_f32_32x32x16_bf16 v[224:239], v[140:143], v[188:191], v[224:239]
    ds_read_b128 v[180:183], v46 offset:10240
    s_waitcnt vmcnt(7) lgkmcnt(8)
    v_mfma_f32_32x32x16_bf16 v[208:223], v[160:163], v[144:147], v[208:223]
    ds_read_b128 v[184:187], v46 offset:7168
    v_mfma_f32_32x32x16_bf16 v[224:239], v[144:147], v[164:167], v[224:239]
    ds_read_b128 v[188:191], v46 offset:11264
    s_waitcnt vmcnt(6) lgkmcnt(8)
    v_mfma_f32_32x32x16_bf16 v[208:223], v[168:171], v[148:151], v[208:223]
    v_mad_u32_u24 v47, s47, 3, v1
    ds_read_b128 v[160:163], v47 offset:4096
    v_mfma_f32_32x32x16_bf16 v[224:239], v[148:151], v[172:175], v[224:239]
    ds_read_b128 v[164:167], v47 offset:8192
    s_waitcnt vmcnt(5) lgkmcnt(4)
    v_mfma_f32_32x32x16_bf16 v[208:223], v[176:179], v[152:155], v[208:223]
    ds_read_b128 v[168:171], v47 offset:5120
    v_mfma_f32_32x32x16_bf16 v[224:239], v[152:155], v[180:183], v[224:239]
    ds_read_b128 v[172:175], v47 offset:9216
    s_waitcnt vmcnt(4) lgkmcnt(4)
    v_mfma_f32_32x32x16_bf16 v[208:223], v[184:187], v[156:159], v[208:223]
    ds_read_b128 v[176:179], v47 offset:6144
    v_mfma_f32_32x32x16_bf16 v[224:239], v[156:159], v[188:191], v[224:239]
    ds_read_b128 v[180:183], v47 offset:10240
    s_waitcnt vmcnt(3) lgkmcnt(4)
    v_mfma_f32_32x32x16_bf16 v[208:223], v[160:163], a[240:243], v[208:223]
    ds_read_b128 v[184:187], v47 offset:7168
    v_mfma_f32_32x32x16_bf16 v[224:239], a[240:243], v[164:167], v[224:239]
    ds_read_b128 v[188:191], v47 offset:11264
    s_waitcnt vmcnt(2) lgkmcnt(4)
    v_mfma_f32_32x32x16_bf16 v[208:223], v[168:171], a[244:247], v[208:223]
    v_mfma_f32_32x32x16_bf16 v[224:239], a[244:247], v[172:175], v[224:239]
    v_mad_u32_u24 v46, s40, 3, v1
    s_waitcnt vmcnt(1) lgkmcnt(2)
    v_mfma_f32_32x32x16_bf16 v[208:223], v[176:179], a[248:251], v[208:223]
    v_mfma_f32_32x32x16_bf16 v[224:239], a[248:251], v[180:183], v[224:239]
    s_waitcnt vmcnt(0) lgkmcnt(0)
    v_mfma_f32_32x32x16_bf16 v[208:223], v[184:187], a[252:255], v[208:223]
    v_mfma_f32_32x32x16_bf16 v[224:239], a[252:255], v[188:191], v[224:239]
    ds_read_b128 v[160:163], v46 offset:0
    ds_read_b128 v[164:167], v46 offset:1024
    ds_read_b128 v[168:171], v46 offset:2048
    ds_read_b128 v[172:175], v46 offset:3072
    v_mad_u32_u24 v47, s41, 3, v1
    ds_read_b128 v[176:179], v47 offset:0
    ds_read_b128 v[180:183], v47 offset:1024
    s_nop 3
    v_pk_mul_f32 v[208:209], v[252:253], v[208:209]
    v_pk_mul_f32 v[210:211], v[252:253], v[210:211]
    v_pk_mul_f32 v[212:213], v[252:253], v[212:213]
    v_pk_mul_f32 v[214:215], v[252:253], v[214:215]
    v_pk_mul_f32 v[216:217], v[252:253], v[216:217]
    v_pk_mul_f32 v[218:219], v[252:253], v[218:219]
    v_pk_mul_f32 v[220:221], v[252:253], v[220:221]
    v_pk_mul_f32 v[222:223], v[252:253], v[222:223]
    v_cvt_pk_bf16_f32 v208, v208, v209
    v_cvt_pk_bf16_f32 v209, v210, v211
    v_cvt_pk_bf16_f32 v210, v212, v213
    v_cvt_pk_bf16_f32 v211, v214, v215
    v_cvt_pk_bf16_f32 v212, v216, v217
    v_cvt_pk_bf16_f32 v213, v218, v219
    v_cvt_pk_bf16_f32 v214, v220, v221
    v_cvt_pk_bf16_f32 v215, v222, v223
    buffer_store_dwordx4 v[208:211], v1, s[4:7], s96 offen offset:0 sc1
    buffer_store_dwordx4 v[212:215], v1, s[4:7], s96 offen offset:1024 sc1
    v_pk_mul_f32 v[224:225], v[240:241], v[224:225]
    v_pk_mul_f32 v[226:227], v[242:243], v[226:227]
    v_pk_mul_f32 v[228:229], v[244:245], v[228:229]
    v_pk_mul_f32 v[230:231], v[246:247], v[230:231]
    v_pk_mul_f32 v[232:233], v[192:193], v[232:233]
    v_pk_mul_f32 v[234:235], v[194:195], v[234:235]
    v_pk_mul_f32 v[236:237], v[196:197], v[236:237]
    v_pk_mul_f32 v[238:239], v[198:199], v[238:239]
    v_cvt_pk_bf16_f32 v216, v224, v225
    v_cvt_pk_bf16_f32 v217, v226, v227
    v_cvt_pk_bf16_f32 v218, v228, v229
    v_cvt_pk_bf16_f32 v219, v230, v231
    v_cvt_pk_bf16_f32 v220, v232, v233
    v_cvt_pk_bf16_f32 v221, v234, v235
    v_cvt_pk_bf16_f32 v222, v236, v237
    v_cvt_pk_bf16_f32 v223, v238, v239
    buffer_store_dwordx4 v[216:219], v1, s[4:7], s96 offen offset:2048 sc1
    buffer_store_dwordx4 v[220:223], v1, s[4:7], s96 offen offset:3072 sc1
    v_mfma_f32_32x32x16_bf16 v[192:207], a[224:227], v[248:251], 0
    s_waitcnt lgkmcnt(4)
    v_mfma_f32_32x32x16_bf16 v[192:207], v[160:163], v[48:51], v[192:207]
    ds_read_b128 v[184:187], v47 offset:2048
    ds_write_b128 v40, v[208:211] offset:33280
    v_mfma_f32_32x32x16_bf16 v[192:207], v[164:167], v[52:55], v[192:207]
    ds_read_b128 v[188:191], v47 offset:3072
    ds_write_b128 v40, v[212:215] offset:34304
    s_waitcnt lgkmcnt(6)
    v_mfma_f32_32x32x16_bf16 v[192:207], v[168:171], v[56:59], v[192:207]
    v_mad_u32_u24 v46, s42, 3, v1
    ds_read_b128 v[160:163], v46 offset:0
    ds_write_b128 v40, v[216:219] offset:35328
    v_mfma_f32_32x32x16_bf16 v[192:207], v[172:175], v[60:63], v[192:207]
    ds_read_b128 v[164:167], v46 offset:1024
    ds_write_b128 v40, v[220:223] offset:36384
    s_waitcnt lgkmcnt(8)
    v_mfma_f32_32x32x16_bf16 v[192:207], v[176:179], v[64:67], v[192:207]
    ds_read_b128 v[168:171], v46 offset:2048
    s_lshl_b32 s33, s20, 2
    s_add_u32 s33, s33, s35
    v_mfma_f32_32x32x16_bf16 v[192:207], v[180:183], v[68:71], v[192:207]
    ds_read_b128 v[172:175], v46 offset:3072
    s_waitcnt lgkmcnt(7)
    v_mfma_f32_32x32x16_bf16 v[192:207], v[184:187], v[72:75], v[192:207]
    v_mad_u32_u24 v47, s43, 3, v1
    ds_read_b128 v[176:179], v47 offset:0
    v_mfma_f32_32x32x16_bf16 v[192:207], v[188:191], v[76:79], v[192:207]
    ds_read_b128 v[180:183], v47 offset:1024
    s_waitcnt lgkmcnt(5)
    v_mfma_f32_32x32x16_bf16 v[192:207], v[160:163], v[80:83], v[192:207]
    ds_read_b128 v[184:187], v47 offset:2048
    v_mfma_f32_32x32x16_bf16 v[192:207], v[164:167], v[84:87], v[192:207]
    ds_read_b128 v[188:191], v47 offset:3072
    s_waitcnt lgkmcnt(4)
    v_mfma_f32_32x32x16_bf16 v[192:207], v[168:171], v[88:91], v[192:207]
    v_mad_u32_u24 v46, s44, 3, v1
    ds_read_b128 v[160:163], v46 offset:0
    v_mfma_f32_32x32x16_bf16 v[192:207], v[172:175], v[92:95], v[192:207]
    ds_read_b128 v[164:167], v46 offset:1024
    s_waitcnt lgkmcnt(4)
    v_mfma_f32_32x32x16_bf16 v[192:207], v[176:179], v[96:99], v[192:207]
    ds_read_b128 v[168:171], v46 offset:2048
    v_mfma_f32_32x32x16_bf16 v[192:207], v[180:183], v[100:103], v[192:207]
    ds_read_b128 v[172:175], v46 offset:3072
    s_waitcnt lgkmcnt(4)
    v_mfma_f32_32x32x16_bf16 v[192:207], v[184:187], v[104:107], v[192:207]
    v_mad_u32_u24 v47, s45, 3, v1
    ds_read_b128 v[176:179], v47 offset:0
    v_mfma_f32_32x32x16_bf16 v[192:207], v[188:191], v[108:111], v[192:207]
    ds_read_b128 v[180:183], v47 offset:1024
    s_waitcnt lgkmcnt(4)
    v_mfma_f32_32x32x16_bf16 v[192:207], v[160:163], v[112:115], v[192:207]
    ds_read_b128 v[184:187], v47 offset:2048
    v_mfma_f32_32x32x16_bf16 v[192:207], v[164:167], v[116:119], v[192:207]
    ds_read_b128 v[188:191], v47 offset:3072
    s_waitcnt lgkmcnt(4)
    v_mfma_f32_32x32x16_bf16 v[192:207], v[168:171], v[120:123], v[192:207]
    v_mad_u32_u24 v46, s46, 3, v1
    ds_read_b128 v[160:163], v46 offset:0
    s_waitcnt vmcnt(0)
    s_mov_b64 exec, 1
    buffer_store_dword v11, v9, s[4:7], s33 offen offset:0 sc1
    s_mov_b64 exec, -1
    v_mfma_f32_32x32x16_bf16 v[192:207], v[172:175], v[124:127], v[192:207]
    ds_read_b128 v[164:167], v46 offset:1024
    s_waitcnt lgkmcnt(4)
    v_mfma_f32_32x32x16_bf16 v[192:207], v[176:179], v[128:131], v[192:207]
    ds_read_b128 v[168:171], v46 offset:2048
    v_mfma_f32_32x32x16_bf16 v[192:207], v[180:183], v[132:135], v[192:207]
    ds_read_b128 v[172:175], v46 offset:3072
    s_waitcnt lgkmcnt(4)
    v_mfma_f32_32x32x16_bf16 v[192:207], v[184:187], v[136:139], v[192:207]
    v_mad_u32_u24 v47, s47, 3, v1
    ds_read_b128 v[176:179], v47 offset:0
    v_mfma_f32_32x32x16_bf16 v[192:207], v[188:191], v[140:143], v[192:207]
    ds_read_b128 v[180:183], v47 offset:1024
    s_waitcnt lgkmcnt(4)
    v_mfma_f32_32x32x16_bf16 v[192:207], v[160:163], v[144:147], v[192:207]
    ds_read_b128 v[184:187], v47 offset:2048
    s_lshr_b32 s30, s20, 1
    s_sub_u32 s30, 2, s30
    s_min_u32 s31, s30, s21
    s_lshl_b32 s32, s31, 11
    s_sub_u32 s35, s35, s32
    v_mfma_f32_32x32x16_bf16 v[192:207], v[164:167], v[148:151], v[192:207]
    ds_read_b128 v[188:191], v47 offset:3072
    s_waitcnt lgkmcnt(4)
    v_mfma_f32_32x32x16_bf16 v[192:207], v[168:171], v[152:155], v[192:207]
    s_and_b32 s32, s20, 1
    s_lshl_b32 s32, s32, 1
    s_lshl_b32 s32, 3, s32
    s_cmp_eq_u32 s30, s31
    s_cselect_b32 s32, s32, 1
    s_mov_b32 s33, 0
    v_mfma_f32_32x32x16_bf16 v[192:207], v[172:175], v[156:159], v[192:207]
    s_waitcnt lgkmcnt(2)
    v_mfma_f32_32x32x16_bf16 v[192:207], v[176:179], a[240:243], v[192:207]
    s_lshl_b32 s100, s22, 18
    s_add_u32 s100, s100, s26
    s_mul_i32 s101, s20, 8320
    s_add_u32 s101, s101, 98304
    v_mfma_f32_32x32x16_bf16 v[192:207], v[180:183], a[244:247], v[192:207]
    s_waitcnt lgkmcnt(0)
    v_mfma_f32_32x32x16_bf16 v[192:207], v[184:187], a[248:251], v[192:207]
    v_mfma_f32_32x32x16_bf16 v[192:207], v[188:191], a[252:255], v[192:207]
M_slow_entry:
    s_mov_b64 exec, s[32:33]
    buffer_load_dword v45, v10, s[4:7], s35 offen sc1
    s_mov_b64 exec, -1
    s_nop 8
    v_pk_mul_f32 v[192:193], v[254:255], v[192:193]
    v_pk_mul_f32 v[194:195], v[254:255], v[194:195]
    v_pk_mul_f32 v[196:197], v[254:255], v[196:197]
    v_pk_mul_f32 v[198:199], v[254:255], v[198:199]
    v_pk_mul_f32 v[200:201], v[254:255], v[200:201]
    v_pk_mul_f32 v[202:203], v[254:255], v[202:203]
    v_pk_mul_f32 v[204:205], v[254:255], v[204:205]
    v_pk_mul_f32 v[206:207], v[254:255], v[206:207]
    v_cvt_pk_bf16_f32 v48, v192, v193
    v_cvt_pk_bf16_f32 v49, v194, v195
    v_cvt_pk_bf16_f32 v50, v196, v197
    v_cvt_pk_bf16_f32 v51, v198, v199
    v_cvt_pk_bf16_f32 v52, v200, v201
    v_cvt_pk_bf16_f32 v53, v202, v203
    v_cvt_pk_bf16_f32 v54, v204, v205
    v_cvt_pk_bf16_f32 v55, v206, v207
    s_mov_b64 exec, s[32:33]
S_44:
    s_waitcnt vmcnt(0)
    v_cmp_ne_u32 vcc, v11, v45
    s_nop 0
    s_cbranch_vccz S_43
    buffer_load_dword v45, v10, s[4:7], s35 offen sc1
    s_add_u32 s39, s39, 1
    s_cmp_lt_u32 s39, 200000
    s_cbranch_scc1 S_44
S_43:
    s_mov_b64 exec, -1
    s_cmp_eq_u32 s30, s31
    s_cbranch_scc1 K_45
    v_mov_b32 v47, 0x7ff00000
    s_add_u32 m0, s101, 0
    s_nop 0
    buffer_load_dwordx4 v43, s[4:7], s100 offen offset:0 sc1 lds
    s_add_u32 m0, s101, 4160
    s_nop 0
    buffer_load_dwordx4 v43, s[4:7], s100 offen offset:0 sc1 lds
    s_add_u32 m0, s101, 0
    s_nop 0
    buffer_load_dwordx4 v43, s[4:7], s100 offen offset:1024 sc1 lds
    s_add_u32 m0, s101, 4160
    s_nop 0
    buffer_load_dwordx4 v43, s[4:7], s100 offen offset:1024 sc1 lds
    s_add_u32 m0, s101, 2048
    s_nop 0
    buffer_load_dwordx4 v47, s[4:7], 0 offen sc1 lds
    s_add_u32 m0, s101, 6208
    s_nop 0
    buffer_load_dwordx4 v47, s[4:7], 0 offen sc1 lds
    s_add_u32 m0, s101, 3104
    s_nop 0
    buffer_load_dwordx4 v47, s[4:7], 0 offen sc1 lds
    s_add_u32 m0, s101, 7264
    s_nop 0
    buffer_load_dwordx4 v47, s[4:7], 0 offen sc1 lds
    s_branch K_46
K_45:
    s_lshl_b32 s31, s21, 2
    s_lshl_b32 s32, s20, 1
    s_add_u32 s31, s31, s32
    s_sub_u32 s31, s31, 8
    s_lshl_b32 s31, s31, 12
    s_add_u32 s100, s100, s31
    s_add_u32 s33, s100, 4096
    s_add_u32 m0, s101, 0
    s_nop 0
    buffer_load_dwordx4 v1, s[4:7], s100 offen offset:0 sc1 lds
    s_add_u32 m0, s101, 4160
    s_nop 0
    buffer_load_dwordx4 v1, s[4:7], s33 offen offset:0 sc1 lds
    s_add_u32 m0, s101, 0
    s_nop 0
    buffer_load_dwordx4 v1, s[4:7], s100 offen offset:1024 sc1 lds
    s_add_u32 m0, s101, 4160
    s_nop 0
    buffer_load_dwordx4 v1, s[4:7], s33 offen offset:1024 sc1 lds
    s_add_u32 m0, s101, 0
    s_nop 0
    buffer_load_dwordx4 v1, s[4:7], s100 offen offset:2048 sc1 lds
    s_add_u32 m0, s101, 4160
    s_nop 0
    buffer_load_dwordx4 v1, s[4:7], s33 offen offset:2048 sc1 lds
    s_add_u32 m0, s101, 32
    s_nop 0
    buffer_load_dwordx4 v1, s[4:7], s100 offen offset:3072 sc1 lds
    s_add_u32 m0, s101, 4192
    s_nop 0
    buffer_load_dwordx4 v1, s[4:7], s33 offen offset:3072 sc1 lds
K_46:
    s_lshl_b32 s30, s28, 15
    s_lshl_b32 s31, s22, 11
    s_add_u32 s30, s30, s31
    s_add_u32 s96, s30, 19922944
    s_lshl_b32 s14, s24, 16
    s_and_b32 s30, s20, 1
    s_lshl_b32 s30, s30, 15
    s_add_u32 s14, s14, s30
    s_add_u32 s14, s14, 1048576
    s_waitcnt lgkmcnt(0)
    s_waitcnt vmcnt(6)
    s_barrier
    ds_read_b128 v[56:59], v40 offset:0
    ds_read_b128 v[60:63], v40 offset:33280
    ds_read_b128 v[64:67], v40 offset:4160
    ds_read_b128 v[68:71], v40 offset:8320
    ds_read_b128 v[72:75], v40 offset:12480
    ds_read_b128 v[76:79], v40 offset:16640
    ds_read_b128 a[240:243], v40 offset:20800
    ds_read_b128 a[244:247], v40 offset:24960
    ds_read_b128 a[248:251], v40 offset:29120
    s_waitcnt lgkmcnt(7)
    v_mfma_f32_32x32x16_bf16 v[80:95], v[56:59], v[48:51], 0
    v_mfma_f32_32x32x16_bf16 v[112:127], v[60:63], v[48:51], 0
    s_waitcnt lgkmcnt(3)
    v_mfma_f32_32x32x16_bf16 v[96:111], v[64:67], v[48:51], 0
    v_mfma_f32_32x32x16_bf16 v[128:143], v[68:71], v[48:51], 0
    s_nop 8
    v_cndmask_b32 v112, v80, v112, s[64:65]
    v_cndmask_b32 v113, v81, v113, s[66:67]
    v_cndmask_b32 v114, v82, v114, s[68:69]
    v_cndmask_b32 v115, v83, v115, s[70:71]
    v_cndmask_b32 v116, v84, v116, s[72:73]
    v_cndmask_b32 v117, v85, v117, s[74:75]
    v_cndmask_b32 v118, v86, v118, s[76:77]
    v_cndmask_b32 v119, v87, v119, s[78:79]
    v_mfma_f32_32x32x16_bf16 v[144:159], v[72:75], v[48:51], 0
    v_cndmask_b32 v120, v88, v120, s[80:81]
    v_cndmask_b32 v121, v89, v121, s[82:83]
    v_cndmask_b32 v122, v90, v122, s[84:85]
    v_cndmask_b32 v123, v91, v123, s[86:87]
    v_cndmask_b32 v124, v92, v124, s[88:89]
    v_cndmask_b32 v125, v93, v125, s[90:91]
    v_cndmask_b32 v126, v94, v126, s[92:93]
    v_cndmask_b32 v127, v95, v127, s[94:95]
    v_max_f32 v45, v112, v113
    v_mfma_f32_32x32x16_bf16 v[80:95], v[76:79], v[48:51], 0
    v_max3_f32 v45, v114, v115, v45
    v_max3_f32 v45, v116, v117, v45
    v_max3_f32 v45, v118, v119, v45
    v_max3_f32 v45, v120, v121, v45
    v_max3_f32 v45, v122, v123, v45
    v_max3_f32 v45, v124, v125, v45
    v_max3_f32 v45, v126, v127, v45
    v_max3_f32 v45, v96, v97, v45
    v_max3_f32 v45, v98, v99, v45
    v_max3_f32 v45, v100, v101, v45
    v_max3_f32 v45, v102, v103, v45
    v_max3_f32 v45, v104, v105, v45
    v_max3_f32 v45, v106, v107, v45
    v_max3_f32 v45, v108, v109, v45
    v_max3_f32 v45, v110, v111, v45
    s_waitcnt lgkmcnt(0)
    v_mfma_f32_32x32x16_bf16 v[96:111], a[240:243], v[48:51], 0
    v_max3_f32 v45, v128, v129, v45
    v_max3_f32 v45, v130, v131, v45
    v_max3_f32 v45, v132, v133, v45
    v_max3_f32 v45, v134, v135, v45
    v_max3_f32 v45, v136, v137, v45
    v_max3_f32 v45, v138, v139, v45
    v_max3_f32 v45, v140, v141, v45
    v_max3_f32 v45, v142, v143, v45
    v_mfma_f32_32x32x16_bf16 v[128:143], a[244:247], v[48:51], 0
    v_max3_f32 v45, v144, v145, v45
    v_max3_f32 v45, v146, v147, v45
    v_max3_f32 v45, v148, v149, v45
    v_max3_f32 v45, v150, v151, v45
    v_max3_f32 v45, v152, v153, v45
    v_max3_f32 v45, v154, v155, v45
    v_max3_f32 v45, v156, v157, v45
    v_max3_f32 v45, v158, v159, v45
    v_mfma_f32_32x32x16_bf16 v[144:159], a[248:251], v[48:51], 0
    v_max3_f32 v45, v80, v81, v45
    v_max3_f32 v45, v82, v83, v45
    v_max3_f32 v45, v84, v85, v45
    v_max3_f32 v45, v86, v87, v45
    v_max3_f32 v45, v88, v89, v45
    v_max3_f32 v45, v90, v91, v45
    v_max3_f32 v45, v92, v93, v45
    v_max3_f32 v45, v94, v95, v45
    v_max3_f32 v45, v96, v97, v45
    v_max3_f32 v45, v98, v99, v45
    v_max3_f32 v45, v100, v101, v45
    v_max3_f32 v45, v102, v103, v45
    v_max3_f32 v45, v104, v105, v45
    v_max3_f32 v45, v106, v107, v45
    v_max3_f32 v45, v108, v109, v45
    v_max3_f32 v45, v110, v111, v45
    v_max3_f32 v45, v128, v129, v45
    v_max3_f32 v45, v130, v131, v45
    v_max3_f32 v45, v132, v133, v45
    v_max3_f32 v45, v134, v135, v45
    v_max3_f32 v45, v136, v137, v45
    v_max3_f32 v45, v138, v139, v45
    v_max3_f32 v45, v140, v141, v45
    v_max3_f32 v45, v142, v143, v45
    s_waitcnt vmcnt(0)
    s_barrier
    v_max3_f32 v45, v144, v145, v45
    v_max3_f32 v45, v146, v147, v45
    v_max3_f32 v45, v148, v149, v45
    v_max3_f32 v45, v150, v151, v45
    v_max3_f32 v45, v152, v153, v45
    v_max3_f32 v45, v154, v155, v45
    v_max3_f32 v45, v156, v157, v45
    v_max3_f32 v45, v158, v159, v45
    v_mov_b32 v128, v45
    ds_read_b128 v[160:163], v41 offset:0
    ds_read_b128 v[164:167], v41 offset:1056
    v_permlane32_swap_b32 v128, v45
    v_max_f32 v45, v128, v45
    v_sub_f32 v128, 0, v45
    v_sub_f32 v129, 0, v45
    v_pk_mov_b32 v[130:131], v[128:129], v[128:129]
    v_pk_mov_b32 v[132:133], v[128:129], v[128:129]
    v_pk_mov_b32 v[134:135], v[128:129], v[128:129]
    v_pk_mov_b32 v[136:137], v[128:129], v[128:129]
    v_pk_mov_b32 v[138:139], v[128:129], v[128:129]
    v_pk_mov_b32 v[140:141], v[128:129], v[128:129]
    v_pk_mov_b32 v[142:143], v[128:129], v[128:129]
    v_pk_add_f32 v[112:113], v[112:113], v[128:129]
    v_pk_add_f32 v[114:115], v[114:115], v[128:129]
    v_pk_add_f32 v[116:117], v[116:117], v[128:129]
    v_pk_add_f32 v[118:119], v[118:119], v[128:129]
    v_pk_add_f32 v[120:121], v[120:121], v[128:129]
    v_pk_add_f32 v[122:123], v[122:123], v[128:129]
    v_pk_add_f32 v[124:125], v[124:125], v[128:129]
    v_pk_add_f32 v[126:127], v[126:127], v[128:129]
    ds_read_b128 v[168:171], v41 offset:33280
    ds_read_b128 v[172:175], v41 offset:34336
    v_mfma_f32_32x32x16_bf16 v[96:111], v[64:67], v[48:51], v[128:143]
    v_exp_f32 v112, v112
    v_exp_f32 v113, v113
    v_exp_f32 v114, v114
    v_cvt_pk_bf16_f32 v112, v112, v113
    s_mul_i32 s100, s20, 24576
    s_add_u32 m0, s100, 0
    s_mul_i32 s101, s22, 114688
    s_add_u32 s101, s101, s100
    s_add_u32 s101, s101, 3407872
    buffer_load_dwordx4 v1, s[4:7], s101 offen offset:0 lds
    v_exp_f32 v115, v115
    v_exp_f32 v116, v116
    v_cvt_pk_bf16_f32 v113, v114, v115
    v_exp_f32 v117, v117
    v_exp_f32 v118, v118
    v_cvt_pk_bf16_f32 v114, v116, v117
    v_exp_f32 v119, v119
    v_exp_f32 v120, v120
    v_cvt_pk_bf16_f32 v115, v118, v119
    buffer_load_dwordx4 v1, s[4:7], s101 offen offset:1024 lds
    v_exp_f32 v121, v121
    v_exp_f32 v122, v122
    v_cvt_pk_bf16_f32 v116, v120, v121
    v_exp_f32 v123, v123
    v_exp_f32 v124, v124
    v_cvt_pk_bf16_f32 v117, v122, v123
    v_exp_f32 v125, v125
    v_exp_f32 v126, v126
    v_cvt_pk_bf16_f32 v118, v124, v125
    buffer_load_dwordx4 v1, s[4:7], s101 offen offset:2048 lds
    v_exp_f32 v127, v127
    v_and_b32 v120, v32, v112
    v_cvt_pk_bf16_f32 v119, v126, v127
    v_xor_b32 v112, v120, v112
    v_and_b32 v121, v33, v113
    v_xor_b32 v113, v121, v113
    v_and_b32 v122, v34, v114
    v_xor_b32 v114, v122, v114
    v_and_b32 v123, v35, v115
    v_xor_b32 v115, v123, v115
    v_and_b32 v124, v36, v116
    v_xor_b32 v116, v124, v116
    v_and_b32 v125, v37, v117
    v_xor_b32 v117, v125, v117
    v_and_b32 v126, v38, v118
    v_xor_b32 v118, v126, v118
    v_and_b32 v127, v39, v119
    v_xor_b32 v119, v127, v119
    v_mfma_f32_32x32x16_bf16 v[80:95], v[68:71], v[48:51], v[128:143]
    v_exp_f32 v96, v96
    v_exp_f32 v97, v97
    buffer_load_dwordx4 v1, s[4:7], s101 offen offset:3072 lds
    v_exp_f32 v98, v98
    v_cvt_pk_bf16_f32 v152, v96, v97
    s_waitcnt lgkmcnt(0)
    v_mfma_f32_32x32x16_bf16 v[176:191], v[160:163], v[112:115], 0
    v_exp_f32 v99, v99
    v_exp_f32 v100, v100
    v_cvt_pk_bf16_f32 v153, v98, v99
    v_exp_f32 v101, v101
    v_mfma_f32_32x32x16_bf16 v[176:191], v[164:167], v[116:119], v[176:191]
    v_exp_f32 v102, v102
    v_cvt_pk_bf16_f32 v154, v100, v101
    ds_read_b128 v[160:163], v41 offset:4160
    v_exp_f32 v103, v103
    v_exp_f32 v104, v104
    v_cvt_pk_bf16_f32 v155, v102, v103
    v_mfma_f32_32x32x16_bf16 v[176:191], v[168:171], v[120:123], v[176:191]
    s_add_u32 m0, m0, 4096
    s_add_u32 s101, s101, 4096
    buffer_load_dwordx4 v1, s[4:7], s101 offen offset:0 lds
    v_exp_f32 v105, v105
    v_exp_f32 v106, v106
    v_cvt_pk_bf16_f32 v156, v104, v105
    v_exp_f32 v107, v107
    v_mfma_f32_32x32x16_bf16 v[176:191], v[172:175], v[124:127], v[176:191]
    v_exp_f32 v108, v108
    v_cvt_pk_bf16_f32 v157, v106, v107
    v_exp_f32 v109, v109
    buffer_load_dwordx4 v1, s[4:7], s101 offen offset:1024 lds
    v_exp_f32 v110, v110
    v_cvt_pk_bf16_f32 v158, v108, v109
    v_exp_f32 v111, v111
    ds_read_b128 v[164:167], v41 offset:5216
    v_cvt_pk_bf16_f32 v159, v110, v111
    v_mfma_f32_32x32x16_bf16 v[96:111], v[72:75], v[48:51], v[128:143]
    v_exp_f32 v80, v80
    v_exp_f32 v81, v81
    buffer_load_dwordx4 v1, s[4:7], s101 offen offset:2048 lds
    v_exp_f32 v82, v82
    v_cvt_pk_bf16_f32 v144, v80, v81
    v_exp_f32 v83, v83
    v_exp_f32 v84, v84
    v_cvt_pk_bf16_f32 v145, v82, v83
    s_waitcnt lgkmcnt(0)
    v_mfma_f32_32x32x16_bf16 v[176:191], v[160:163], v[152:155], v[176:191]
    v_exp_f32 v85, v85
    v_exp_f32 v86, v86
    v_cvt_pk_bf16_f32 v146, v84, v85
    ds_read_b128 v[168:171], v41 offset:8320
    v_exp_f32 v87, v87
    v_exp_f32 v88, v88
    v_cvt_pk_bf16_f32 v147, v86, v87
    buffer_load_dwordx4 v1, s[4:7], s101 offen offset:3072 lds
    v_exp_f32 v89, v89
    v_exp_f32 v90, v90
    v_cvt_pk_bf16_f32 v148, v88, v89
    v_mfma_f32_32x32x16_bf16 v[176:191], v[164:167], v[156:159], v[176:191]
    v_exp_f32 v91, v91
    v_exp_f32 v92, v92
    v_cvt_pk_bf16_f32 v149, v90, v91
    ds_read_b128 v[56:59], v40 offset:1024
    v_exp_f32 v93, v93
    s_add_u32 m0, m0, 4096
    s_add_u32 s101, s101, 4096
    buffer_load_dwordx4 v1, s[4:7], s101 offen offset:0 lds
    v_exp_f32 v94, v94
    v_cvt_pk_bf16_f32 v150, v92, v93
    v_exp_f32 v95, v95
    ds_read_b128 v[172:175], v41 offset:9376
    v_cvt_pk_bf16_f32 v151, v94, v95
    v_mfma_f32_32x32x16_bf16 v[80:95], v[76:79], v[48:51], v[128:143]
    v_exp_f32 v96, v96
    v_exp_f32 v97, v97
    buffer_load_dwordx4 v1, s[4:7], s101 offen offset:1024 lds
    v_exp_f32 v98, v98
    v_cvt_pk_bf16_f32 v152, v96, v97
    v_exp_f32 v99, v99
    v_exp_f32 v100, v100
    v_cvt_pk_bf16_f32 v153, v98, v99
    s_waitcnt lgkmcnt(0)
    v_mfma_f32_32x32x16_bf16 v[176:191], v[168:171], v[144:147], v[176:191]
    v_exp_f32 v101, v101
    v_exp_f32 v102, v102
    v_cvt_pk_bf16_f32 v154, v100, v101
    ds_read_b128 v[160:163], v41 offset:12480
    v_exp_f32 v103, v103
    v_exp_f32 v104, v104
    v_cvt_pk_bf16_f32 v155, v102, v103
    buffer_load_dwordx4 v1, s[4:7], s101 offen offset:2048 lds
    v_exp_f32 v105, v105
    v_exp_f32 v106, v106
    v_cvt_pk_bf16_f32 v156, v104, v105
    v_mfma_f32_32x32x16_bf16 v[176:191], v[172:175], v[148:151], v[176:191]
    v_exp_f32 v107, v107
    v_exp_f32 v108, v108
    v_cvt_pk_bf16_f32 v157, v106, v107
    ds_read_b128 v[60:63], v40 offset:34304
    ds_read_b128 a[252:255], v40 offset:5184
    v_exp_f32 v109, v109
    buffer_load_dwordx4 v1, s[4:7], s101 offen offset:3072 lds
    v_exp_f32 v110, v110
    v_cvt_pk_bf16_f32 v158, v108, v109
    v_exp_f32 v111, v111
    ds_read_b128 v[164:167], v41 offset:13536
    v_cvt_pk_bf16_f32 v159, v110, v111
    v_mfma_f32_32x32x16_bf16 v[96:111], a[240:243], v[48:51], v[128:143]
    v_exp_f32 v80, v80
    v_exp_f32 v81, v81
    s_add_u32 m0, m0, 4096
    s_add_u32 s101, s101, 4096
    buffer_load_dwordx4 v1, s[4:7], s101 offen offset:0 lds
    v_exp_f32 v82, v82
    v_cvt_pk_bf16_f32 v144, v80, v81
    v_exp_f32 v83, v83
    v_exp_f32 v84, v84
    v_cvt_pk_bf16_f32 v145, v82, v83
    s_waitcnt lgkmcnt(0)
    v_mfma_f32_32x32x16_bf16 v[176:191], v[160:163], v[152:155], v[176:191]
    v_exp_f32 v85, v85
    v_exp_f32 v86, v86
    v_cvt_pk_bf16_f32 v146, v84, v85
    ds_read_b128 v[168:171], v41 offset:16640
    v_exp_f32 v87, v87
    v_exp_f32 v88, v88
    v_cvt_pk_bf16_f32 v147, v86, v87
    buffer_load_dwordx4 v1, s[4:7], s101 offen offset:1024 lds
    v_exp_f32 v89, v89
    v_exp_f32 v90, v90
    v_cvt_pk_bf16_f32 v148, v88, v89
    v_mfma_f32_32x32x16_bf16 v[176:191], v[164:167], v[156:159], v[176:191]
    v_exp_f32 v91, v91
    v_exp_f32 v92, v92
    v_cvt_pk_bf16_f32 v149, v90, v91
    ds_read_b128 v[64:67], v40 offset:9344
    ds_read_b128 v[68:71], v40 offset:13504
    v_exp_f32 v93, v93
    buffer_load_dwordx4 v1, s[4:7], s101 offen offset:2048 lds
    v_exp_f32 v94, v94
    v_cvt_pk_bf16_f32 v150, v92, v93
    v_exp_f32 v95, v95
    ds_read_b128 v[172:175], v41 offset:17696
    v_cvt_pk_bf16_f32 v151, v94, v95
    v_mfma_f32_32x32x16_bf16 v[80:95], a[244:247], v[48:51], v[128:143]
    v_exp_f32 v96, v96
    v_exp_f32 v97, v97
    buffer_load_dwordx4 v1, s[4:7], s101 offen offset:3072 lds
    v_exp_f32 v98, v98
    v_cvt_pk_bf16_f32 v152, v96, v97
    v_exp_f32 v99, v99
    v_exp_f32 v100, v100
    v_cvt_pk_bf16_f32 v153, v98, v99
    s_waitcnt lgkmcnt(0)
    v_mfma_f32_32x32x16_bf16 v[176:191], v[168:171], v[144:147], v[176:191]
    v_exp_f32 v101, v101
    v_exp_f32 v102, v102
    v_cvt_pk_bf16_f32 v154, v100, v101
    ds_read_b128 v[160:163], v41 offset:20800
    v_exp_f32 v103, v103
    v_exp_f32 v104, v104
    v_cvt_pk_bf16_f32 v155, v102, v103
    s_add_u32 m0, m0, 4096
    s_add_u32 s101, s101, 4096
    buffer_load_dwordx4 v1, s[4:7], s101 offen offset:0 lds
    v_exp_f32 v105, v105
    v_exp_f32 v106, v106
    v_cvt_pk_bf16_f32 v156, v104, v105
    v_mfma_f32_32x32x16_bf16 v[176:191], v[172:175], v[148:151], v[176:191]
    v_exp_f32 v107, v107
    v_exp_f32 v108, v108
    v_cvt_pk_bf16_f32 v157, v106, v107
    ds_read_b128 v[72:75], v40 offset:17664
    ds_read_b128 v[76:79], v40 offset:21824
    v_exp_f32 v109, v109
    buffer_load_dwordx4 v1, s[4:7], s101 offen offset:1024 lds
    v_exp_f32 v110, v110
    v_cvt_pk_bf16_f32 v158, v108, v109
    v_exp_f32 v111, v111
    ds_read_b128 v[164:167], v41 offset:21856
    v_cvt_pk_bf16_f32 v159, v110, v111
    v_mfma_f32_32x32x16_bf16 v[96:111], a[248:251], v[48:51], v[128:143]
    v_exp_f32 v80, v80
    v_exp_f32 v81, v81
    buffer_load_dwordx4 v1, s[4:7], s101 offen offset:2048 lds
    v_exp_f32 v82, v82
    v_cvt_pk_bf16_f32 v144, v80, v81
    v_exp_f32 v83, v83
    v_exp_f32 v84, v84
    v_cvt_pk_bf16_f32 v145, v82, v83
    s_waitcnt lgkmcnt(0)
    v_mfma_f32_32x32x16_bf16 v[176:191], v[160:163], v[152:155], v[176:191]
    v_exp_f32 v85, v85
    v_exp_f32 v86, v86
    v_cvt_pk_bf16_f32 v146, v84, v85
    ds_read_b128 v[168:171], v41 offset:24960
    v_exp_f32 v87, v87
    v_exp_f32 v88, v88
    v_cvt_pk_bf16_f32 v147, v86, v87
    buffer_load_dwordx4 v1, s[4:7], s101 offen offset:3072 lds
    v_exp_f32 v89, v89
    v_exp_f32 v90, v90
    v_cvt_pk_bf16_f32 v148, v88, v89
    v_mfma_f32_32x32x16_bf16 v[176:191], v[164:167], v[156:159], v[176:191]
    v_exp_f32 v91, v91
    v_exp_f32 v92, v92
    v_cvt_pk_bf16_f32 v149, v90, v91
    ds_read_b128 a[240:243], v40 offset:25984
    ds_read_b128 a[244:247], v40 offset:30144
    v_exp_f32 v93, v93
    s_add_u32 m0, m0, 4096
    s_add_u32 s101, s101, 4096
    buffer_load_dwordx4 v1, s[4:7], s101 offen offset:0 lds
    v_exp_f32 v94, v94
    v_cvt_pk_bf16_f32 v150, v92, v93
    v_exp_f32 v95, v95
    ds_read_b128 v[172:175], v41 offset:26016
    v_cvt_pk_bf16_f32 v151, v94, v95
    v_exp_f32 v96, v96
    v_mfma_f32_32x32x16_bf16 v[80:95], v[56:59], v[52:55], 0
    v_exp_f32 v97, v97
    buffer_load_dwordx4 v1, s[4:7], s101 offen offset:1024 lds
    v_exp_f32 v98, v98
    v_cvt_pk_bf16_f32 v152, v96, v97
    v_exp_f32 v99, v99
    v_exp_f32 v100, v100
    v_cvt_pk_bf16_f32 v153, v98, v99
    s_waitcnt lgkmcnt(0)
    v_mfma_f32_32x32x16_bf16 v[176:191], v[168:171], v[144:147], v[176:191]
    v_exp_f32 v101, v101
    v_exp_f32 v102, v102
    v_cvt_pk_bf16_f32 v154, v100, v101
    ds_read_b128 v[160:163], v41 offset:29120
    ds_read_b128 v[164:167], v41 offset:30176
    v_exp_f32 v103, v103
    v_mfma_f32_32x32x16_bf16 v[112:127], v[60:63], v[52:55], 0
    v_exp_f32 v104, v104
    v_cvt_pk_bf16_f32 v155, v102, v103
    buffer_load_dwordx4 v1, s[4:7], s101 offen offset:2048 lds
    v_exp_f32 v105, v105
    v_exp_f32 v106, v106
    v_cvt_pk_bf16_f32 v156, v104, v105
    v_mfma_f32_32x32x16_bf16 v[176:191], v[172:175], v[148:151], v[176:191]
    v_exp_f32 v107, v107
    v_exp_f32 v108, v108
    v_cvt_pk_bf16_f32 v157, v106, v107
    v_exp_f32 v109, v109
    buffer_load_dwordx4 v1, s[4:7], s101 offen offset:3072 lds
    s_waitcnt lgkmcnt(0)
    v_mfma_f32_32x32x16_bf16 v[176:191], v[160:163], v[152:155], v[176:191]
    v_exp_f32 v110, v110
    v_cvt_pk_bf16_f32 v158, v108, v109
    v_exp_f32 v111, v111
    s_nop 0
    v_cvt_pk_bf16_f32 v159, v110, v111
    s_nop 1
    v_mfma_f32_32x32x16_bf16 v[176:191], v[164:167], v[156:159], v[176:191]
    v_mfma_f32_32x32x16_bf16 v[96:111], a[252:255], v[52:55], 0
    v_mfma_f32_32x32x16_bf16 v[128:143], v[64:67], v[52:55], 0
    v_cndmask_b32 v112, v80, v112, s[64:65]
    v_cndmask_b32 v113, v81, v113, s[66:67]
    v_cndmask_b32 v114, v82, v114, s[68:69]
    v_cndmask_b32 v115, v83, v115, s[70:71]
    v_cndmask_b32 v116, v84, v116, s[72:73]
    v_cndmask_b32 v117, v85, v117, s[74:75]
    v_cndmask_b32 v118, v86, v118, s[76:77]
    v_cndmask_b32 v119, v87, v119, s[78:79]
    v_mfma_f32_32x32x16_bf16 v[144:159], v[68:71], v[52:55], 0
    v_cndmask_b32 v120, v88, v120, s[80:81]
    v_cndmask_b32 v121, v89, v121, s[82:83]
    v_cndmask_b32 v122, v90, v122, s[84:85]
    v_cndmask_b32 v123, v91, v123, s[86:87]
    v_cndmask_b32 v124, v92, v124, s[88:89]
    v_cndmask_b32 v125, v93, v125, s[90:91]
    v_cndmask_b32 v126, v94, v126, s[92:93]
    v_cndmask_b32 v127, v95, v127, s[94:95]
    v_max_f32 v45, v112, v113
    v_mfma_f32_32x32x16_bf16 v[80:95], v[72:75], v[52:55], 0
    v_rcp_f32 v184, v184
    s_nop 0
    v_mul_f32 v176, v176, v184
    v_mul_f32 v177, v177, v184
    v_mul_f32 v178, v178, v184
    v_mul_f32 v179, v179, v184
    v_mul_f32 v180, v180, v184
    v_mul_f32 v181, v181, v184
    v_mul_f32 v182, v182, v184
    v_mul_f32 v183, v183, v184
    v_cvt_pk_bf16_f32 v188, v176, v177
    v_cvt_pk_bf16_f32 v189, v178, v179
    v_cvt_pk_bf16_f32 v190, v180, v181
    v_cvt_pk_bf16_f32 v191, v182, v183
    buffer_store_dwordx4 v[188:191], v1, s[4:7], s96 offen offset:0 sc1
    v_max3_f32 v45, v114, v115, v45
    v_max3_f32 v45, v116, v117, v45
    v_max3_f32 v45, v118, v119, v45
    v_max3_f32 v45, v120, v121, v45
    v_max3_f32 v45, v122, v123, v45
    v_max3_f32 v45, v124, v125, v45
    v_max3_f32 v45, v126, v127, v45
    v_max3_f32 v45, v96, v97, v45
    v_max3_f32 v45, v98, v99, v45
    v_max3_f32 v45, v100, v101, v45
    v_max3_f32 v45, v102, v103, v45
    v_max3_f32 v45, v104, v105, v45
    v_max3_f32 v45, v106, v107, v45
    v_max3_f32 v45, v108, v109, v45
    v_max3_f32 v45, v110, v111, v45
    v_mfma_f32_32x32x16_bf16 v[96:111], v[76:79], v[52:55], 0
    s_add_u32 s15, s14, 0
    buffer_load_dwordx4 v[192:195], v1, s[4:7], s15 offen offset:0
    v_max3_f32 v45, v128, v129, v45
    v_max3_f32 v45, v130, v131, v45
    v_max3_f32 v45, v132, v133, v45
    v_max3_f32 v45, v134, v135, v45
    v_max3_f32 v45, v136, v137, v45
    v_max3_f32 v45, v138, v139, v45
    v_max3_f32 v45, v140, v141, v45
    v_max3_f32 v45, v142, v143, v45
    v_mfma_f32_32x32x16_bf16 v[128:143], a[240:243], v[52:55], 0
    buffer_load_dwordx4 v[196:199], v1, s[4:7], s15 offen offset:1024
    v_max3_f32 v45, v144, v145, v45
    v_max3_f32 v45, v146, v147, v45
    v_max3_f32 v45, v148, v149, v45
    v_max3_f32 v45, v150, v151, v45
    v_max3_f32 v45, v152, v153, v45
    v_max3_f32 v45, v154, v155, v45
    v_max3_f32 v45, v156, v157, v45
    v_max3_f32 v45, v158, v159, v45
    v_mfma_f32_32x32x16_bf16 v[144:159], a[244:247], v[52:55], 0
    s_add_u32 s15, s14, 4096
    buffer_load_dwordx4 v[200:203], v1, s[4:7], s15 offen offset:0
    v_max3_f32 v45, v80, v81, v45
    v_max3_f32 v45, v82, v83, v45
    v_max3_f32 v45, v84, v85, v45
    v_max3_f32 v45, v86, v87, v45
    v_max3_f32 v45, v88, v89, v45
    v_max3_f32 v45, v90, v91, v45
    v_max3_f32 v45, v92, v93, v45
    v_max3_f32 v45, v94, v95, v45
    v_max3_f32 v45, v96, v97, v45
    v_max3_f32 v45, v98, v99, v45
    v_max3_f32 v45, v100, v101, v45
    v_max3_f32 v45, v102, v103, v45
    v_max3_f32 v45, v104, v105, v45
    v_max3_f32 v45, v106, v107, v45
    v_max3_f32 v45, v108, v109, v45
    v_max3_f32 v45, v110, v111, v45
    buffer_load_dwordx4 v[204:207], v1, s[4:7], s15 offen offset:1024
    v_max3_f32 v45, v128, v129, v45
    v_max3_f32 v45, v130, v131, v45
    v_max3_f32 v45, v132, v133, v45
    v_max3_f32 v45, v134, v135, v45
    v_max3_f32 v45, v136, v137, v45
    v_max3_f32 v45, v138, v139, v45
    v_max3_f32 v45, v140, v141, v45
    v_max3_f32 v45, v142, v143, v45
    s_add_u32 s15, s14, 8192
    buffer_load_dwordx4 v[208:211], v1, s[4:7], s15 offen offset:0
    v_max3_f32 v45, v144, v145, v45
    v_max3_f32 v45, v146, v147, v45
    v_max3_f32 v45, v148, v149, v45
    v_max3_f32 v45, v150, v151, v45
    v_max3_f32 v45, v152, v153, v45
    v_max3_f32 v45, v154, v155, v45
    v_max3_f32 v45, v156, v157, v45
    v_max3_f32 v45, v158, v159, v45
    buffer_load_dwordx4 v[212:215], v1, s[4:7], s15 offen offset:1024
    v_mov_b32 v128, v45
    ds_read_b128 v[160:163], v42 offset:0
    ds_read_b128 v[164:167], v42 offset:1056
    v_permlane32_swap_b32 v128, v45
    v_max_f32 v45, v128, v45
    v_sub_f32 v128, 0, v45
    v_sub_f32 v129, 0, v45
    v_pk_mov_b32 v[130:131], v[128:129], v[128:129]
    v_pk_mov_b32 v[132:133], v[128:129], v[128:129]
    v_pk_mov_b32 v[134:135], v[128:129], v[128:129]
    v_pk_mov_b32 v[136:137], v[128:129], v[128:129]
    v_pk_mov_b32 v[138:139], v[128:129], v[128:129]
    v_pk_mov_b32 v[140:141], v[128:129], v[128:129]
    v_pk_mov_b32 v[142:143], v[128:129], v[128:129]
    v_pk_add_f32 v[112:113], v[112:113], v[128:129]
    v_pk_add_f32 v[114:115], v[114:115], v[128:129]
    v_pk_add_f32 v[116:117], v[116:117], v[128:129]
    v_pk_add_f32 v[118:119], v[118:119], v[128:129]
    v_pk_add_f32 v[120:121], v[120:121], v[128:129]
    v_pk_add_f32 v[122:123], v[122:123], v[128:129]
    v_pk_add_f32 v[124:125], v[124:125], v[128:129]
    v_pk_add_f32 v[126:127], v[126:127], v[128:129]
    ds_read_b128 v[168:171], v42 offset:33280
    ds_read_b128 v[172:175], v42 offset:34336
    v_mfma_f32_32x32x16_bf16 v[96:111], a[252:255], v[52:55], v[128:143]
    v_exp_f32 v112, v112
    v_exp_f32 v113, v113
    v_exp_f32 v114, v114
    v_cvt_pk_bf16_f32 v112, v112, v113
    s_add_u32 s15, s14, 12288
    buffer_load_dwordx4 v[216:219], v1, s[4:7], s15 offen offset:0
    v_exp_f32 v115, v115
    v_exp_f32 v116, v116
    v_cvt_pk_bf16_f32 v113, v114, v115
    v_exp_f32 v117, v117
    v_exp_f32 v118, v118
    v_cvt_pk_bf16_f32 v114, v116, v117
    v_exp_f32 v119, v119
    v_exp_f32 v120, v120
    v_cvt_pk_bf16_f32 v115, v118, v119
    buffer_load_dwordx4 v[220:223], v1, s[4:7], s15 offen offset:1024
    v_exp_f32 v121, v121
    v_exp_f32 v122, v122
    v_cvt_pk_bf16_f32 v116, v120, v121
    v_exp_f32 v123, v123
    v_exp_f32 v124, v124
    v_cvt_pk_bf16_f32 v117, v122, v123
    v_exp_f32 v125, v125
    v_exp_f32 v126, v126
    v_cvt_pk_bf16_f32 v118, v124, v125
    s_add_u32 s15, s14, 16384
    buffer_load_dwordx4 v[224:227], v1, s[4:7], s15 offen offset:0
    v_exp_f32 v127, v127
    v_and_b32 v120, v32, v112
    v_cvt_pk_bf16_f32 v119, v126, v127
    v_xor_b32 v112, v120, v112
    v_and_b32 v121, v33, v113
    v_xor_b32 v113, v121, v113
    v_and_b32 v122, v34, v114
    v_xor_b32 v114, v122, v114
    v_and_b32 v123, v35, v115
    v_xor_b32 v115, v123, v115
    v_and_b32 v124, v36, v116
    v_xor_b32 v116, v124, v116
    v_and_b32 v125, v37, v117
    v_xor_b32 v117, v125, v117
    v_and_b32 v126, v38, v118
    v_xor_b32 v118, v126, v118
    v_and_b32 v127, v39, v119
    v_xor_b32 v119, v127, v119
    v_mfma_f32_32x32x16_bf16 v[80:95], v[64:67], v[52:55], v[128:143]
    v_exp_f32 v96, v96
    v_exp_f32 v97, v97
    buffer_load_dwordx4 v[228:231], v1, s[4:7], s15 offen offset:1024
    v_exp_f32 v98, v98
    v_cvt_pk_bf16_f32 v152, v96, v97
    s_waitcnt lgkmcnt(0)
    v_mfma_f32_32x32x16_bf16 v[176:191], v[160:163], v[112:115], 0
    v_exp_f32 v99, v99
    v_exp_f32 v100, v100
    v_cvt_pk_bf16_f32 v153, v98, v99
    v_exp_f32 v101, v101
    v_mfma_f32_32x32x16_bf16 v[176:191], v[164:167], v[116:119], v[176:191]
    v_exp_f32 v102, v102
    v_cvt_pk_bf16_f32 v154, v100, v101
    ds_read_b128 v[160:163], v42 offset:4160
    v_exp_f32 v103, v103
    v_exp_f32 v104, v104
    v_cvt_pk_bf16_f32 v155, v102, v103
    v_mfma_f32_32x32x16_bf16 v[176:191], v[168:171], v[120:123], v[176:191]
    s_add_u32 s15, s14, 20480
    buffer_load_dwordx4 v[232:235], v1, s[4:7], s15 offen offset:0
    v_exp_f32 v105, v105
    v_exp_f32 v106, v106
    v_cvt_pk_bf16_f32 v156, v104, v105
    v_exp_f32 v107, v107
    v_mfma_f32_32x32x16_bf16 v[176:191], v[172:175], v[124:127], v[176:191]
    v_exp_f32 v108, v108
    v_cvt_pk_bf16_f32 v157, v106, v107
    v_exp_f32 v109, v109
    buffer_load_dwordx4 v[236:239], v1, s[4:7], s15 offen offset:1024
    v_exp_f32 v110, v110
    v_cvt_pk_bf16_f32 v158, v108, v109
    v_exp_f32 v111, v111
    ds_read_b128 v[164:167], v42 offset:5216
    v_cvt_pk_bf16_f32 v159, v110, v111
    s_waitcnt vmcnt(12)
    s_mov_b64 exec, 1
    buffer_store_dword v11, v9, s[4:7], s38 offen offset:512 sc1
    s_mov_b64 exec, -1
    v_mfma_f32_32x32x16_bf16 v[96:111], v[68:71], v[52:55], v[128:143]
    v_exp_f32 v80, v80
    v_exp_f32 v81, v81
    s_add_u32 s15, s14, 24576
    buffer_load_dwordx4 v[240:243], v1, s[4:7], s15 offen offset:0
    v_exp_f32 v82, v82
    v_cvt_pk_bf16_f32 v144, v80, v81
    v_exp_f32 v83, v83
    v_exp_f32 v84, v84
    v_cvt_pk_bf16_f32 v145, v82, v83
    s_waitcnt lgkmcnt(0)
    v_mfma_f32_32x32x16_bf16 v[176:191], v[160:163], v[152:155], v[176:191]
    v_exp_f32 v85, v85
    v_exp_f32 v86, v86
    v_cvt_pk_bf16_f32 v146, v84, v85
    ds_read_b128 v[168:171], v42 offset:8320
    v_exp_f32 v87, v87
    v_exp_f32 v88, v88
    v_cvt_pk_bf16_f32 v147, v86, v87
    buffer_load_dwordx4 v[244:247], v1, s[4:7], s15 offen offset:1024
    v_exp_f32 v89, v89
    v_exp_f32 v90, v90
    v_cvt_pk_bf16_f32 v148, v88, v89
    v_mfma_f32_32x32x16_bf16 v[176:191], v[164:167], v[156:159], v[176:191]
    v_exp_f32 v91, v91
    v_exp_f32 v92, v92
    v_cvt_pk_bf16_f32 v149, v90, v91
    v_exp_f32 v93, v93
    s_add_u32 s15, s14, 28672
    buffer_load_dwordx4 v[248:251], v1, s[4:7], s15 offen offset:0
    v_exp_f32 v94, v94
    v_cvt_pk_bf16_f32 v150, v92, v93
    v_exp_f32 v95, v95
    ds_read_b128 v[172:175], v42 offset:9376
    v_cvt_pk_bf16_f32 v151, v94, v95
    v_mfma_f32_32x32x16_bf16 v[80:95], v[72:75], v[52:55], v[128:143]
    v_exp_f32 v96, v96
    v_exp_f32 v97, v97
    buffer_load_dwordx4 v[252:255], v1, s[4:7], s15 offen offset:1024
    v_exp_f32 v98, v98
    v_cvt_pk_bf16_f32 v152, v96, v97
    v_exp_f32 v99, v99
    s_add_u32 s62, s14, 0
    buffer_load_dwordx4 v[112:115], v1, s[4:7], s62 offen offset:2048
    v_exp_f32 v100, v100
    v_cvt_pk_bf16_f32 v153, v98, v99
    s_waitcnt lgkmcnt(0)
    v_mfma_f32_32x32x16_bf16 v[176:191], v[168:171], v[144:147], v[176:191]
    v_exp_f32 v101, v101
    v_exp_f32 v102, v102
    v_cvt_pk_bf16_f32 v154, v100, v101
    ds_read_b128 v[160:163], v42 offset:12480
    v_exp_f32 v103, v103
    v_exp_f32 v104, v104
    v_cvt_pk_bf16_f32 v155, v102, v103
    v_exp_f32 v105, v105
    v_exp_f32 v106, v106
    v_cvt_pk_bf16_f32 v156, v104, v105
    v_mfma_f32_32x32x16_bf16 v[176:191], v[172:175], v[148:151], v[176:191]
    v_exp_f32 v107, v107
    buffer_load_dwordx4 v[116:119], v1, s[4:7], s62 offen offset:3072
    v_exp_f32 v108, v108
    v_cvt_pk_bf16_f32 v157, v106, v107
    v_exp_f32 v109, v109
    v_exp_f32 v110, v110
    v_cvt_pk_bf16_f32 v158, v108, v109
    v_exp_f32 v111, v111
    ds_read_b128 v[164:167], v42 offset:13536
    v_cvt_pk_bf16_f32 v159, v110, v111
    v_mfma_f32_32x32x16_bf16 v[96:111], v[76:79], v[52:55], v[128:143]
    v_exp_f32 v80, v80
    v_exp_f32 v81, v81
    v_exp_f32 v82, v82
    v_cvt_pk_bf16_f32 v144, v80, v81
    v_exp_f32 v83, v83
    s_add_u32 s62, s14, 4096
    buffer_load_dwordx4 v[120:123], v1, s[4:7], s62 offen offset:2048
    v_exp_f32 v84, v84
    v_cvt_pk_bf16_f32 v145, v82, v83
    s_waitcnt lgkmcnt(0)
    v_mfma_f32_32x32x16_bf16 v[176:191], v[160:163], v[152:155], v[176:191]
    v_exp_f32 v85, v85
    v_exp_f32 v86, v86
    v_cvt_pk_bf16_f32 v146, v84, v85
    ds_read_b128 v[168:171], v42 offset:16640
    v_exp_f32 v87, v87
    v_exp_f32 v88, v88
    v_cvt_pk_bf16_f32 v147, v86, v87
    v_exp_f32 v89, v89
    v_exp_f32 v90, v90
    v_cvt_pk_bf16_f32 v148, v88, v89
    v_mfma_f32_32x32x16_bf16 v[176:191], v[164:167], v[156:159], v[176:191]
    v_exp_f32 v91, v91
    buffer_load_dwordx4 v[124:127], v1, s[4:7], s62 offen offset:3072
    v_exp_f32 v92, v92
    v_cvt_pk_bf16_f32 v149, v90, v91
    v_exp_f32 v93, v93
    v_exp_f32 v94, v94
    v_cvt_pk_bf16_f32 v150, v92, v93
    v_exp_f32 v95, v95
    ds_read_b128 v[172:175], v42 offset:17696
    v_cvt_pk_bf16_f32 v151, v94, v95
    v_mfma_f32_32x32x16_bf16 v[80:95], a[240:243], v[52:55], v[128:143]
    v_exp_f32 v96, v96
    v_exp_f32 v97, v97
    s_add_u32 s62, s14, 8192
    buffer_load_dwordx4 v[56:59], v1, s[4:7], s62 offen offset:2048
    v_exp_f32 v98, v98
    v_cvt_pk_bf16_f32 v152, v96, v97
    v_exp_f32 v99, v99
    buffer_load_dwordx4 v[60:63], v1, s[4:7], s62 offen offset:3072
    v_exp_f32 v100, v100
    v_cvt_pk_bf16_f32 v153, v98, v99
    s_waitcnt lgkmcnt(0)
    v_mfma_f32_32x32x16_bf16 v[176:191], v[168:171], v[144:147], v[176:191]
    v_exp_f32 v101, v101
    v_exp_f32 v102, v102
    v_cvt_pk_bf16_f32 v154, v100, v101
    ds_read_b128 v[160:163], v42 offset:20800
    v_exp_f32 v103, v103
    s_add_u32 s62, s14, 12288
    buffer_load_dwordx4 v[64:67], v1, s[4:7], s62 offen offset:2048
    v_exp_f32 v104, v104
    v_cvt_pk_bf16_f32 v155, v102, v103
    v_exp_f32 v105, v105
    buffer_load_dwordx4 v[68:71], v1, s[4:7], s62 offen offset:3072
    v_exp_f32 v106, v106
    v_cvt_pk_bf16_f32 v156, v104, v105
    v_mfma_f32_32x32x16_bf16 v[176:191], v[172:175], v[148:151], v[176:191]
    v_exp_f32 v107, v107
    v_exp_f32 v108, v108
    v_cvt_pk_bf16_f32 v157, v106, v107
    v_exp_f32 v109, v109
    v_exp_f32 v110, v110
    v_cvt_pk_bf16_f32 v158, v108, v109
    v_exp_f32 v111, v111
    ds_read_b128 v[164:167], v42 offset:21856
    v_cvt_pk_bf16_f32 v159, v110, v111
    v_mfma_f32_32x32x16_bf16 v[96:111], a[244:247], v[52:55], v[128:143]
    v_exp_f32 v80, v80
    v_exp_f32 v81, v81
    s_add_u32 s62, s14, 16384
    buffer_load_dwordx4 v[72:75], v1, s[4:7], s62 offen offset:2048
    v_exp_f32 v82, v82
    v_cvt_pk_bf16_f32 v144, v80, v81
    v_exp_f32 v83, v83
    buffer_load_dwordx4 v[76:79], v1, s[4:7], s62 offen offset:3072
    v_exp_f32 v84, v84
    v_cvt_pk_bf16_f32 v145, v82, v83
    s_waitcnt lgkmcnt(0)
    v_mfma_f32_32x32x16_bf16 v[176:191], v[160:163], v[152:155], v[176:191]
    v_exp_f32 v85, v85
    v_exp_f32 v86, v86
    v_cvt_pk_bf16_f32 v146, v84, v85
    ds_read_b128 v[168:171], v42 offset:24960
    v_exp_f32 v87, v87
    v_exp_f32 v88, v88
    v_cvt_pk_bf16_f32 v147, v86, v87
    v_exp_f32 v89, v89
    v_exp_f32 v90, v90
    v_cvt_pk_bf16_f32 v148, v88, v89
    v_mfma_f32_32x32x16_bf16 v[176:191], v[164:167], v[156:159], v[176:191]
    v_exp_f32 v91, v91
    v_exp_f32 v92, v92
    v_cvt_pk_bf16_f32 v149, v90, v91
    v_exp_f32 v93, v93
    v_exp_f32 v94, v94
    v_cvt_pk_bf16_f32 v150, v92, v93
    v_exp_f32 v95, v95
    ds_read_b128 v[172:175], v42 offset:26016
    v_cvt_pk_bf16_f32 v151, v94, v95
    v_exp_f32 v96, v96
    v_exp_f32 v97, v97
    s_add_u32 s62, s14, 20480
    buffer_load_dwordx4 v[80:83], v1, s[4:7], s62 offen offset:2048
    v_exp_f32 v98, v98
    v_cvt_pk_bf16_f32 v152, v96, v97
    v_exp_f32 v99, v99
    buffer_load_dwordx4 v[84:87], v1, s[4:7], s62 offen offset:3072
    v_exp_f32 v100, v100
    v_cvt_pk_bf16_f32 v153, v98, v99
    s_waitcnt lgkmcnt(0)
    v_mfma_f32_32x32x16_bf16 v[176:191], v[168:171], v[144:147], v[176:191]
    v_exp_f32 v101, v101
    v_exp_f32 v102, v102
    v_cvt_pk_bf16_f32 v154, v100, v101
    ds_read_b128 v[160:163], v42 offset:29120
    ds_read_b128 v[164:167], v42 offset:30176
    v_exp_f32 v103, v103
    s_add_u32 s62, s14, 24576
    buffer_load_dwordx4 v[88:91], v1, s[4:7], s62 offen offset:2048
    v_exp_f32 v104, v104
    v_cvt_pk_bf16_f32 v155, v102, v103
    v_exp_f32 v105, v105
    buffer_load_dwordx4 v[92:95], v1, s[4:7], s62 offen offset:3072
    v_exp_f32 v106, v106
    v_cvt_pk_bf16_f32 v156, v104, v105
    v_mfma_f32_32x32x16_bf16 v[176:191], v[172:175], v[148:151], v[176:191]
    v_exp_f32 v107, v107
    v_exp_f32 v108, v108
    v_cvt_pk_bf16_f32 v157, v106, v107
    s_add_u32 s62, s14, 28672
    buffer_load_dwordx4 v[128:131], v1, s[4:7], s62 offen offset:2048
    v_exp_f32 v109, v109
    s_waitcnt lgkmcnt(0)
    v_mfma_f32_32x32x16_bf16 v[176:191], v[160:163], v[152:155], v[176:191]
    v_exp_f32 v110, v110
    v_cvt_pk_bf16_f32 v158, v108, v109
    buffer_load_dwordx4 v[132:135], v1, s[4:7], s62 offen offset:3072
    v_exp_f32 v111, v111
    s_nop 0
    v_cvt_pk_bf16_f32 v159, v110, v111
    s_nop 1
    v_mfma_f32_32x32x16_bf16 v[176:191], v[164:167], v[156:159], v[176:191]
    s_lshr_b32 s30, s20, 1
    s_add_u32 s30, s30, s29
    s_lshl_b32 s30, s30, 15
    s_and_b32 s31, s20, 1
    s_lshl_b32 s31, s31, 14
    s_add_u32 s30, s30, s31
    s_add_u32 s30, s30, 19922944
    v_add_u32 v15, s30, v1
    s_mov_b32 s31, 4096
    s_mov_b32 s32, 8192
    s_mov_b32 s33, 12288
    buffer_load_dword v46, v10, s[4:7], s27 offen offset:512 sc1
    v_rcp_f32 v184, v184
    s_nop 0
    v_mul_f32 v176, v176, v184
    v_mul_f32 v177, v177, v184
    v_mul_f32 v178, v178, v184
    v_mul_f32 v179, v179, v184
    v_mul_f32 v180, v180, v184
    v_mul_f32 v181, v181, v184
    v_mul_f32 v182, v182, v184
    v_mul_f32 v183, v183, v184
    v_cvt_pk_bf16_f32 v188, v176, v177
    v_cvt_pk_bf16_f32 v189, v178, v179
    v_cvt_pk_bf16_f32 v190, v180, v181
    v_cvt_pk_bf16_f32 v191, v182, v183
    buffer_store_dwordx4 v[188:191], v1, s[4:7], s96 offen offset:1024 sc1
    s_waitcnt vmcnt(1)
    v_cmp_ne_u32 vcc, v11, v46
    s_nop 0
    s_and_b64 vcc, vcc, s[60:61]
    s_cbranch_scc0 S_47
    s_mov_b64 exec, s[60:61]
    buffer_load_dword v45, v10, s[4:7], s27 offen offset:512 sc1
    s_waitcnt vmcnt(0)
    v_cmp_ne_u32 vcc, v11, v45
    s_mov_b64 exec, 1
    buffer_store_dword v11, v9, s[4:7], s38 offen offset:768 sc1
    s_mov_b64 exec, -1
    s_cbranch_vccz S_48
    s_mov_b64 exec, s[60:61]
S_49:
    buffer_load_dword v45, v10, s[4:7], s27 offen offset:512 sc1
    s_waitcnt vmcnt(0)
    v_cmp_ne_u32 vcc, v11, v45
    s_nop 0
    s_cbranch_vccz S_48
    s_add_u32 s39, s39, 1
    s_cmp_lt_u32 s39, 200000
    s_cbranch_scc1 S_49
S_48:
    s_mov_b64 exec, -1
S_47:
    buffer_load_dwordx4 v[96:99], v15, s[4:7], 0 offen offset:0 sc1
    buffer_load_dwordx4 v[100:103], v15, s[4:7], 0 offen offset:2048 sc1
    buffer_load_dwordx4 v[104:107], v15, s[4:7], s31 offen offset:0 sc1
    buffer_load_dwordx4 v[108:111], v15, s[4:7], s31 offen offset:2048 sc1
    buffer_load_dwordx4 v[136:139], v15, s[4:7], s32 offen offset:0 sc1
    buffer_load_dwordx4 v[140:143], v15, s[4:7], s32 offen offset:2048 sc1
    buffer_load_dwordx4 v[144:147], v15, s[4:7], s33 offen offset:0 sc1
    buffer_load_dwordx4 v[148:151], v15, s[4:7], s33 offen offset:2048 sc1
    s_waitcnt vmcnt(8)
    s_mov_b64 exec, 1
    buffer_store_dword v11, v9, s[4:7], s38 offen offset:768 sc1
    s_mov_b64 exec, -1
    s_mov_b64 exec, s[60:61]
S_51:
    buffer_load_dword v45, v10, s[4:7], s27 offen offset:768 sc1
    s_waitcnt vmcnt(0)
    v_cmp_ne_u32 vcc, v11, v45
    s_nop 0
    s_cbranch_vccz S_50
    s_add_u32 s39, s39, 1
    s_cmp_lt_u32 s39, 200000
    s_cbranch_scc1 S_51
S_50:
    s_mov_b64 exec, -1
    buffer_load_dwordx4 v[152:155], v15, s[4:7], 0 offen offset:1024 sc1
    buffer_load_dwordx4 v[156:159], v15, s[4:7], 0 offen offset:3072 sc1
    buffer_load_dwordx4 v[48:51], v15, s[4:7], s31 offen offset:1024 sc1
    buffer_load_dwordx4 v[52:55], v15, s[4:7], s31 offen offset:3072 sc1
    buffer_load_dwordx4 a[240:243], v15, s[4:7], s32 offen offset:1024 sc1
    buffer_load_dwordx4 a[244:247], v15, s[4:7], s32 offen offset:3072 sc1
    buffer_load_dwordx4 a[248:251], v15, s[4:7], s33 offen offset:1024 sc1
    buffer_load_dwordx4 a[252:255], v15, s[4:7], s33 offen offset:3072 sc1
    s_barrier
    v_mfma_f32_32x32x16_bf16 v[160:175], v[192:195], v[96:99], 0
    v_mfma_f32_32x32x16_bf16 v[176:191], v[196:199], v[96:99], 0
    v_mfma_f32_32x32x16_bf16 v[160:175], v[200:203], v[100:103], v[160:175]
    v_mfma_f32_32x32x16_bf16 v[176:191], v[204:207], v[100:103], v[176:191]
    v_mfma_f32_32x32x16_bf16 v[160:175], v[208:211], v[104:107], v[160:175]
    v_mfma_f32_32x32x16_bf16 v[176:191], v[212:215], v[104:107], v[176:191]
    v_mfma_f32_32x32x16_bf16 v[160:175], v[216:219], v[108:111], v[160:175]
    v_mfma_f32_32x32x16_bf16 v[176:191], v[220:223], v[108:111], v[176:191]
    v_mfma_f32_32x32x16_bf16 v[160:175], v[224:227], v[136:139], v[160:175]
    v_mfma_f32_32x32x16_bf16 v[176:191], v[228:231], v[136:139], v[176:191]
    v_mfma_f32_32x32x16_bf16 v[160:175], v[232:235], v[140:143], v[160:175]
    v_mfma_f32_32x32x16_bf16 v[176:191], v[236:239], v[140:143], v[176:191]
    v_mfma_f32_32x32x16_bf16 v[160:175], v[240:243], v[144:147], v[160:175]
    v_mfma_f32_32x32x16_bf16 v[176:191], v[244:247], v[144:147], v[176:191]
    v_mfma_f32_32x32x16_bf16 v[160:175], v[248:251], v[148:151], v[160:175]
    v_mfma_f32_32x32x16_bf16 v[176:191], v[252:255], v[148:151], v[176:191]
    s_mul_i32 s100, s20, 4096
    s_add_u32 m0, s100, 98304
    s_mul_i32 s101, s22, 114688
    s_add_u32 s101, s101, s100
    s_add_u32 s101, s101, 3506176
    buffer_load_dwordx4 v1, s[4:7], s101 offen offset:0 lds
    buffer_load_dwordx4 v1, s[4:7], s101 offen offset:1024 lds
    buffer_load_dwordx4 v1, s[4:7], s101 offen offset:2048 lds
    buffer_load_dwordx4 v1, s[4:7], s101 offen offset:3072 lds
    s_waitcnt vmcnt(11)
    v_mfma_f32_32x32x16_bf16 v[160:175], v[112:115], v[152:155], v[160:175]
    v_mfma_f32_32x32x16_bf16 v[176:191], v[116:119], v[152:155], v[176:191]
    s_waitcnt vmcnt(10)
    v_mfma_f32_32x32x16_bf16 v[160:175], v[120:123], v[156:159], v[160:175]
    v_mfma_f32_32x32x16_bf16 v[176:191], v[124:127], v[156:159], v[176:191]
    s_waitcnt vmcnt(9)
    v_mfma_f32_32x32x16_bf16 v[160:175], v[56:59], v[48:51], v[160:175]
    v_mfma_f32_32x32x16_bf16 v[176:191], v[60:63], v[48:51], v[176:191]
    s_waitcnt vmcnt(8)
    v_mfma_f32_32x32x16_bf16 v[160:175], v[64:67], v[52:55], v[160:175]
    v_mfma_f32_32x32x16_bf16 v[176:191], v[68:71], v[52:55], v[176:191]
    s_waitcnt vmcnt(7)
    v_mfma_f32_32x32x16_bf16 v[160:175], v[72:75], a[240:243], v[160:175]
    v_mfma_f32_32x32x16_bf16 v[176:191], v[76:79], a[240:243], v[176:191]
    s_waitcnt vmcnt(6)
    v_mfma_f32_32x32x16_bf16 v[160:175], v[80:83], a[244:247], v[160:175]
    v_mfma_f32_32x32x16_bf16 v[176:191], v[84:87], a[244:247], v[176:191]
    s_waitcnt vmcnt(5)
    v_mfma_f32_32x32x16_bf16 v[160:175], v[88:91], a[248:251], v[160:175]
    v_mfma_f32_32x32x16_bf16 v[176:191], v[92:95], a[248:251], v[176:191]
    s_waitcnt vmcnt(4)
    v_mfma_f32_32x32x16_bf16 v[160:175], v[128:131], a[252:255], v[160:175]
    v_mfma_f32_32x32x16_bf16 v[176:191], v[132:135], a[252:255], v[176:191]
    s_lshl_b32 s31, s28, 15
    s_add_u32 s30, s31, 16777216
    v_add_u32 v15, s30, v1
    s_nop 7
    ds_write_b128 v12, v[160:163] offset:0
    ds_write_b128 v12, v[164:167] offset:32
    ds_write_b128 v12, v[168:171] offset:64
    ds_write_b128 v12, v[172:175] offset:96
    ds_write_b128 v12, v[176:179] offset:128
    ds_write_b128 v12, v[180:183] offset:160
    ds_write_b128 v12, v[184:187] offset:192
    ds_write_b128 v12, v[188:191] offset:224
    s_waitcnt lgkmcnt(0)
    s_barrier
    ds_read_b128 v[48:51], v13 offset:0
    ds_read_b128 v[52:55], v13 offset:16
    ds_read_b128 v[56:59], v13 offset:8704
    ds_read_b128 v[60:63], v13 offset:8720
    ds_read_b128 v[64:67], v13 offset:17408
    ds_read_b128 v[68:71], v13 offset:17424
    ds_read_b128 v[72:75], v13 offset:26112
    ds_read_b128 v[76:79], v13 offset:26128
    s_waitcnt lgkmcnt(4)
    v_pk_add_f32 v[16:17], v[16:17], v[48:49]
    v_pk_add_f32 v[18:19], v[18:19], v[50:51]
    v_pk_add_f32 v[20:21], v[20:21], v[52:53]
    v_pk_add_f32 v[22:23], v[22:23], v[54:55]
    v_pk_add_f32 v[16:17], v[16:17], v[56:57]
    v_pk_add_f32 v[18:19], v[18:19], v[58:59]
    v_pk_add_f32 v[20:21], v[20:21], v[60:61]
    v_pk_add_f32 v[22:23], v[22:23], v[62:63]
    v_cvt_pk_bf16_f32 v112, v16, v17
    v_cvt_pk_bf16_f32 v113, v18, v19
    v_cvt_pk_bf16_f32 v114, v20, v21
    v_cvt_pk_bf16_f32 v115, v22, v23
    buffer_store_dwordx4 v[112:115], v5, s[4:7], 0 offen sc1
    s_waitcnt lgkmcnt(0)
    v_pk_add_f32 v[24:25], v[24:25], v[64:65]
    v_pk_add_f32 v[26:27], v[26:27], v[66:67]
    v_pk_add_f32 v[28:29], v[28:29], v[68:69]
    v_pk_add_f32 v[30:31], v[30:31], v[70:71]
    v_pk_add_f32 v[24:25], v[24:25], v[72:73]
    v_pk_add_f32 v[26:27], v[26:27], v[74:75]
    v_pk_add_f32 v[28:29], v[28:29], v[76:77]
    v_pk_add_f32 v[30:31], v[30:31], v[78:79]
    v_cvt_pk_bf16_f32 v120, v24, v25
    v_cvt_pk_bf16_f32 v121, v26, v27
    v_cvt_pk_bf16_f32 v122, v28, v29
    v_cvt_pk_bf16_f32 v123, v30, v31
    buffer_store_dwordx4 v[120:123], v5, s[4:7], s63 offen sc1
    v_pk_add_f32 v[116:117], v[16:17], v[18:19]
    v_pk_add_f32 v[124:125], v[24:25], v[26:27]
    v_pk_mul_f32 v[118:119], v[16:17], v[16:17]
    v_pk_mul_f32 v[126:127], v[24:25], v[24:25]
    v_pk_fma_f32 v[118:119], v[18:19], v[18:19], v[118:119]
    v_pk_fma_f32 v[126:127], v[26:27], v[26:27], v[126:127]
    v_pk_add_f32 v[116:117], v[116:117], v[20:21]
    v_pk_add_f32 v[124:125], v[124:125], v[28:29]
    v_pk_fma_f32 v[118:119], v[20:21], v[20:21], v[118:119]
    v_pk_fma_f32 v[126:127], v[28:29], v[28:29], v[126:127]
    v_pk_add_f32 v[116:117], v[116:117], v[22:23]
    v_pk_add_f32 v[124:125], v[124:125], v[30:31]
    v_pk_fma_f32 v[118:119], v[22:23], v[22:23], v[118:119]
    v_pk_fma_f32 v[126:127], v[30:31], v[30:31], v[126:127]
    v_add_f32 v116, v116, v117
    v_add_f32 v124, v124, v125
    v_add_f32 v118, v118, v119
    v_add_f32 v126, v126, v127
    s_nop 0
    v_permlane16_swap_b32 v116, v118
    v_permlane16_swap_b32 v124, v126
    v_add_f32 v116, v116, v118
    v_add_f32 v124, v124, v126
    s_nop 0
    v_add_f32_dpp v116, v116, v116 row_ror:8 row_mask:0xf bank_mask:0xf
    v_add_f32_dpp v124, v124, v124 row_ror:8 row_mask:0xf bank_mask:0xf
    v_mov_b32 v118, v116
    v_mov_b32 v126, v124
    s_nop 0
    v_permlane32_swap_b32 v116, v118
    v_permlane32_swap_b32 v124, v126
    v_add_f32 v116, v116, v118
    v_add_f32 v124, v124, v126
    s_mov_b64 exec, 0xff00ff
    buffer_store_dword v116, v7, s[4:7], 0 offen offset:0 sc1
    s_mov_b64 exec, -1
    s_mov_b64 exec, 0xff00ff
    buffer_store_dword v124, v7, s[4:7], 0 offen offset:2048 sc1
    s_mov_b64 exec, -1
    s_waitcnt vmcnt(0)
    s_mov_b32 exec_lo, 1
    s_mov_b32 exec_hi, 1
    buffer_store_dword v11, v10, s[4:7], s0 offen offset:1024 sc1
    s_mov_b64 exec, -1
    s_barrier
    s_mov_b64 exec, 0xffffffff
S_53:
    buffer_load_dword v45, v10, s[4:7], s34 offen offset:1024 sc1
    s_waitcnt vmcnt(0)
    v_cmp_ne_u32 vcc, v11, v45
    s_nop 0
    s_cbranch_vccz S_52
    s_add_u32 s39, s39, 1
    s_cmp_lt_u32 s39, 200000
    s_cbranch_scc1 S_53
S_52:
    s_mov_b64 exec, -1
    buffer_load_dwordx4 v[48:51], v15, s[4:7], s40 offen offset:0 sc1
    buffer_load_dwordx4 v[52:55], v15, s[4:7], s40 offen offset:1024 sc1
    buffer_load_dwordx4 v[56:59], v15, s[4:7], s40 offen offset:2048 sc1
    buffer_load_dwordx4 v[60:63], v15, s[4:7], s40 offen offset:3072 sc1
    buffer_load_dwordx2 v[240:241], v8, s[4:7], 0 offen offset:0 sc1
    buffer_load_dwordx2 v[242:243], v8, s[4:7], 0 offen offset:256 sc1
    buffer_load_dwordx2 v[244:245], v8, s[4:7], 0 offen offset:512 sc1
    buffer_load_dwordx2 v[246:247], v8, s[4:7], 0 offen offset:768 sc1
    buffer_load_dwordx4 v[64:67], v15, s[4:7], s41 offen offset:0 sc1
    buffer_load_dwordx4 v[68:71], v15, s[4:7], s41 offen offset:1024 sc1
    buffer_load_dwordx4 v[72:75], v15, s[4:7], s41 offen offset:2048 sc1
    buffer_load_dwordx4 v[76:79], v15, s[4:7], s41 offen offset:3072 sc1
    buffer_load_dwordx4 v[80:83], v15, s[4:7], s42 offen offset:0 sc1
    buffer_load_dwordx4 v[84:87], v15, s[4:7], s42 offen offset:1024 sc1
    v_mad_u32_u24 v46, s48, 7, v6
    ds_read_b128 v[160:163], v46 offset:0
    ds_read_b128 v[164:167], v46 offset:1024
    ds_read_b128 v[168:171], v46 offset:2048
    ds_read_b128 v[172:175], v46 offset:3584
    ds_read_b128 v[176:179], v46 offset:4608
    ds_read_b128 v[180:183], v46 offset:5632
    s_waitcnt vmcnt(13) lgkmcnt(3)
    v_mfma_f32_32x32x16_bf16 v[192:207], v[160:163], v[48:51], 0
    ds_read_b128 v[184:187], v46 offset:7168
    v_mfma_f32_32x32x16_bf16 v[208:223], v[164:167], v[48:51], 0
    ds_read_b128 v[188:191], v46 offset:8192
    buffer_load_dwordx4 v[88:91], v15, s[4:7], s42 offen offset:2048 sc1
    v_mfma_f32_32x32x16_bf16 v[224:239], v[168:171], v[48:51], 0
    ds_read_b128 v[160:163], v46 offset:9216
    s_waitcnt vmcnt(13) lgkmcnt(3)
    v_mfma_f32_32x32x16_bf16 v[192:207], v[172:175], v[52:55], v[192:207]
    ds_read_b128 v[164:167], v46 offset:10752
    v_mfma_f32_32x32x16_bf16 v[208:223], v[176:179], v[52:55], v[208:223]
    ds_read_b128 v[168:171], v46 offset:11776
    buffer_load_dwordx4 v[92:95], v15, s[4:7], s42 offen offset:3072 sc1
    v_mfma_f32_32x32x16_bf16 v[224:239], v[180:183], v[52:55], v[224:239]
    ds_read_b128 v[172:175], v46 offset:12800
    s_waitcnt vmcnt(13) lgkmcnt(3)
    v_mfma_f32_32x32x16_bf16 v[192:207], v[184:187], v[56:59], v[192:207]
    v_mad_u32_u24 v47, s49, 7, v6
    ds_read_b128 v[176:179], v47 offset:0
    v_mfma_f32_32x32x16_bf16 v[208:223], v[188:191], v[56:59], v[208:223]
    ds_read_b128 v[180:183], v47 offset:1024
    buffer_load_dwordx4 v[96:99], v15, s[4:7], s43 offen offset:0 sc1
    v_mfma_f32_32x32x16_bf16 v[224:239], v[160:163], v[56:59], v[224:239]
    ds_read_b128 v[184:187], v47 offset:2048
    s_waitcnt vmcnt(13) lgkmcnt(3)
    v_mfma_f32_32x32x16_bf16 v[192:207], v[164:167], v[60:63], v[192:207]
    ds_read_b128 v[188:191], v47 offset:3584
    v_mfma_f32_32x32x16_bf16 v[208:223], v[168:171], v[60:63], v[208:223]
    ds_read_b128 v[160:163], v47 offset:4608
    buffer_load_dwordx4 v[100:103], v15, s[4:7], s43 offen offset:1024 sc1
    v_mfma_f32_32x32x16_bf16 v[224:239], v[172:175], v[60:63], v[224:239]
    ds_read_b128 v[164:167], v47 offset:5632
    s_waitcnt vmcnt(9) lgkmcnt(3)
    v_mfma_f32_32x32x16_bf16 v[192:207], v[176:179], v[64:67], v[192:207]
    ds_read_b128 v[168:171], v47 offset:7168
    v_mfma_f32_32x32x16_bf16 v[208:223], v[180:183], v[64:67], v[208:223]
    ds_read_b128 v[172:175], v47 offset:8192
    buffer_load_dwordx4 v[104:107], v15, s[4:7], s43 offen offset:2048 sc1
    v_add_f32 v240, v240, v242
    v_mfma_f32_32x32x16_bf16 v[224:239], v[184:187], v[64:67], v[224:239]
    ds_read_b128 v[176:179], v47 offset:9216
    v_add_f32 v244, v244, v246
    s_waitcnt vmcnt(9) lgkmcnt(3)
    v_mfma_f32_32x32x16_bf16 v[192:207], v[188:191], v[68:71], v[192:207]
    ds_read_b128 v[180:183], v47 offset:10752
    v_add_f32 v241, v241, v243
    v_mfma_f32_32x32x16_bf16 v[208:223], v[160:163], v[68:71], v[208:223]
    ds_read_b128 v[184:187], v47 offset:11776
    buffer_load_dwordx4 v[108:111], v15, s[4:7], s43 offen offset:3072 sc1
    v_add_f32 v245, v245, v247
    v_mfma_f32_32x32x16_bf16 v[224:239], v[164:167], v[68:71], v[224:239]
    ds_read_b128 v[188:191], v47 offset:12800
    v_add_f32 v240, v240, v244
    s_waitcnt vmcnt(9) lgkmcnt(3)
    v_mfma_f32_32x32x16_bf16 v[192:207], v[168:171], v[72:75], v[192:207]
    v_mad_u32_u24 v46, s50, 7, v6
    ds_read_b128 v[160:163], v46 offset:0
    v_add_f32 v241, v241, v245
    v_mfma_f32_32x32x16_bf16 v[208:223], v[172:175], v[72:75], v[208:223]
    ds_read_b128 v[164:167], v46 offset:1024
    buffer_load_dwordx4 v[112:115], v15, s[4:7], s44 offen offset:0 sc1
    v_mov_b32 v242, v240
    v_mfma_f32_32x32x16_bf16 v[224:239], v[176:179], v[72:75], v[224:239]
    ds_read_b128 v[168:171], v46 offset:2048
    v_mov_b32 v243, v241
    s_waitcnt vmcnt(9) lgkmcnt(3)
    v_mfma_f32_32x32x16_bf16 v[192:207], v[180:183], v[76:79], v[192:207]
    ds_read_b128 v[172:175], v46 offset:3584
    v_mov_b32 v250, 0
    v_mfma_f32_32x32x16_bf16 v[208:223], v[184:187], v[76:79], v[208:223]
    ds_read_b128 v[176:179], v46 offset:4608
    buffer_load_dwordx4 v[116:119], v15, s[4:7], s44 offen offset:1024 sc1
    v_permlane32_swap_b32 v240, v242
    v_mfma_f32_32x32x16_bf16 v[224:239], v[188:191], v[76:79], v[224:239]
    ds_read_b128 v[180:183], v46 offset:5632
    v_permlane32_swap_b32 v241, v243
    s_waitcnt vmcnt(9) lgkmcnt(3)
    v_mfma_f32_32x32x16_bf16 v[192:207], v[160:163], v[80:83], v[192:207]
    ds_read_b128 v[184:187], v46 offset:7168
    v_add_f32 v240, v240, v242
    v_mfma_f32_32x32x16_bf16 v[208:223], v[164:167], v[80:83], v[208:223]
    ds_read_b128 v[188:191], v46 offset:8192
    buffer_load_dwordx4 v[120:123], v15, s[4:7], s44 offen offset:2048 sc1
    v_add_f32 v241, v241, v243
    v_mfma_f32_32x32x16_bf16 v[224:239], v[168:171], v[80:83], v[224:239]
    ds_read_b128 v[160:163], v46 offset:9216
    v_mul_f32 v240, 0xbb000000, v240
    s_waitcnt vmcnt(9) lgkmcnt(3)
    v_mfma_f32_32x32x16_bf16 v[192:207], v[172:175], v[84:87], v[192:207]
    ds_read_b128 v[164:167], v46 offset:10752
    v_mul_f32 v241, 0x3b000000, v241
    v_mfma_f32_32x32x16_bf16 v[208:223], v[176:179], v[84:87], v[208:223]
    ds_read_b128 v[168:171], v46 offset:11776
    buffer_load_dwordx4 v[124:127], v15, s[4:7], s44 offen offset:3072 sc1
    v_fma_f32 v241, -v240, v240, v241
    v_mfma_f32_32x32x16_bf16 v[224:239], v[180:183], v[84:87], v[224:239]
    ds_read_b128 v[172:175], v46 offset:12800
    v_max_f32 v241, 0, v241
    s_waitcnt vmcnt(9) lgkmcnt(3)
    v_mfma_f32_32x32x16_bf16 v[192:207], v[184:187], v[88:91], v[192:207]
    v_mad_u32_u24 v47, s51, 7, v6
    ds_read_b128 v[176:179], v47 offset:0
    v_add_f32 v241, 0x3727c5ac, v241
    v_mfma_f32_32x32x16_bf16 v[208:223], v[188:191], v[88:91], v[208:223]
    ds_read_b128 v[180:183], v47 offset:1024
    buffer_load_dwordx4 v[128:131], v15, s[4:7], s45 offen offset:0 sc1
    v_rsq_f32 v252, v241
    v_mfma_f32_32x32x16_bf16 v[224:239], v[160:163], v[88:91], v[224:239]
    ds_read_b128 v[184:187], v47 offset:2048
    v_cvt_pk_bf16_f32 v242, v240, v240
    s_waitcnt vmcnt(9) lgkmcnt(3)
    v_mfma_f32_32x32x16_bf16 v[192:207], v[164:167], v[92:95], v[192:207]
    ds_read_b128 v[188:191], v47 offset:3584
    v_and_b32 v243, 0xffff0000, v242
    v_mfma_f32_32x32x16_bf16 v[208:223], v[168:171], v[92:95], v[208:223]
    ds_read_b128 v[160:163], v47 offset:4608
    buffer_load_dwordx4 v[132:135], v15, s[4:7], s45 offen offset:1024 sc1
    v_sub_f32 v243, v240, v243
    v_mfma_f32_32x32x16_bf16 v[224:239], v[172:175], v[92:95], v[224:239]
    ds_read_b128 v[164:167], v47 offset:5632
    v_lshrrev_b32 v249, 5, v0
    s_waitcnt vmcnt(9) lgkmcnt(3)
    v_mfma_f32_32x32x16_bf16 v[192:207], v[176:179], v[96:99], v[192:207]
    ds_read_b128 v[168:171], v47 offset:7168
    v_add_u32 v249, -1, v249
    v_mfma_f32_32x32x16_bf16 v[208:223], v[180:183], v[96:99], v[208:223]
    ds_read_b128 v[172:175], v47 offset:8192
    buffer_load_dwordx4 v[136:139], v15, s[4:7], s45 offen offset:2048 sc1
    v_cvt_pk_bf16_f32 v242, v240, v243
    v_mfma_f32_32x32x16_bf16 v[224:239], v[184:187], v[96:99], v[224:239]
    ds_read_b128 v[176:179], v47 offset:9216
    v_mov_b32 v251, 0
    s_waitcnt vmcnt(9) lgkmcnt(3)
    v_mfma_f32_32x32x16_bf16 v[192:207], v[188:191], v[100:103], v[192:207]
    ds_read_b128 v[180:183], v47 offset:10752
    v_mov_b32 v253, v252
    v_mfma_f32_32x32x16_bf16 v[208:223], v[160:163], v[100:103], v[208:223]
    ds_read_b128 v[184:187], v47 offset:11776
    buffer_load_dwordx4 v[140:143], v15, s[4:7], s45 offen offset:3072 sc1
    v_and_b32 v248, v249, v242
    v_mfma_f32_32x32x16_bf16 v[224:239], v[164:167], v[100:103], v[224:239]
    ds_read_b128 v[188:191], v47 offset:12800
    v_mov_b32 v249, v248
    s_waitcnt vmcnt(9) lgkmcnt(3)
    v_mfma_f32_32x32x16_bf16 v[192:207], v[168:171], v[104:107], v[192:207]
    v_mad_u32_u24 v46, s52, 7, v6
    ds_read_b128 v[160:163], v46 offset:0
    v_mul_f32 v254, 0xbfb8aa3b, v252
    v_mfma_f32_32x32x16_bf16 v[208:223], v[172:175], v[104:107], v[208:223]
    ds_read_b128 v[164:167], v46 offset:1024
    buffer_load_dwordx4 v[144:147], v15, s[4:7], s46 offen offset:0 sc1
    v_mov_b32 v255, v254
    v_mfma_f32_32x32x16_bf16 v[224:239], v[176:179], v[104:107], v[224:239]
    ds_read_b128 v[168:171], v46 offset:2048
    s_waitcnt vmcnt(9) lgkmcnt(3)
    v_mfma_f32_32x32x16_bf16 v[192:207], v[180:183], v[108:111], v[192:207]
    ds_read_b128 v[172:175], v46 offset:3584
    v_mfma_f32_32x32x16_bf16 v[208:223], v[184:187], v[108:111], v[208:223]
    ds_read_b128 v[176:179], v46 offset:4608
    buffer_load_dwordx4 v[148:151], v15, s[4:7], s46 offen offset:1024 sc1
    v_mfma_f32_32x32x16_bf16 v[224:239], v[188:191], v[108:111], v[224:239]
    ds_read_b128 v[180:183], v46 offset:5632
    s_waitcnt vmcnt(9) lgkmcnt(3)
    v_mfma_f32_32x32x16_bf16 v[192:207], v[160:163], v[112:115], v[192:207]
    ds_read_b128 v[184:187], v46 offset:7168
    v_mfma_f32_32x32x16_bf16 v[208:223], v[164:167], v[112:115], v[208:223]
    ds_read_b128 v[188:191], v46 offset:8192
    buffer_load_dwordx4 v[152:155], v15, s[4:7], s46 offen offset:2048 sc1
    v_mfma_f32_32x32x16_bf16 v[224:239], v[168:171], v[112:115], v[224:239]
    ds_read_b128 v[160:163], v46 offset:9216
    v_mfma_f32_32x32x16_bf16 v[192:207], a[230:233], v[248:251], v[192:207]
    v_mfma_f32_32x32x16_bf16 v[208:223], a[232:235], v[248:251], v[208:223]
    v_mfma_f32_32x32x16_bf16 v[224:239], a[234:237], v[248:251], v[224:239]
    s_waitcnt vmcnt(9) lgkmcnt(3)
    v_mfma_f32_32x32x16_bf16 v[192:207], v[172:175], v[116:119], v[192:207]
    ds_read_b128 v[164:167], v46 offset:10752
    v_mfma_f32_32x32x16_bf16 v[208:223], v[176:179], v[116:119], v[208:223]
    ds_read_b128 v[168:171], v46 offset:11776
    buffer_load_dwordx4 v[156:159], v15, s[4:7], s46 offen offset:3072 sc1
    v_mfma_f32_32x32x16_bf16 v[224:239], v[180:183], v[116:119], v[224:239]
    ds_read_b128 v[172:175], v46 offset:12800
    s_waitcnt vmcnt(9) lgkmcnt(3)
    v_mfma_f32_32x32x16_bf16 v[192:207], v[184:187], v[120:123], v[192:207]
    v_mad_u32_u24 v47, s53, 7, v6
    ds_read_b128 v[176:179], v47 offset:0
    v_mfma_f32_32x32x16_bf16 v[208:223], v[188:191], v[120:123], v[208:223]
    ds_read_b128 v[180:183], v47 offset:1024
    buffer_load_dwordx4 a[240:243], v15, s[4:7], s47 offen offset:0 sc1
    v_mfma_f32_32x32x16_bf16 v[224:239], v[160:163], v[120:123], v[224:239]
    ds_read_b128 v[184:187], v47 offset:2048
    s_waitcnt vmcnt(9) lgkmcnt(3)
    v_mfma_f32_32x32x16_bf16 v[192:207], v[164:167], v[124:127], v[192:207]
    ds_read_b128 v[188:191], v47 offset:3584
    v_mfma_f32_32x32x16_bf16 v[208:223], v[168:171], v[124:127], v[208:223]
    ds_read_b128 v[160:163], v47 offset:4608
    buffer_load_dwordx4 a[244:247], v15, s[4:7], s47 offen offset:1024 sc1
    v_mfma_f32_32x32x16_bf16 v[224:239], v[172:175], v[124:127], v[224:239]
    ds_read_b128 v[164:167], v47 offset:5632
    s_waitcnt vmcnt(9) lgkmcnt(3)
    v_mfma_f32_32x32x16_bf16 v[192:207], v[176:179], v[128:131], v[192:207]
    ds_read_b128 v[168:171], v47 offset:7168
    v_mfma_f32_32x32x16_bf16 v[208:223], v[180:183], v[128:131], v[208:223]
    ds_read_b128 v[172:175], v47 offset:8192
    buffer_load_dwordx4 a[248:251], v15, s[4:7], s47 offen offset:2048 sc1
    v_mfma_f32_32x32x16_bf16 v[224:239], v[184:187], v[128:131], v[224:239]
    ds_read_b128 v[176:179], v47 offset:9216
    s_waitcnt vmcnt(9) lgkmcnt(3)
    v_mfma_f32_32x32x16_bf16 v[192:207], v[188:191], v[132:135], v[192:207]
    ds_read_b128 v[180:183], v47 offset:10752
    v_mfma_f32_32x32x16_bf16 v[208:223], v[160:163], v[132:135], v[208:223]
    ds_read_b128 v[184:187], v47 offset:11776
    buffer_load_dwordx4 a[252:255], v15, s[4:7], s47 offen offset:3072 sc1
    v_mfma_f32_32x32x16_bf16 v[224:239], v[164:167], v[132:135], v[224:239]
    ds_read_b128 v[188:191], v47 offset:12800
    s_waitcnt vmcnt(9) lgkmcnt(3)
    v_mfma_f32_32x32x16_bf16 v[192:207], v[168:171], v[136:139], v[192:207]
    v_mad_u32_u24 v46, s54, 7, v6
    ds_read_b128 v[160:163], v46 offset:0
    v_mfma_f32_32x32x16_bf16 v[208:223], v[172:175], v[136:139], v[208:223]
    ds_read_b128 v[164:167], v46 offset:1024
    v_mfma_f32_32x32x16_bf16 v[224:239], v[176:179], v[136:139], v[224:239]
    ds_read_b128 v[168:171], v46 offset:2048
    s_waitcnt vmcnt(8) lgkmcnt(3)
    v_mfma_f32_32x32x16_bf16 v[192:207], v[180:183], v[140:143], v[192:207]
    ds_read_b128 v[172:175], v46 offset:3584
    v_mfma_f32_32x32x16_bf16 v[208:223], v[184:187], v[140:143], v[208:223]
    ds_read_b128 v[176:179], v46 offset:4608
    v_mfma_f32_32x32x16_bf16 v[224:239], v[188:191], v[140:143], v[224:239]
    ds_read_b128 v[180:183], v46 offset:5632
    s_waitcnt vmcnt(7) lgkmcnt(3)
    v_mfma_f32_32x32x16_bf16 v[192:207], v[160:163], v[144:147], v[192:207]
    ds_read_b128 v[184:187], v46 offset:7168
    v_mfma_f32_32x32x16_bf16 v[208:223], v[164:167], v[144:147], v[208:223]
    ds_read_b128 v[188:191], v46 offset:8192
    v_mfma_f32_32x32x16_bf16 v[224:239], v[168:171], v[144:147], v[224:239]
    ds_read_b128 v[160:163], v46 offset:9216
    s_mul_i32 s30, s28, 114688
    s_mul_i32 s31, s22, 7168
    s_add_u32 s30, s30, s31
    s_add_u32 s96, s30, 22020096
    s_add_u32 s97, s96, 4096
    s_waitcnt vmcnt(6) lgkmcnt(3)
    v_mfma_f32_32x32x16_bf16 v[192:207], v[172:175], v[148:151], v[192:207]
    ds_read_b128 v[164:167], v46 offset:10752
    v_mfma_f32_32x32x16_bf16 v[208:223], v[176:179], v[148:151], v[208:223]
    ds_read_b128 v[168:171], v46 offset:11776
    v_mfma_f32_32x32x16_bf16 v[224:239], v[180:183], v[148:151], v[224:239]
    ds_read_b128 v[172:175], v46 offset:12800
    s_waitcnt vmcnt(5) lgkmcnt(3)
    v_mfma_f32_32x32x16_bf16 v[192:207], v[184:187], v[152:155], v[192:207]
    v_mad_u32_u24 v47, s55, 7, v6
    ds_read_b128 v[176:179], v47 offset:0
    v_mfma_f32_32x32x16_bf16 v[208:223], v[188:191], v[152:155], v[208:223]
    ds_read_b128 v[180:183], v47 offset:1024
    v_mfma_f32_32x32x16_bf16 v[224:239], v[160:163], v[152:155], v[224:239]
    ds_read_b128 v[184:187], v47 offset:2048
    s_waitcnt vmcnt(4) lgkmcnt(3)
    v_mfma_f32_32x32x16_bf16 v[192:207], v[164:167], v[156:159], v[192:207]
    ds_read_b128 v[188:191], v47 offset:3584
    v_mfma_f32_32x32x16_bf16 v[208:223], v[168:171], v[156:159], v[208:223]
    ds_read_b128 v[160:163], v47 offset:4608
    v_mfma_f32_32x32x16_bf16 v[224:239], v[172:175], v[156:159], v[224:239]
    ds_read_b128 v[164:167], v47 offset:5632
    s_waitcnt vmcnt(3) lgkmcnt(3)
    v_mfma_f32_32x32x16_bf16 v[192:207], v[176:179], a[240:243], v[192:207]
    ds_read_b128 v[168:171], v47 offset:7168
    v_mfma_f32_32x32x16_bf16 v[208:223], v[180:183], a[240:243], v[208:223]
    ds_read_b128 v[172:175], v47 offset:8192
    v_mfma_f32_32x32x16_bf16 v[224:239], v[184:187], a[240:243], v[224:239]
    ds_read_b128 v[176:179], v47 offset:9216
    s_waitcnt vmcnt(2) lgkmcnt(3)
    v_mfma_f32_32x32x16_bf16 v[192:207], v[188:191], a[244:247], v[192:207]
    ds_read_b128 v[180:183], v47 offset:10752
    v_mfma_f32_32x32x16_bf16 v[208:223], v[160:163], a[244:247], v[208:223]
    ds_read_b128 v[184:187], v47 offset:11776
    v_mfma_f32_32x32x16_bf16 v[224:239], v[164:167], a[244:247], v[224:239]
    ds_read_b128 v[188:191], v47 offset:12800
    s_waitcnt vmcnt(1) lgkmcnt(3)
    v_mfma_f32_32x32x16_bf16 v[192:207], v[168:171], a[248:251], v[192:207]
    v_mfma_f32_32x32x16_bf16 v[208:223], v[172:175], a[248:251], v[208:223]
    v_mfma_f32_32x32x16_bf16 v[224:239], v[176:179], a[248:251], v[224:239]
    v_mad_u32_u24 v46, s48, 7, v6
    s_waitcnt vmcnt(0) lgkmcnt(0)
    v_mfma_f32_32x32x16_bf16 v[192:207], v[180:183], a[252:255], v[192:207]
    v_mfma_f32_32x32x16_bf16 v[208:223], v[184:187], a[252:255], v[208:223]
    v_mfma_f32_32x32x16_bf16 v[224:239], v[188:191], a[252:255], v[224:239]
    ds_read_b128 v[160:163], v46 offset:3072
    ds_read_b128 v[164:167], v46 offset:6656
    ds_read_b128 v[168:171], v46 offset:10240
    v_mfma_f32_32x32x16_bf16 v[176:191], a[236:239], v[248:251], 0
    s_waitcnt lgkmcnt(1)
    v_mfma_f32_32x32x16_bf16 v[176:191], v[160:163], v[48:51], v[176:191]
    ds_read_b128 v[172:175], v46 offset:13824
    v_mfma_f32_32x32x16_bf16 v[176:191], v[164:167], v[52:55], v[176:191]
    v_mad_u32_u24 v47, s49, 7, v6
    ds_read_b128 v[160:163], v47 offset:3072
    v_mul_f32 v240, v254, v192
    v_mul_f32 v241, v254, v193
    v_mul_f32 v242, v254, v194
    v_mul_f32 v243, v254, v195
    v_mul_f32 v244, v254, v196
    v_mul_f32 v245, v254, v197
    s_waitcnt lgkmcnt(1)
    v_mfma_f32_32x32x16_bf16 v[176:191], v[168:171], v[56:59], v[176:191]
    ds_read_b128 v[164:167], v47 offset:6656
    v_mul_f32 v246, v254, v198
    v_mul_f32 v247, v254, v199
    v_exp_f32 v240, v240
    v_mul_f32 v192, v252, v192
    v_exp_f32 v241, v241
    v_mul_f32 v193, v252, v193
    v_mfma_f32_32x32x16_bf16 v[176:191], v[172:175], v[60:63], v[176:191]
    ds_read_b128 v[168:171], v47 offset:10240
    v_exp_f32 v242, v242
    v_mul_f32 v194, v252, v194
    v_exp_f32 v243, v243
    v_mul_f32 v195, v252, v195
    v_exp_f32 v244, v244
    v_mul_f32 v196, v252, v196
    s_waitcnt lgkmcnt(1)
    v_mfma_f32_32x32x16_bf16 v[176:191], v[160:163], v[64:67], v[176:191]
    ds_read_b128 v[172:175], v47 offset:13824
    v_exp_f32 v245, v245
    v_mul_f32 v197, v252, v197
    v_exp_f32 v246, v246
    v_mul_f32 v198, v252, v198
    v_exp_f32 v247, v247
    v_mul_f32 v199, v252, v199
    v_mfma_f32_32x32x16_bf16 v[176:191], v[164:167], v[68:71], v[176:191]
    v_mad_u32_u24 v46, s50, 7, v6
    ds_read_b128 v[160:163], v46 offset:3072
    v_add_f32 v240, 1.0, v240
    v_add_f32 v241, 1.0, v241
    v_add_f32 v242, 1.0, v242
    v_add_f32 v243, 1.0, v243
    v_add_f32 v244, 1.0, v244
    v_add_f32 v245, 1.0, v245
    s_waitcnt lgkmcnt(1)
    v_mfma_f32_32x32x16_bf16 v[176:191], v[168:171], v[72:75], v[176:191]
    ds_read_b128 v[164:167], v46 offset:6656
    v_add_f32 v246, 1.0, v246
    v_add_f32 v247, 1.0, v247
    v_rcp_f32 v240, v240
    v_rcp_f32 v241, v241
    v_rcp_f32 v242, v242
    v_rcp_f32 v243, v243
    v_mfma_f32_32x32x16_bf16 v[176:191], v[172:175], v[76:79], v[176:191]
    ds_read_b128 v[168:171], v46 offset:10240
    v_rcp_f32 v244, v244
    v_rcp_f32 v245, v245
    v_rcp_f32 v246, v246
    v_rcp_f32 v247, v247
    v_mul_f32 v192, v192, v240
    v_mul_f32 v193, v193, v241
    s_waitcnt lgkmcnt(1)
    v_mfma_f32_32x32x16_bf16 v[176:191], v[160:163], v[80:83], v[176:191]
    ds_read_b128 v[172:175], v46 offset:13824
    v_mul_f32 v194, v194, v242
    v_mul_f32 v195, v195, v243
    v_mul_f32 v196, v196, v244
    v_mul_f32 v197, v197, v245
    v_mul_f32 v198, v198, v246
    v_mul_f32 v199, v199, v247
    v_mfma_f32_32x32x16_bf16 v[176:191], v[164:167], v[84:87], v[176:191]
    v_mad_u32_u24 v47, s51, 7, v6
    ds_read_b128 v[160:163], v47 offset:3072
    v_cvt_pk_bf16_f32 v192, v192, v193
    v_cvt_pk_bf16_f32 v193, v194, v195
    v_cvt_pk_bf16_f32 v194, v196, v197
    v_cvt_pk_bf16_f32 v195, v198, v199
    buffer_store_dwordx4 v[192:195], v1, s[4:7], s96 offen offset:0 sc1
    v_mul_f32 v240, v254, v200
    s_waitcnt lgkmcnt(1)
    v_mfma_f32_32x32x16_bf16 v[176:191], v[168:171], v[88:91], v[176:191]
    ds_read_b128 v[164:167], v47 offset:6656
    v_mul_f32 v241, v254, v201
    v_mul_f32 v242, v254, v202
    v_mul_f32 v243, v254, v203
    v_mul_f32 v244, v254, v204
    v_mul_f32 v245, v254, v205
    v_mul_f32 v246, v254, v206
    v_mfma_f32_32x32x16_bf16 v[176:191], v[172:175], v[92:95], v[176:191]
    ds_read_b128 v[168:171], v47 offset:10240
    v_mul_f32 v247, v254, v207
    v_exp_f32 v240, v240
    v_mul_f32 v200, v252, v200
    v_exp_f32 v241, v241
    v_mul_f32 v201, v252, v201
    v_exp_f32 v242, v242
    s_waitcnt lgkmcnt(1)
    v_mfma_f32_32x32x16_bf16 v[176:191], v[160:163], v[96:99], v[176:191]
    ds_read_b128 v[172:175], v47 offset:13824
    v_mul_f32 v202, v252, v202
    v_exp_f32 v243, v243
    v_mul_f32 v203, v252, v203
    v_exp_f32 v244, v244
    v_mul_f32 v204, v252, v204
    v_exp_f32 v245, v245
    v_mfma_f32_32x32x16_bf16 v[176:191], v[164:167], v[100:103], v[176:191]
    v_mad_u32_u24 v46, s52, 7, v6
    ds_read_b128 v[160:163], v46 offset:3072
    v_mul_f32 v205, v252, v205
    v_exp_f32 v246, v246
    v_mul_f32 v206, v252, v206
    v_exp_f32 v247, v247
    v_mul_f32 v207, v252, v207
    v_add_f32 v240, 1.0, v240
    s_waitcnt lgkmcnt(1)
    v_mfma_f32_32x32x16_bf16 v[176:191], v[168:171], v[104:107], v[176:191]
    ds_read_b128 v[164:167], v46 offset:6656
    v_add_f32 v241, 1.0, v241
    v_add_f32 v242, 1.0, v242
    v_add_f32 v243, 1.0, v243
    v_add_f32 v244, 1.0, v244
    v_add_f32 v245, 1.0, v245
    v_add_f32 v246, 1.0, v246
    v_mfma_f32_32x32x16_bf16 v[176:191], v[172:175], v[108:111], v[176:191]
    ds_read_b128 v[168:171], v46 offset:10240
    v_add_f32 v247, 1.0, v247
    v_rcp_f32 v240, v240
    v_rcp_f32 v241, v241
    v_rcp_f32 v242, v242
    v_rcp_f32 v243, v243
    v_rcp_f32 v244, v244
    s_waitcnt lgkmcnt(1)
    v_mfma_f32_32x32x16_bf16 v[176:191], v[160:163], v[112:115], v[176:191]
    ds_read_b128 v[172:175], v46 offset:13824
    v_rcp_f32 v245, v245
    v_rcp_f32 v246, v246
    v_rcp_f32 v247, v247
    v_mul_f32 v200, v200, v240
    v_mul_f32 v201, v201, v241
    v_mul_f32 v202, v202, v242
    v_mfma_f32_32x32x16_bf16 v[176:191], v[164:167], v[116:119], v[176:191]
    v_mad_u32_u24 v47, s53, 7, v6
    ds_read_b128 v[160:163], v47 offset:3072
    v_mul_f32 v203, v203, v243
    v_mul_f32 v204, v204, v244
    v_mul_f32 v205, v205, v245
    v_mul_f32 v206, v206, v246
    v_mul_f32 v207, v207, v247
    v_cvt_pk_bf16_f32 v200, v200, v201
    s_waitcnt lgkmcnt(1)
    v_mfma_f32_32x32x16_bf16 v[176:191], v[168:171], v[120:123], v[176:191]
    ds_read_b128 v[164:167], v47 offset:6656
    v_cvt_pk_bf16_f32 v201, v202, v203
    v_cvt_pk_bf16_f32 v202, v204, v205
    v_cvt_pk_bf16_f32 v203, v206, v207
    buffer_store_dwordx4 v[200:203], v1, s[4:7], s96 offen offset:1024 sc1
    v_mul_f32 v240, v254, v208
    v_mul_f32 v241, v254, v209
    v_mfma_f32_32x32x16_bf16 v[176:191], v[172:175], v[124:127], v[176:191]
    ds_read_b128 v[168:171], v47 offset:10240
    v_mul_f32 v242, v254, v210
    v_mul_f32 v243, v254, v211
    v_mul_f32 v244, v254, v212
    v_mul_f32 v245, v254, v213
    v_mul_f32 v246, v254, v214
    v_mul_f32 v247, v254, v215
    s_waitcnt lgkmcnt(1)
    v_mfma_f32_32x32x16_bf16 v[176:191], v[160:163], v[128:131], v[176:191]
    ds_read_b128 v[172:175], v47 offset:13824
    v_exp_f32 v240, v240
    v_mul_f32 v208, v252, v208
    v_exp_f32 v241, v241
    v_mul_f32 v209, v252, v209
    v_exp_f32 v242, v242
    v_mul_f32 v210, v252, v210
    v_mfma_f32_32x32x16_bf16 v[176:191], v[164:167], v[132:135], v[176:191]
    v_mad_u32_u24 v46, s54, 7, v6
    ds_read_b128 v[160:163], v46 offset:3072
    v_exp_f32 v243, v243
    v_mul_f32 v211, v252, v211
    v_exp_f32 v244, v244
    v_mul_f32 v212, v252, v212
    v_exp_f32 v245, v245
    v_mul_f32 v213, v252, v213
    s_waitcnt lgkmcnt(1)
    v_mfma_f32_32x32x16_bf16 v[176:191], v[168:171], v[136:139], v[176:191]
    ds_read_b128 v[164:167], v46 offset:6656
    v_exp_f32 v246, v246
    v_mul_f32 v214, v252, v214
    v_exp_f32 v247, v247
    v_mul_f32 v215, v252, v215
    v_add_f32 v240, 1.0, v240
    v_add_f32 v241, 1.0, v241
    v_mfma_f32_32x32x16_bf16 v[176:191], v[172:175], v[140:143], v[176:191]
    ds_read_b128 v[168:171], v46 offset:10240
    v_add_f32 v242, 1.0, v242
    v_add_f32 v243, 1.0, v243
    v_add_f32 v244, 1.0, v244
    v_add_f32 v245, 1.0, v245
    v_add_f32 v246, 1.0, v246
    v_add_f32 v247, 1.0, v247
    s_waitcnt lgkmcnt(1)
    v_mfma_f32_32x32x16_bf16 v[176:191], v[160:163], v[144:147], v[176:191]
    ds_read_b128 v[172:175], v46 offset:13824
    v_rcp_f32 v240, v240
    v_rcp_f32 v241, v241
    v_rcp_f32 v242, v242
    v_rcp_f32 v243, v243
    v_rcp_f32 v244, v244
    v_rcp_f32 v245, v245
    v_mfma_f32_32x32x16_bf16 v[176:191], v[164:167], v[148:151], v[176:191]
    v_mad_u32_u24 v47, s55, 7, v6
    ds_read_b128 v[160:163], v47 offset:3072
    v_rcp_f32 v246, v246
    v_rcp_f32 v247, v247
    v_mul_f32 v208, v208, v240
    v_mul_f32 v209, v209, v241
    v_mul_f32 v210, v210, v242
    v_mul_f32 v211, v211, v243
    s_waitcnt lgkmcnt(1)
    v_mfma_f32_32x32x16_bf16 v[176:191], v[168:171], v[152:155], v[176:191]
    ds_read_b128 v[164:167], v47 offset:6656
    v_mul_f32 v212, v212, v244
    v_mul_f32 v213, v213, v245
    v_mul_f32 v214, v214, v246
    v_mul_f32 v215, v215, v247
    v_cvt_pk_bf16_f32 v208, v208, v209
    v_cvt_pk_bf16_f32 v209, v210, v211
    v_mfma_f32_32x32x16_bf16 v[176:191], v[172:175], v[156:159], v[176:191]
    ds_read_b128 v[168:171], v47 offset:10240
    v_cvt_pk_bf16_f32 v210, v212, v213
    v_cvt_pk_bf16_f32 v211, v214, v215
    buffer_store_dwordx4 v[208:211], v1, s[4:7], s96 offen offset:2048 sc1
    s_waitcnt lgkmcnt(1)
    v_mfma_f32_32x32x16_bf16 v[176:191], v[160:163], a[240:243], v[176:191]
    ds_read_b128 v[172:175], v47 offset:13824
    v_mfma_f32_32x32x16_bf16 v[176:191], v[164:167], a[244:247], v[176:191]
    s_waitcnt lgkmcnt(0)
    v_mfma_f32_32x32x16_bf16 v[176:191], v[168:171], a[248:251], v[176:191]
    v_mfma_f32_32x32x16_bf16 v[176:191], v[172:175], a[252:255], v[176:191]
    s_mul_i32 s30, s29, 114688
    s_mul_i32 s31, s20, 28672
    s_add_u32 s30, s30, s31
    s_add_u32 s30, s30, 22020096
    v_add_u32 v15, s30, v1
    v_add_u32 v47, 4096, v15
    v_add_u32 v2, 114688, v15
    v_add_u32 v3, 118784, v15
    v_pk_mul_f32 v[240:241], v[254:255], v[216:217]
    v_pk_mul_f32 v[242:243], v[254:255], v[218:219]
    v_pk_mul_f32 v[244:245], v[254:255], v[220:221]
    v_pk_mul_f32 v[246:247], v[254:255], v[222:223]
    v_exp_f32 v240, v240
    v_exp_f32 v241, v241
    v_pk_mul_f32 v[216:217], v[252:253], v[216:217]
    v_exp_f32 v242, v242
    v_exp_f32 v243, v243
    v_pk_mul_f32 v[218:219], v[252:253], v[218:219]
    v_exp_f32 v244, v244
    v_exp_f32 v245, v245
    v_pk_mul_f32 v[220:221], v[252:253], v[220:221]
    v_exp_f32 v246, v246
    v_exp_f32 v247, v247
    v_pk_mul_f32 v[222:223], v[252:253], v[222:223]
    v_pk_add_f32 v[240:241], v[240:241], 1.0 op_sel_hi:[1,0]
    v_pk_add_f32 v[242:243], v[242:243], 1.0 op_sel_hi:[1,0]
    v_pk_add_f32 v[244:245], v[244:245], 1.0 op_sel_hi:[1,0]
    v_pk_add_f32 v[246:247], v[246:247], 1.0 op_sel_hi:[1,0]
    v_rcp_f32 v240, v240
    v_rcp_f32 v241, v241
    v_rcp_f32 v242, v242
    v_rcp_f32 v243, v243
    v_rcp_f32 v244, v244
    v_rcp_f32 v245, v245
    v_rcp_f32 v246, v246
    v_rcp_f32 v247, v247
    v_pk_mul_f32 v[216:217], v[216:217], v[240:241]
    v_pk_mul_f32 v[218:219], v[218:219], v[242:243]
    v_pk_mul_f32 v[220:221], v[220:221], v[244:245]
    v_pk_mul_f32 v[222:223], v[222:223], v[246:247]
    v_cvt_pk_bf16_f32 v216, v216, v217
    v_cvt_pk_bf16_f32 v217, v218, v219
    v_cvt_pk_bf16_f32 v218, v220, v221
    v_cvt_pk_bf16_f32 v219, v222, v223
    buffer_store_dwordx4 v[216:219], v1, s[4:7], s96 offen offset:3072 sc1
    s_waitcnt vmcnt(1)
    s_mov_b64 exec, 1
    buffer_store_dword v11, v9, s[4:7], s38 offen offset:1536 sc1
    s_mov_b64 exec, -1
    v_pk_mul_f32 v[240:241], v[254:255], v[224:225]
    v_pk_mul_f32 v[242:243], v[254:255], v[226:227]
    v_pk_mul_f32 v[244:245], v[254:255], v[228:229]
    v_pk_mul_f32 v[246:247], v[254:255], v[230:231]
    v_exp_f32 v240, v240
    v_exp_f32 v241, v241
    v_pk_mul_f32 v[224:225], v[252:253], v[224:225]
    v_exp_f32 v242, v242
    v_exp_f32 v243, v243
    v_pk_mul_f32 v[226:227], v[252:253], v[226:227]
    v_exp_f32 v244, v244
    v_exp_f32 v245, v245
    v_pk_mul_f32 v[228:229], v[252:253], v[228:229]
    v_exp_f32 v246, v246
    v_exp_f32 v247, v247
    v_pk_mul_f32 v[230:231], v[252:253], v[230:231]
    v_pk_add_f32 v[240:241], v[240:241], 1.0 op_sel_hi:[1,0]
    v_pk_add_f32 v[242:243], v[242:243], 1.0 op_sel_hi:[1,0]
    v_pk_add_f32 v[244:245], v[244:245], 1.0 op_sel_hi:[1,0]
    v_pk_add_f32 v[246:247], v[246:247], 1.0 op_sel_hi:[1,0]
    v_rcp_f32 v240, v240
    v_rcp_f32 v241, v241
    v_rcp_f32 v242, v242
    v_rcp_f32 v243, v243
    v_rcp_f32 v244, v244
    v_rcp_f32 v245, v245
    v_rcp_f32 v246, v246
    v_rcp_f32 v247, v247
    v_pk_mul_f32 v[224:225], v[224:225], v[240:241]
    v_pk_mul_f32 v[226:227], v[226:227], v[242:243]
    v_pk_mul_f32 v[228:229], v[228:229], v[244:245]
    v_pk_mul_f32 v[230:231], v[230:231], v[246:247]
    v_cvt_pk_bf16_f32 v224, v224, v225
    v_cvt_pk_bf16_f32 v225, v226, v227
    v_cvt_pk_bf16_f32 v226, v228, v229
    v_cvt_pk_bf16_f32 v227, v230, v231
    buffer_store_dwordx4 v[224:227], v1, s[4:7], s97 offen offset:0 sc1
    v_pk_mul_f32 v[240:241], v[254:255], v[232:233]
    v_pk_mul_f32 v[242:243], v[254:255], v[234:235]
    v_pk_mul_f32 v[244:245], v[254:255], v[236:237]
    v_pk_mul_f32 v[246:247], v[254:255], v[238:239]
    v_exp_f32 v240, v240
    v_exp_f32 v241, v241
    v_pk_mul_f32 v[232:233], v[252:253], v[232:233]
    v_exp_f32 v242, v242
    v_exp_f32 v243, v243
    v_pk_mul_f32 v[234:235], v[252:253], v[234:235]
    v_exp_f32 v244, v244
    v_exp_f32 v245, v245
    v_pk_mul_f32 v[236:237], v[252:253], v[236:237]
    v_exp_f32 v246, v246
    v_exp_f32 v247, v247
    v_pk_mul_f32 v[238:239], v[252:253], v[238:239]
    v_pk_add_f32 v[240:241], v[240:241], 1.0 op_sel_hi:[1,0]
    v_pk_add_f32 v[242:243], v[242:243], 1.0 op_sel_hi:[1,0]
    v_pk_add_f32 v[244:245], v[244:245], 1.0 op_sel_hi:[1,0]
    v_pk_add_f32 v[246:247], v[246:247], 1.0 op_sel_hi:[1,0]
    v_rcp_f32 v240, v240
    v_rcp_f32 v241, v241
    v_rcp_f32 v242, v242
    v_rcp_f32 v243, v243
    v_rcp_f32 v244, v244
    v_rcp_f32 v245, v245
    v_rcp_f32 v246, v246
    v_rcp_f32 v247, v247
    v_pk_mul_f32 v[232:233], v[232:233], v[240:241]
    v_pk_mul_f32 v[234:235], v[234:235], v[242:243]
    v_pk_mul_f32 v[236:237], v[236:237], v[244:245]
    v_pk_mul_f32 v[238:239], v[238:239], v[246:247]
    v_cvt_pk_bf16_f32 v232, v232, v233
    v_cvt_pk_bf16_f32 v233, v234, v235
    v_cvt_pk_bf16_f32 v234, v236, v237
    v_cvt_pk_bf16_f32 v235, v238, v239
    buffer_store_dwordx4 v[232:235], v1, s[4:7], s97 offen offset:1024 sc1
    buffer_load_dword v45, v10, s[4:7], s27 offen offset:1536 sc1
    v_pk_mul_f32 v[240:241], v[254:255], v[176:177]
    v_pk_mul_f32 v[242:243], v[254:255], v[178:179]
    v_pk_mul_f32 v[244:245], v[254:255], v[180:181]
    v_pk_mul_f32 v[246:247], v[254:255], v[182:183]
    v_exp_f32 v240, v240
    v_exp_f32 v241, v241
    v_pk_mul_f32 v[176:177], v[252:253], v[176:177]
    v_exp_f32 v242, v242
    v_exp_f32 v243, v243
    v_pk_mul_f32 v[178:179], v[252:253], v[178:179]
    v_exp_f32 v244, v244
    v_exp_f32 v245, v245
    v_pk_mul_f32 v[180:181], v[252:253], v[180:181]
    v_exp_f32 v246, v246
    v_exp_f32 v247, v247
    v_pk_mul_f32 v[182:183], v[252:253], v[182:183]
    v_pk_add_f32 v[240:241], v[240:241], 1.0 op_sel_hi:[1,0]
    v_pk_add_f32 v[242:243], v[242:243], 1.0 op_sel_hi:[1,0]
    v_pk_add_f32 v[244:245], v[244:245], 1.0 op_sel_hi:[1,0]
    v_pk_add_f32 v[246:247], v[246:247], 1.0 op_sel_hi:[1,0]
    v_rcp_f32 v240, v240
    v_rcp_f32 v241, v241
    v_rcp_f32 v242, v242
    v_rcp_f32 v243, v243
    v_rcp_f32 v244, v244
    v_rcp_f32 v245, v245
    v_rcp_f32 v246, v246
    v_rcp_f32 v247, v247
    v_pk_mul_f32 v[176:177], v[176:177], v[240:241]
    v_pk_mul_f32 v[178:179], v[178:179], v[242:243]
    v_pk_mul_f32 v[180:181], v[180:181], v[244:245]
    v_pk_mul_f32 v[182:183], v[182:183], v[246:247]
    v_cvt_pk_bf16_f32 v176, v176, v177
    v_cvt_pk_bf16_f32 v177, v178, v179
    v_cvt_pk_bf16_f32 v178, v180, v181
    v_cvt_pk_bf16_f32 v179, v182, v183
    buffer_store_dwordx4 v[176:179], v1, s[4:7], s97 offen offset:2048 sc1
    s_waitcnt vmcnt(1)
    v_cmp_ne_u32 vcc, v11, v45
    s_nop 0
    s_and_b64 vcc, vcc, s[36:37]
    s_cbranch_scc0 S_54
    s_mov_b64 exec, s[36:37]
    buffer_load_dword v45, v10, s[4:7], s27 offen offset:1536 sc1
    s_waitcnt vmcnt(0)
    v_cmp_ne_u32 vcc, v11, v45
    s_mov_b64 exec, 1
    buffer_store_dword v11, v9, s[4:7], s38 offen offset:1792 sc1
    s_mov_b64 exec, -1
    s_cbranch_vccz S_55
    s_mov_b64 exec, s[36:37]
S_56:
    buffer_load_dword v45, v10, s[4:7], s27 offen offset:1536 sc1
    s_waitcnt vmcnt(0)
    v_cmp_ne_u32 vcc, v11, v45
    s_nop 0
    s_cbranch_vccz S_55
    s_add_u32 s39, s39, 1
    s_cmp_lt_u32 s39, 200000
    s_cbranch_scc1 S_56
S_55:
    s_mov_b64 exec, -1
S_54:
    s_cmp_lg_u32 s25, 0
    s_cbranch_scc1 Z_57
    buffer_load_dwordx4 a[0:3], v1, s[4:7], s8 offen offset:0
    buffer_load_dwordx4 a[4:7], v1, s[4:7], s8 offen offset:1024
    buffer_load_dwordx4 a[8:11], v1, s[4:7], s8 offen offset:2048
    buffer_load_dwordx4 a[12:15], v1, s[4:7], s8 offen offset:3072
    s_add_u32 s12, s8, 4096
    buffer_load_dwordx4 a[16:19], v1, s[4:7], s12 offen offset:0
    buffer_load_dwordx4 a[20:23], v1, s[4:7], s12 offen offset:1024
    buffer_load_dwordx4 a[24:27], v1, s[4:7], s12 offen offset:2048
    buffer_load_dwordx4 a[28:31], v1, s[4:7], s12 offen offset:3072
    s_add_u32 s12, s8, 8192
    buffer_load_dwordx4 a[32:35], v1, s[4:7], s12 offen offset:0
    buffer_load_dwordx4 a[36:39], v1, s[4:7], s12 offen offset:1024
    buffer_load_dwordx4 a[40:43], v1, s[4:7], s12 offen offset:2048
    buffer_load_dwordx4 a[44:47], v1, s[4:7], s12 offen offset:3072
    s_add_u32 s12, s8, 12288
    buffer_load_dwordx4 a[48:51], v1, s[4:7], s12 offen offset:0
    buffer_load_dwordx4 a[52:55], v1, s[4:7], s12 offen offset:1024
    buffer_load_dwordx4 a[56:59], v1, s[4:7], s9 offen offset:0
    buffer_load_dwordx4 a[60:63], v1, s[4:7], s9 offen offset:1024
    buffer_load_dwordx4 a[64:67], v1, s[4:7], s9 offen offset:2048
    buffer_load_dwordx4 a[68:71], v1, s[4:7], s9 offen offset:3072
    s_add_u32 s12, s9, 4096
    buffer_load_dwordx4 a[72:75], v1, s[4:7], s12 offen offset:0
    buffer_load_dwordx4 a[76:79], v1, s[4:7], s12 offen offset:1024
    buffer_load_dwordx4 a[80:83], v1, s[4:7], s12 offen offset:2048
    buffer_load_dwordx4 a[84:87], v1, s[4:7], s12 offen offset:3072
    s_add_u32 s12, s9, 8192
    buffer_load_dwordx4 a[88:91], v1, s[4:7], s12 offen offset:0
    buffer_load_dwordx4 a[92:95], v1, s[4:7], s12 offen offset:1024
    buffer_load_dwordx4 a[96:99], v1, s[4:7], s12 offen offset:2048
    buffer_load_dwordx4 a[100:103], v1, s[4:7], s12 offen offset:3072
    s_add_u32 s12, s9, 12288
    buffer_load_dwordx4 a[104:107], v1, s[4:7], s12 offen offset:0
    buffer_load_dwordx4 a[108:111], v1, s[4:7], s12 offen offset:1024
    buffer_load_dwordx4 a[112:115], v1, s[4:7], s10 offen offset:0
    buffer_load_dwordx4 a[116:119], v1, s[4:7], s10 offen offset:1024
    buffer_load_dwordx4 a[120:123], v1, s[4:7], s10 offen offset:2048
    buffer_load_dwordx4 a[124:127], v1, s[4:7], s10 offen offset:3072
    s_add_u32 s12, s10, 4096
    buffer_load_dwordx4 a[128:131], v1, s[4:7], s12 offen offset:0
    buffer_load_dwordx4 a[132:135], v1, s[4:7], s12 offen offset:1024
    buffer_load_dwordx4 a[136:139], v1, s[4:7], s12 offen offset:2048
    buffer_load_dwordx4 a[140:143], v1, s[4:7], s12 offen offset:3072
    s_add_u32 s12, s10, 8192
    buffer_load_dwordx4 a[144:147], v1, s[4:7], s12 offen offset:0
    buffer_load_dwordx4 a[148:151], v1, s[4:7], s12 offen offset:1024
    buffer_load_dwordx4 a[152:155], v1, s[4:7], s12 offen offset:2048
    buffer_load_dwordx4 a[156:159], v1, s[4:7], s12 offen offset:3072
    s_add_u32 s12, s10, 12288
    buffer_load_dwordx4 a[160:163], v1, s[4:7], s12 offen offset:0
    buffer_load_dwordx4 a[164:167], v1, s[4:7], s12 offen offset:1024
    buffer_load_dwordx4 a[168:171], v1, s[4:7], s11 offen offset:0
    buffer_load_dwordx4 a[172:175], v1, s[4:7], s11 offen offset:1024
    buffer_load_dwordx4 a[176:179], v1, s[4:7], s11 offen offset:2048
    buffer_load_dwordx4 a[180:183], v1, s[4:7], s11 offen offset:3072
    s_add_u32 s12, s11, 4096
    buffer_load_dwordx4 a[184:187], v1, s[4:7], s12 offen offset:0
    buffer_load_dwordx4 a[188:191], v1, s[4:7], s12 offen offset:1024
    buffer_load_dwordx4 a[192:195], v1, s[4:7], s12 offen offset:2048
    buffer_load_dwordx4 a[196:199], v1, s[4:7], s12 offen offset:3072
    s_add_u32 s12, s11, 8192
    buffer_load_dwordx4 a[200:203], v1, s[4:7], s12 offen offset:0
    buffer_load_dwordx4 a[204:207], v1, s[4:7], s12 offen offset:1024
    buffer_load_dwordx4 a[208:211], v1, s[4:7], s12 offen offset:2048
    buffer_load_dwordx4 a[212:215], v1, s[4:7], s12 offen offset:3072
    s_add_u32 s12, s11, 12288
    buffer_load_dwordx4 a[216:219], v1, s[4:7], s12 offen offset:0
    buffer_load_dwordx4 a[220:223], v1, s[4:7], s12 offen offset:1024
    s_waitcnt vmcnt(0)
Z_57:
    buffer_load_dwordx4 v[48:51], v15, s[4:7], s56 offen offset:0 sc1
    buffer_load_dwordx4 v[52:55], v15, s[4:7], s56 offen offset:1024 sc1
    buffer_load_dwordx4 v[56:59], v15, s[4:7], s56 offen offset:2048 sc1
    buffer_load_dwordx4 v[60:63], v15, s[4:7], s57 offen offset:0 sc1
    buffer_load_dwordx4 v[64:67], v15, s[4:7], s57 offen offset:1024 sc1
    buffer_load_dwordx4 v[68:71], v15, s[4:7], s57 offen offset:2048 sc1
    buffer_load_dwordx4 v[72:75], v15, s[4:7], s58 offen offset:0 sc1
    buffer_load_dwordx4 v[76:79], v15, s[4:7], s58 offen offset:1024 sc1
    s_waitcnt vmcnt(8)
    s_mov_b64 exec, 1
    buffer_store_dword v11, v9, s[4:7], s38 offen offset:1792 sc1
    s_mov_b64 exec, -1
    buffer_load_dwordx4 v[80:83], v15, s[4:7], s58 offen offset:2048 sc1
    buffer_load_dwordx4 v[84:87], v15, s[4:7], s59 offen offset:0 sc1
    buffer_load_dwordx4 v[88:91], v15, s[4:7], s59 offen offset:1024 sc1
    buffer_load_dwordx4 v[92:95], v15, s[4:7], s59 offen offset:2048 sc1
    buffer_load_dwordx4 v[96:99], v2, s[4:7], s56 offen offset:0 sc1
    buffer_load_dwordx4 v[100:103], v2, s[4:7], s56 offen offset:1024 sc1
    buffer_load_dwordx4 v[104:107], v2, s[4:7], s56 offen offset:2048 sc1
    buffer_load_dwordx4 v[108:111], v2, s[4:7], s57 offen offset:0 sc1
    s_barrier
    s_add_u32 s0, s0, 32768
    s_add_u32 s34, s34, 32768
    s_waitcnt vmcnt(16)
    v_mfma_f32_32x32x16_bf16 v[112:127], a[0:3], v[48:51], 0
    v_mfma_f32_32x32x16_bf16 v[128:143], a[4:7], v[48:51], 0
    buffer_load_dwordx4 v[48:51], v2, s[4:7], s57 offen offset:1024 sc1
    s_waitcnt vmcnt(16)
    v_mfma_f32_32x32x16_bf16 v[112:127], a[8:11], v[52:55], v[112:127]
    v_mfma_f32_32x32x16_bf16 v[128:143], a[12:15], v[52:55], v[128:143]
    buffer_load_dwordx4 v[52:55], v2, s[4:7], s57 offen offset:2048 sc1
    s_waitcnt vmcnt(16)
    v_mfma_f32_32x32x16_bf16 v[112:127], a[16:19], v[56:59], v[112:127]
    v_mfma_f32_32x32x16_bf16 v[128:143], a[20:23], v[56:59], v[128:143]
    buffer_load_dwordx4 v[56:59], v2, s[4:7], s58 offen offset:0 sc1
    buffer_load_dword v45, v10, s[4:7], s27 offen offset:1792 sc1
    s_waitcnt vmcnt(17)
    v_mfma_f32_32x32x16_bf16 v[112:127], a[56:59], v[60:63], v[112:127]
    v_mfma_f32_32x32x16_bf16 v[128:143], a[60:63], v[60:63], v[128:143]
    buffer_load_dwordx4 v[60:63], v2, s[4:7], s58 offen offset:1024 sc1
    s_waitcnt vmcnt(17)
    v_mfma_f32_32x32x16_bf16 v[112:127], a[64:67], v[64:67], v[112:127]
    v_mfma_f32_32x32x16_bf16 v[128:143], a[68:71], v[64:67], v[128:143]
    buffer_load_dwordx4 v[64:67], v2, s[4:7], s58 offen offset:2048 sc1
    s_mul_i32 s100, s20, 24576
    s_add_u32 m0, s100, 0
    s_mul_i32 s101, s22, 98304
    s_add_u32 s101, s101, s100
    s_add_u32 s101, s101, 6291456
    buffer_load_dwordx4 v1, s[4:7], s101 offen offset:0 lds
    s_waitcnt vmcnt(18)
    v_mfma_f32_32x32x16_bf16 v[112:127], a[72:75], v[68:71], v[112:127]
    v_mfma_f32_32x32x16_bf16 v[128:143], a[76:79], v[68:71], v[128:143]
    buffer_load_dwordx4 v[68:71], v2, s[4:7], s59 offen offset:0 sc1
    s_waitcnt vmcnt(18)
    v_mfma_f32_32x32x16_bf16 v[112:127], a[112:115], v[72:75], v[112:127]
    v_mfma_f32_32x32x16_bf16 v[128:143], a[116:119], v[72:75], v[128:143]
    buffer_load_dwordx4 v[72:75], v2, s[4:7], s59 offen offset:1024 sc1
    s_waitcnt vmcnt(18)
    v_mfma_f32_32x32x16_bf16 v[112:127], a[120:123], v[76:79], v[112:127]
    v_mfma_f32_32x32x16_bf16 v[128:143], a[124:127], v[76:79], v[128:143]
    buffer_load_dwordx4 v[76:79], v2, s[4:7], s59 offen offset:2048 sc1
    s_waitcnt vmcnt(6)
    v_cmp_ne_u32 vcc, v11, v45
    s_nop 0
    s_and_b64 vcc, vcc, s[36:37]
    s_cbranch_scc0 S_58
    s_mov_b64 exec, s[36:37]
S_60:
    buffer_load_dword v45, v10, s[4:7], s27 offen offset:1792 sc1
    s_waitcnt vmcnt(0)
    v_cmp_ne_u32 vcc, v11, v45
    s_nop 0
    s_cbranch_vccz S_59
    s_add_u32 s39, s39, 1
    s_cmp_lt_u32 s39, 200000
    s_cbranch_scc1 S_60
S_59:
    s_mov_b64 exec, -1
S_58:
    v_mfma_f32_32x32x16_bf16 v[112:127], a[128:131], v[80:83], v[112:127]
    v_mfma_f32_32x32x16_bf16 v[128:143], a[132:135], v[80:83], v[128:143]
    buffer_load_dwordx4 v[80:83], v15, s[4:7], s56 offen offset:3072 sc1
    v_mfma_f32_32x32x16_bf16 v[112:127], a[168:171], v[84:87], v[112:127]
    v_mfma_f32_32x32x16_bf16 v[128:143], a[172:175], v[84:87], v[128:143]
    buffer_load_dwordx4 v[84:87], v47, s[4:7], s56 offen offset:0 sc1
    buffer_load_dwordx4 v1, s[4:7], s101 offen offset:1024 lds
    v_mfma_f32_32x32x16_bf16 v[112:127], a[176:179], v[88:91], v[112:127]
    v_mfma_f32_32x32x16_bf16 v[128:143], a[180:183], v[88:91], v[128:143]
    buffer_load_dwordx4 v[88:91], v47, s[4:7], s56 offen offset:1024 sc1
    v_mfma_f32_32x32x16_bf16 v[112:127], a[184:187], v[92:95], v[112:127]
    v_mfma_f32_32x32x16_bf16 v[128:143], a[188:191], v[92:95], v[128:143]
    buffer_load_dwordx4 v[92:95], v47, s[4:7], s56 offen offset:2048 sc1
    v_mfma_f32_32x32x16_bf16 v[144:159], a[0:3], v[96:99], 0
    v_mfma_f32_32x32x16_bf16 v[160:175], a[4:7], v[96:99], 0
    buffer_load_dwordx4 v[96:99], v15, s[4:7], s57 offen offset:3072 sc1
    v_mfma_f32_32x32x16_bf16 v[144:159], a[8:11], v[100:103], v[144:159]
    v_mfma_f32_32x32x16_bf16 v[160:175], a[12:15], v[100:103], v[160:175]
    buffer_load_dwordx4 v[100:103], v47, s[4:7], s57 offen offset:0 sc1
    v_mfma_f32_32x32x16_bf16 v[144:159], a[16:19], v[104:107], v[144:159]
    v_mfma_f32_32x32x16_bf16 v[160:175], a[20:23], v[104:107], v[160:175]
    buffer_load_dwordx4 v[104:107], v47, s[4:7], s57 offen offset:1024 sc1
    buffer_load_dwordx4 v1, s[4:7], s101 offen offset:2048 lds
    v_mfma_f32_32x32x16_bf16 v[144:159], a[56:59], v[108:111], v[144:159]
    v_mfma_f32_32x32x16_bf16 v[160:175], a[60:63], v[108:111], v[160:175]
    buffer_load_dwordx4 v[108:111], v47, s[4:7], s57 offen offset:2048 sc1
    v_mfma_f32_32x32x16_bf16 v[144:159], a[64:67], v[48:51], v[144:159]
    v_mfma_f32_32x32x16_bf16 v[160:175], a[68:71], v[48:51], v[160:175]
    buffer_load_dwordx4 v[48:51], v15, s[4:7], s58 offen offset:3072 sc1
    v_mfma_f32_32x32x16_bf16 v[144:159], a[72:75], v[52:55], v[144:159]
    v_mfma_f32_32x32x16_bf16 v[160:175], a[76:79], v[52:55], v[160:175]
    buffer_load_dwordx4 v[52:55], v47, s[4:7], s58 offen offset:0 sc1
    v_mfma_f32_32x32x16_bf16 v[144:159], a[112:115], v[56:59], v[144:159]
    v_mfma_f32_32x32x16_bf16 v[160:175], a[116:119], v[56:59], v[160:175]
    buffer_load_dwordx4 v[56:59], v47, s[4:7], s58 offen offset:1024 sc1
    s_waitcnt vmcnt(18)
    v_mfma_f32_32x32x16_bf16 v[144:159], a[120:123], v[60:63], v[144:159]
    v_mfma_f32_32x32x16_bf16 v[160:175], a[124:127], v[60:63], v[160:175]
    buffer_load_dwordx4 v[60:63], v47, s[4:7], s58 offen offset:2048 sc1
    buffer_load_dwordx4 v1, s[4:7], s101 offen offset:3072 lds
    s_waitcnt vmcnt(19)
    v_mfma_f32_32x32x16_bf16 v[144:159], a[128:131], v[64:67], v[144:159]
    v_mfma_f32_32x32x16_bf16 v[160:175], a[132:135], v[64:67], v[160:175]
    buffer_load_dwordx4 v[64:67], v15, s[4:7], s59 offen offset:3072 sc1
    s_waitcnt vmcnt(18)
    v_mfma_f32_32x32x16_bf16 v[144:159], a[168:171], v[68:71], v[144:159]
    v_mfma_f32_32x32x16_bf16 v[160:175], a[172:175], v[68:71], v[160:175]
    buffer_load_dwordx4 v[68:71], v47, s[4:7], s59 offen offset:0 sc1
    s_waitcnt vmcnt(18)
    v_mfma_f32_32x32x16_bf16 v[144:159], a[176:179], v[72:75], v[144:159]
    v_mfma_f32_32x32x16_bf16 v[160:175], a[180:183], v[72:75], v[160:175]
    buffer_load_dwordx4 v[72:75], v47, s[4:7], s59 offen offset:1024 sc1
    s_waitcnt vmcnt(18)
    v_mfma_f32_32x32x16_bf16 v[144:159], a[184:187], v[76:79], v[144:159]
    v_mfma_f32_32x32x16_bf16 v[160:175], a[188:191], v[76:79], v[160:175]
    buffer_load_dwordx4 v[76:79], v47, s[4:7], s59 offen offset:2048 sc1
    s_waitcnt vmcnt(18)
    v_mfma_f32_32x32x16_bf16 v[112:127], a[24:27], v[80:83], v[112:127]
    v_mfma_f32_32x32x16_bf16 v[128:143], a[28:31], v[80:83], v[128:143]
    buffer_load_dwordx4 v[80:83], v2, s[4:7], s56 offen offset:3072 sc1
    s_add_u32 m0, m0, 4096
    s_add_u32 s101, s101, 4096
    buffer_load_dwordx4 v1, s[4:7], s101 offen offset:0 lds
    s_waitcnt vmcnt(19)
    v_mfma_f32_32x32x16_bf16 v[112:127], a[32:35], v[84:87], v[112:127]
    v_mfma_f32_32x32x16_bf16 v[128:143], a[36:39], v[84:87], v[128:143]
    buffer_load_dwordx4 v[84:87], v3, s[4:7], s56 offen offset:0 sc1
    s_waitcnt vmcnt(18)
    v_mfma_f32_32x32x16_bf16 v[112:127], a[40:43], v[88:91], v[112:127]
    v_mfma_f32_32x32x16_bf16 v[128:143], a[44:47], v[88:91], v[128:143]
    buffer_load_dwordx4 v[88:91], v3, s[4:7], s56 offen offset:1024 sc1
    s_waitcnt vmcnt(18)
    v_mfma_f32_32x32x16_bf16 v[112:127], a[48:51], v[92:95], v[112:127]
    v_mfma_f32_32x32x16_bf16 v[128:143], a[52:55], v[92:95], v[128:143]
    buffer_load_dwordx4 v[92:95], v3, s[4:7], s56 offen offset:2048 sc1
    s_waitcnt vmcnt(18)
    v_mfma_f32_32x32x16_bf16 v[112:127], a[80:83], v[96:99], v[112:127]
    v_mfma_f32_32x32x16_bf16 v[128:143], a[84:87], v[96:99], v[128:143]
    buffer_load_dwordx4 v[96:99], v2, s[4:7], s57 offen offset:3072 sc1
    s_waitcnt vmcnt(18)
    v_mfma_f32_32x32x16_bf16 v[112:127], a[88:91], v[100:103], v[112:127]
    v_mfma_f32_32x32x16_bf16 v[128:143], a[92:95], v[100:103], v[128:143]
    buffer_load_dwordx4 v[100:103], v3, s[4:7], s57 offen offset:0 sc1
    buffer_load_dwordx4 v1, s[4:7], s101 offen offset:1024 lds
    s_waitcnt vmcnt(19)
    v_mfma_f32_32x32x16_bf16 v[112:127], a[96:99], v[104:107], v[112:127]
    v_mfma_f32_32x32x16_bf16 v[128:143], a[100:103], v[104:107], v[128:143]
    buffer_load_dwordx4 v[104:107], v3, s[4:7], s57 offen offset:1024 sc1
    s_waitcnt vmcnt(18)
    v_mfma_f32_32x32x16_bf16 v[112:127], a[104:107], v[108:111], v[112:127]
    v_mfma_f32_32x32x16_bf16 v[128:143], a[108:111], v[108:111], v[128:143]
    buffer_load_dwordx4 v[108:111], v3, s[4:7], s57 offen offset:2048 sc1
    s_waitcnt vmcnt(18)
    v_mfma_f32_32x32x16_bf16 v[112:127], a[136:139], v[48:51], v[112:127]
    v_mfma_f32_32x32x16_bf16 v[128:143], a[140:143], v[48:51], v[128:143]
    buffer_load_dwordx4 v[48:51], v2, s[4:7], s58 offen offset:3072 sc1
    s_waitcnt vmcnt(18)
    v_mfma_f32_32x32x16_bf16 v[112:127], a[144:147], v[52:55], v[112:127]
    v_mfma_f32_32x32x16_bf16 v[128:143], a[148:151], v[52:55], v[128:143]
    buffer_load_dwordx4 v[52:55], v3, s[4:7], s58 offen offset:0 sc1
    s_waitcnt vmcnt(18)
    v_mfma_f32_32x32x16_bf16 v[112:127], a[152:155], v[56:59], v[112:127]
    v_mfma_f32_32x32x16_bf16 v[128:143], a[156:159], v[56:59], v[128:143]
    buffer_load_dwordx4 v[56:59], v3, s[4:7], s58 offen offset:1024 sc1
    buffer_load_dwordx4 v1, s[4:7], s101 offen offset:2048 lds
    s_waitcnt vmcnt(19)
    v_mfma_f32_32x32x16_bf16 v[112:127], a[160:163], v[60:63], v[112:127]
    v_mfma_f32_32x32x16_bf16 v[128:143], a[164:167], v[60:63], v[128:143]
    buffer_load_dwordx4 v[60:63], v3, s[4:7], s58 offen offset:2048 sc1
    s_waitcnt vmcnt(18)
    v_mfma_f32_32x32x16_bf16 v[112:127], a[192:195], v[64:67], v[112:127]
    v_mfma_f32_32x32x16_bf16 v[128:143], a[196:199], v[64:67], v[128:143]
    buffer_load_dwordx4 v[64:67], v2, s[4:7], s59 offen offset:3072 sc1
    s_waitcnt vmcnt(18)
    v_mfma_f32_32x32x16_bf16 v[112:127], a[200:203], v[68:71], v[112:127]
    v_mfma_f32_32x32x16_bf16 v[128:143], a[204:207], v[68:71], v[128:143]
    buffer_load_dwordx4 v[68:71], v3, s[4:7], s59 offen offset:0 sc1
    s_waitcnt vmcnt(18)
    v_mfma_f32_32x32x16_bf16 v[112:127], a[208:211], v[72:75], v[112:127]
    v_mfma_f32_32x32x16_bf16 v[128:143], a[212:215], v[72:75], v[128:143]
    buffer_load_dwordx4 v[72:75], v3, s[4:7], s59 offen offset:1024 sc1
    s_waitcnt vmcnt(18)
    v_mfma_f32_32x32x16_bf16 v[112:127], a[216:219], v[76:79], v[112:127]
    v_mfma_f32_32x32x16_bf16 v[128:143], a[220:223], v[76:79], v[128:143]
    buffer_load_dwordx4 v[76:79], v3, s[4:7], s59 offen offset:2048 sc1
    buffer_load_dwordx4 v1, s[4:7], s101 offen offset:3072 lds
    s_waitcnt vmcnt(19)
    v_mfma_f32_32x32x16_bf16 v[144:159], a[24:27], v[80:83], v[144:159]
    v_mfma_f32_32x32x16_bf16 v[160:175], a[28:31], v[80:83], v[160:175]
    s_add_u32 m0, m0, 4096
    s_add_u32 s101, s101, 4096
    buffer_load_dwordx4 v1, s[4:7], s101 offen offset:0 lds
    s_waitcnt vmcnt(18)
    v_mfma_f32_32x32x16_bf16 v[144:159], a[32:35], v[84:87], v[144:159]
    s_nop 0
    ds_write_b128 v12, v[112:115] offset:0
    v_mfma_f32_32x32x16_bf16 v[160:175], a[36:39], v[84:87], v[160:175]
    ds_write_b128 v12, v[116:119] offset:32
    buffer_load_dwordx4 v1, s[4:7], s101 offen offset:1024 lds
    s_waitcnt vmcnt(18)
    v_mfma_f32_32x32x16_bf16 v[144:159], a[40:43], v[88:91], v[144:159]
    ds_write_b128 v12, v[120:123] offset:64
    v_mfma_f32_32x32x16_bf16 v[160:175], a[44:47], v[88:91], v[160:175]
    ds_write_b128 v12, v[124:127] offset:96
    buffer_load_dwordx4 v1, s[4:7], s101 offen offset:2048 lds
    s_waitcnt vmcnt(18)
    v_mfma_f32_32x32x16_bf16 v[144:159], a[48:51], v[92:95], v[144:159]
    ds_write_b128 v12, v[128:131] offset:128
    v_mfma_f32_32x32x16_bf16 v[160:175], a[52:55], v[92:95], v[160:175]
    ds_write_b128 v12, v[132:135] offset:160
    buffer_load_dwordx4 v1, s[4:7], s101 offen offset:3072 lds
    s_waitcnt vmcnt(18)
    v_mfma_f32_32x32x16_bf16 v[144:159], a[80:83], v[96:99], v[144:159]
    ds_write_b128 v12, v[136:139] offset:192
    v_mfma_f32_32x32x16_bf16 v[160:175], a[84:87], v[96:99], v[160:175]
    ds_write_b128 v12, v[140:143] offset:224
    s_add_u32 m0, m0, 4096
    s_add_u32 s101, s101, 4096
    buffer_load_dwordx4 v1, s[4:7], s101 offen offset:0 lds
    s_waitcnt vmcnt(18)
    v_mfma_f32_32x32x16_bf16 v[144:159], a[88:91], v[100:103], v[144:159]
    v_mfma_f32_32x32x16_bf16 v[160:175], a[92:95], v[100:103], v[160:175]
    buffer_load_dwordx4 v1, s[4:7], s101 offen offset:1024 lds
    s_waitcnt lgkmcnt(0)
    s_barrier
    s_waitcnt vmcnt(17)
    v_mfma_f32_32x32x16_bf16 v[144:159], a[96:99], v[104:107], v[144:159]
    ds_read_b128 v[176:179], v13 offset:0
    ds_read_b128 v[180:183], v13 offset:16
    ds_read_b128 v[184:187], v13 offset:8704
    ds_read_b128 v[188:191], v13 offset:8720
    ds_read_b128 v[192:195], v13 offset:17408
    v_mfma_f32_32x32x16_bf16 v[160:175], a[100:103], v[104:107], v[160:175]
    ds_read_b128 v[196:199], v13 offset:17424
    ds_read_b128 v[200:203], v13 offset:26112
    ds_read_b128 v[204:207], v13 offset:26128
    s_nop 0
    s_nop 0
    buffer_load_dwordx4 v1, s[4:7], s101 offen offset:2048 lds
    s_waitcnt vmcnt(17)
    v_mfma_f32_32x32x16_bf16 v[144:159], a[104:107], v[108:111], v[144:159]
    s_waitcnt lgkmcnt(4)
    v_add_f32 v16, v16, v176
    v_add_f32 v17, v17, v177
    v_add_f32 v18, v18, v178
    v_add_f32 v19, v19, v179
    v_mfma_f32_32x32x16_bf16 v[160:175], a[108:111], v[108:111], v[160:175]
    v_add_f32 v20, v20, v180
    v_add_f32 v21, v21, v181
    v_add_f32 v22, v22, v182
    v_add_f32 v23, v23, v183
    v_add_f32 v16, v16, v184
    buffer_load_dwordx4 v1, s[4:7], s101 offen offset:3072 lds
    s_waitcnt vmcnt(17)
    v_mfma_f32_32x32x16_bf16 v[144:159], a[136:139], v[48:51], v[144:159]
    v_add_f32 v17, v17, v185
    v_add_f32 v18, v18, v186
    v_add_f32 v19, v19, v187
    v_add_f32 v20, v20, v188
    v_add_f32 v21, v21, v189
    v_mfma_f32_32x32x16_bf16 v[160:175], a[140:143], v[48:51], v[160:175]
    v_add_f32 v22, v22, v190
    v_add_f32 v23, v23, v191
    s_waitcnt lgkmcnt(0)
    v_add_f32 v16, v16, v192
    v_add_f32 v17, v17, v193
    s_add_u32 m0, m0, 4096
    s_add_u32 s101, s101, 4096
    buffer_load_dwordx4 v1, s[4:7], s101 offen offset:0 lds
    s_waitcnt vmcnt(17)
    v_mfma_f32_32x32x16_bf16 v[144:159], a[144:147], v[52:55], v[144:159]
    v_add_f32 v18, v18, v194
    v_add_f32 v19, v19, v195
    v_add_f32 v20, v20, v196
    v_add_f32 v21, v21, v197
    v_add_f32 v22, v22, v198
    v_mfma_f32_32x32x16_bf16 v[160:175], a[148:151], v[52:55], v[160:175]
    v_add_f32 v23, v23, v199
    v_add_f32 v16, v16, v200
    v_add_f32 v17, v17, v201
    v_add_f32 v18, v18, v202
    v_add_f32 v19, v19, v203
    buffer_load_dwordx4 v1, s[4:7], s101 offen offset:1024 lds
    s_waitcnt vmcnt(17)
    v_mfma_f32_32x32x16_bf16 v[144:159], a[152:155], v[56:59], v[144:159]
    v_add_f32 v20, v20, v204
    v_add_f32 v21, v21, v205
    v_add_f32 v22, v22, v206
    v_add_f32 v23, v23, v207
    v_cvt_pk_bf16_f32 v212, v16, v17
    v_mfma_f32_32x32x16_bf16 v[160:175], a[156:159], v[56:59], v[160:175]
    v_cvt_pk_bf16_f32 v213, v18, v19
    v_cvt_pk_bf16_f32 v214, v20, v21
    v_cvt_pk_bf16_f32 v215, v22, v23
    buffer_store_dwordx4 v[212:215], v5, s[4:7], 0 offen sc1
    v_add_f32 v216, v16, v17
    buffer_load_dwordx4 v1, s[4:7], s101 offen offset:2048 lds
    s_waitcnt vmcnt(17)
    v_mfma_f32_32x32x16_bf16 v[144:159], a[160:163], v[60:63], v[144:159]
    v_mul_f32 v218, v16, v16
    v_fmac_f32 v218, v17, v17
    v_add_f32 v216, v216, v18
    v_fmac_f32 v218, v18, v18
    v_add_f32 v216, v216, v19
    v_mfma_f32_32x32x16_bf16 v[160:175], a[164:167], v[60:63], v[160:175]
    v_fmac_f32 v218, v19, v19
    v_add_f32 v216, v216, v20
    v_fmac_f32 v218, v20, v20
    v_add_f32 v216, v216, v21
    v_fmac_f32 v218, v21, v21
    buffer_load_dwordx4 v1, s[4:7], s101 offen offset:3072 lds
    s_waitcnt vmcnt(17)
    v_mfma_f32_32x32x16_bf16 v[144:159], a[192:195], v[64:67], v[144:159]
    v_add_f32 v216, v216, v22
    v_fmac_f32 v218, v22, v22
    v_add_f32 v216, v216, v23
    v_fmac_f32 v218, v23, v23
    s_nop 1
    v_permlane16_swap_b32 v216, v218
    v_mfma_f32_32x32x16_bf16 v[160:175], a[196:199], v[64:67], v[160:175]
    v_add_f32 v216, v216, v218
    s_nop 1
    v_add_f32_dpp v216, v216, v216 row_ror:8 row_mask:0xf bank_mask:0xf
    v_mov_b32 v218, v216
    s_nop 1
    v_permlane32_swap_b32 v216, v218
    v_add_f32 v216, v216, v218
    s_add_u32 m0, m0, 4096
    s_add_u32 s101, s101, 4096
    buffer_load_dwordx4 v1, s[4:7], s101 offen offset:0 lds
    s_waitcnt vmcnt(17)
    v_mfma_f32_32x32x16_bf16 v[144:159], a[200:203], v[68:71], v[144:159]
    s_mov_b64 exec, 0xff00ff
    buffer_store_dword v216, v7, s[4:7], 0 offen offset:0 sc1
    s_mov_b64 exec, -1
    buffer_store_dwordx4 v[212:215], v4, s[16:19], 0 offen
    v_mfma_f32_32x32x16_bf16 v[160:175], a[204:207], v[68:71], v[160:175]
    buffer_load_dwordx4 v1, s[4:7], s101 offen offset:1024 lds
    s_waitcnt vmcnt(19)
    v_mfma_f32_32x32x16_bf16 v[144:159], a[208:211], v[72:75], v[144:159]
    v_mfma_f32_32x32x16_bf16 v[160:175], a[212:215], v[72:75], v[160:175]
    buffer_load_dwordx4 v1, s[4:7], s101 offen offset:2048 lds
    s_waitcnt vmcnt(19)
    v_mfma_f32_32x32x16_bf16 v[144:159], a[216:219], v[76:79], v[144:159]
    v_mfma_f32_32x32x16_bf16 v[160:175], a[220:223], v[76:79], v[160:175]
    buffer_load_dwordx4 v1, s[4:7], s101 offen offset:3072 lds
    s_barrier
    s_nop 8
    ds_write_b128 v12, v[144:147] offset:0
    ds_write_b128 v12, v[148:151] offset:32
    ds_write_b128 v12, v[152:155] offset:64
    ds_write_b128 v12, v[156:159] offset:96
    ds_write_b128 v12, v[160:163] offset:128
    ds_write_b128 v12, v[164:167] offset:160
    ds_write_b128 v12, v[168:171] offset:192
    ds_write_b128 v12, v[172:175] offset:224
    s_waitcnt vmcnt(3)
    s_mov_b64 exec, 1
    buffer_store_dword v11, v9, s[4:7], s0 offen offset:0 sc1
    s_mov_b64 exec, -1
    s_waitcnt vmcnt(1)
    s_waitcnt lgkmcnt(0)
    s_barrier
    ds_read_b128 v[176:179], v13 offset:0
    ds_read_b128 v[180:183], v13 offset:16
    ds_read_b128 v[184:187], v13 offset:8704
    ds_read_b128 v[188:191], v13 offset:8720
    ds_read_b128 v[192:195], v13 offset:17408
    ds_read_b128 v[196:199], v13 offset:17424
    ds_read_b128 v[200:203], v13 offset:26112
    ds_read_b128 v[204:207], v13 offset:26128
    s_waitcnt lgkmcnt(4)
    v_pk_add_f32 v[24:25], v[24:25], v[176:177]
    v_pk_add_f32 v[26:27], v[26:27], v[178:179]
    v_pk_add_f32 v[28:29], v[28:29], v[180:181]
    v_pk_add_f32 v[30:31], v[30:31], v[182:183]
    v_pk_add_f32 v[24:25], v[24:25], v[184:185]
    v_pk_add_f32 v[26:27], v[26:27], v[186:187]
    v_pk_add_f32 v[28:29], v[28:29], v[188:189]
    v_pk_add_f32 v[30:31], v[30:31], v[190:191]
    s_waitcnt lgkmcnt(0)
    v_pk_add_f32 v[24:25], v[24:25], v[192:193]
    v_pk_add_f32 v[26:27], v[26:27], v[194:195]
    v_pk_add_f32 v[28:29], v[28:29], v[196:197]
    v_pk_add_f32 v[30:31], v[30:31], v[198:199]
    v_pk_add_f32 v[24:25], v[24:25], v[200:201]
    v_pk_add_f32 v[26:27], v[26:27], v[202:203]
    v_pk_add_f32 v[28:29], v[28:29], v[204:205]
    v_pk_add_f32 v[30:31], v[30:31], v[206:207]
    v_cvt_pk_bf16_f32 v212, v24, v25
    v_cvt_pk_bf16_f32 v213, v26, v27
    v_cvt_pk_bf16_f32 v214, v28, v29
    v_cvt_pk_bf16_f32 v215, v30, v31
    buffer_store_dwordx4 v[212:215], v5, s[4:7], s63 offen sc1
    v_pk_add_f32 v[216:217], v[24:25], v[26:27]
    v_pk_mul_f32 v[218:219], v[24:25], v[24:25]
    v_pk_fma_f32 v[218:219], v[26:27], v[26:27], v[218:219]
    v_pk_add_f32 v[216:217], v[216:217], v[28:29]
    v_pk_fma_f32 v[218:219], v[28:29], v[28:29], v[218:219]
    v_pk_add_f32 v[216:217], v[216:217], v[30:31]
    v_pk_fma_f32 v[218:219], v[30:31], v[30:31], v[218:219]
    v_add_f32 v216, v216, v217
    v_add_f32 v218, v218, v219
    s_nop 1
    v_permlane16_swap_b32 v216, v218
    v_add_f32 v216, v216, v218
    s_nop 1
    v_add_f32_dpp v216, v216, v216 row_ror:8 row_mask:0xf bank_mask:0xf
    v_mov_b32 v218, v216
    s_nop 1
    v_permlane32_swap_b32 v216, v218
    v_add_f32 v216, v216, v218
    s_mov_b64 exec, 0xff00ff
    buffer_store_dword v216, v7, s[4:7], 0 offen offset:2048 sc1
    s_mov_b64 exec, -1
    buffer_store_dwordx4 v[212:215], v4, s[16:19], s63 offen
    s_cmp_lg_u32 s25, 0
    s_cbranch_scc1 M_done
    s_lshl_b32 s31, s28, 15
    s_add_u32 s30, s31, 16777216
    v_add_u32 v15, s30, v1
    s_mov_b32 s25, 1
    s_add_u32 s26, s26, 4194304
    s_add_u32 s27, s27, 32768
    s_add_u32 s38, s38, 32768
    s_waitcnt vmcnt(0)
    s_mov_b64 exec, 1
    buffer_store_dword v11, v9, s[4:7], s0 offen offset:128 sc1
    s_mov_b64 exec, -1
    s_branch M_layer_slow
M_done:
    s_waitcnt vmcnt(0)
M_end:
    s_endpgm
.section .rodata,"a"
.p2align 6
.amdhsa_kernel prep_kernel
  .amdhsa_next_free_vgpr 128
  .amdhsa_next_free_sgpr 100
  .amdhsa_accum_offset 128
  .amdhsa_group_segment_fixed_size 0
  .amdhsa_kernarg_size 72
  .amdhsa_user_sgpr_count 2
  .amdhsa_user_sgpr_kernarg_segment_ptr 1
  .amdhsa_system_sgpr_workgroup_id_x 1
.end_amdhsa_kernel
.p2align 6
.amdhsa_kernel main_kernel
  .amdhsa_next_free_vgpr 512
  .amdhsa_next_free_sgpr 102
  .amdhsa_accum_offset 256
  .amdhsa_group_segment_fixed_size 0
  .amdhsa_kernarg_size 72
  .amdhsa_user_sgpr_count 2
  .amdhsa_user_sgpr_kernarg_segment_ptr 1
  .amdhsa_system_sgpr_workgroup_id_x 1
.end_amdhsa_kernel
```
